```python
import torch

def _softmax(x, axis=-1):
    return torch.softmax(x, dim=axis)
def _gelu(x):
    return torch.nn.functional.gelu(x, approximate="tanh")
def _silu(x):
    return torch.nn.functional.silu(x)
def _sigmoid(x):
    return torch.sigmoid(x)
def _layernorm(x, axis=-1, eps=1e-5):
    m = x.mean(dim=axis, keepdim=True)
    v = x.var(dim=axis, keepdim=True, unbiased=False)
    return (x - m) / torch.sqrt(v + eps)
def _scatter_add(tgt, idx, src, axis=0):
    return tgt.clone().index_add_(axis, idx, src)
def _segment_sum(src, seg, n):
    out = torch.zeros((n,) + src.shape[1:], dtype=src.dtype)
    return out.index_add_(0, seg, src)
def _pad(x, pw):
    flat = tuple(v for pair in reversed(pw) for v in pair)
    return torch.nn.functional.pad(x, flat)

kernel_name = 'concat_heads__gqa_block_cached__mha_block_cached__near_ridge'

def setup_inputs():

    _w = (lambda a: (lambda t: t.to(torch.bfloat16) if t.is_floating_point() else t)(torch.as_tensor(a)))
    def _A_setup():
        B, Sq, D = 16, 80, 512
        Hq, Hkv, Sk, Dh = 32, 8, 1024, 128
        assert Hq % Hkv == 0, (Hq, Hkv)
        return {
            "x": _w((lambda *s: torch.randn(*s, dtype=torch.bfloat16) * 0.8)(B, Sq, D)),
            "k_cache": _w((lambda *s: torch.randn(*s, dtype=torch.bfloat16) * 0.8)(B, Hkv, Sk, Dh)),
            "v_cache": _w((lambda *s: torch.randn(*s, dtype=torch.bfloat16) * 0.05)(B, Hkv, Sk, Dh)),
            "wq": _w((lambda *s: torch.randn(*s, dtype=torch.bfloat16) * 0.8)(D, Hq * Dh) * (D ** -0.5)),
            "wo": _w((lambda *s: torch.randn(*s, dtype=torch.bfloat16) * 0.05)(Hq * Dh, D) * ((Hq * Dh) ** -0.5)),
        }
    _A_in = _A_setup()

    def _B_setup():
        B, Sq, D = 16, 80, 512
        H, Sk, Dh = 32, 1024, 128
        return {
            "x": _w((lambda *s: torch.randn(*s, dtype=torch.bfloat16) * 0.8)(B, Sq, D)),
            "k_cache": _w((lambda *s: torch.randn(*s, dtype=torch.bfloat16) * 0.8)(B, H, Sk, Dh)),
            "v_cache": _w((lambda *s: torch.randn(*s, dtype=torch.bfloat16) * 0.05)(B, H, Sk, Dh)),
            "wq": _w((lambda *s: torch.randn(*s, dtype=torch.bfloat16) * 0.8)(D, H * Dh) * (D ** -0.5)),
            "wo": _w((lambda *s: torch.randn(*s, dtype=torch.bfloat16) * 0.05)(H * Dh, D) * ((H * Dh) ** -0.5)),
        }
    _B_in = _B_setup()

    return {
        "A_x": _A_in["x"],
        "A_k_cache": _A_in["k_cache"],
        "A_v_cache": _A_in["v_cache"],
        "A_wq": _A_in["wq"],
        "A_wo": _A_in["wo"],
        "B_x": _B_in["x"],
        "B_k_cache": _B_in["k_cache"],
        "B_v_cache": _B_in["v_cache"],
        "B_wq": _B_in["wq"],
        "B_wo": _B_in["wo"],
    }

def reference(A_x, A_k_cache, A_v_cache, A_wq, A_wo, B_x, B_k_cache, B_v_cache, B_wq, B_wo):
    def _A_ref(x, k_cache, v_cache, wq, wo):
        B, Sq, D = x.shape
        Hq, Dh = 32, 128
        Hkv = k_cache.shape[1]
        rep = Hq // Hkv
        q = (lambda x, *d: x.permute(*d))((x @ wq).reshape(B, Sq, Hq, Dh), 0, 2, 1, 3)
        k = (lambda x, n, axis: torch.repeat_interleave(x, n, dim=axis))(k_cache, rep, axis=1)
        v = (lambda x, n, axis: torch.repeat_interleave(x, n, dim=axis))(v_cache, rep, axis=1)
        scores = torch.einsum("bhqd,bhkd->bhqk", q, k) * (Dh ** -0.5)
        p = _softmax(scores, axis=-1)
        o = torch.einsum("bhqk,bhkd->bhqd", p, v)
        return (lambda x, *d: x.permute(*d))(o, 0, 2, 1, 3).reshape(B, Sq, Hq * Dh) @ wo

    def _B_ref(x, k_cache, v_cache, wq, wo):
        B, Sq, D = x.shape
        H, Dh = 32, 128
        q = (lambda x, *d: x.permute(*d))((x @ wq).reshape(B, Sq, H, Dh), 0, 2, 1, 3)
        scores = torch.einsum("bhqd,bhkd->bhqk", q, k_cache) * (Dh ** -0.5)
        p = _softmax(scores, axis=-1)
        o = torch.einsum("bhqk,bhkd->bhqd", p, v_cache)
        return (lambda x, *d: x.permute(*d))(o, 0, 2, 1, 3).reshape(B, Sq, H * Dh) @ wo

    a = _A_ref(A_x, A_k_cache, A_v_cache, A_wq, A_wo)
    b = _B_ref(B_x, B_k_cache, B_v_cache, B_wq, B_wo)
    return torch.concatenate([a, b], axis=-1)
```

```asm
; @launch grid=(256,1,1) block=(256,1,1) lds=163840
.amdgcn_target "amdgcn-amd-amdhsa--gfx950"
.text
.globl concat_heads__gqa_block_cached__mha_block_cached__near_ridge_kernel
.p2align 8
.type concat_heads__gqa_block_cached__mha_block_cached__near_ridge_kernel,@function
concat_heads__gqa_block_cached__mha_block_cached__near_ridge_kernel:
    s_cmp_ge_u32 s2, 256
    s_cbranch_scc1 L_done
    s_load_dwordx16 s[36:51], s[0:1], 0
    s_load_dwordx8 s[52:59], s[0:1], 64
    s_load_dwordx2 s[60:61], s[0:1], 96
    v_lshrrev_b32 v1, 6, v0
    v_and_b32 v2, 63, v0
    v_readfirstlane_b32 s3, v1
    v_and_b32 v3, 15, v2
    v_lshrrev_b32 v4, 4, v2
    s_and_b32 s76, s2, 7
    s_bfe_u32 s77, s2, 0x10003
    s_lshr_b32 s78, s2, 4
    s_xor_b32 s77, s77, 1
    v_lshlrev_b32 v243, 7, v2
    s_getpc_b64 s[32:33]
L_pc1:
    s_add_u32 s32, s32, L_first - L_pc1
    s_addc_u32 s33, s33, 0
    s_and_b32 s33, s33, 0xffff
    s_mov_b32 s34, L_code_end - L_first
    s_mov_b32 s35, 0x20000
    s_lshr_b32 s80, s2, 3
    s_lshl_b32 s80, s80, 2
    s_add_u32 s80, s80, s3
    s_mul_i32 s80, s80, 512
    s_mov_b64 exec, 15
    buffer_load_dword v255, v243, s[32:35], s80 offen
    s_mov_b64 exec, -1
L_first:
    v_lshlrev_b32 v7, 1, v4
    v_xor_b32 v7, v7, v3
    v_lshlrev_b32 v7, 4, v7
    v_lshl_add_u32 v247, v4, 13, v7
    v_lshl_add_u32 v238, v4, 10, v7
    v_add_u32 v168, 0, v247
    v_add_u32 v169, 31744, v247
    v_xor_b32 v170, 0x80, v247
    v_add_u32 v170, 63488, v170
    v_xor_b32 v171, 0x80, v247
    v_add_u32 v171, 95232, v171
    v_add_u32 v172, 131072, v247
    v_add_u32 v173, 162816, v247
    v_xor_b32 v174, 0x80, v247
    v_add_u32 v174, 194560, v174
    v_xor_b32 v175, 0x80, v247
    v_add_u32 v175, 226304, v175
    s_and_b32 s74, s3, 1
    s_lshl_b32 s74, s74, 7
    v_xor_b32 v196, s74, v238
    s_lshl_b32 s75, s3, 14
    s_add_u32 s62, s75, 0
    s_add_u32 s63, s75, 4096
    s_add_u32 s64, s75, 8192
    s_add_u32 s65, s75, 12288
    s_lshl_b32 s4, s3, 10
    s_add_u32 s4, s4, 81920
    s_lshl_b32 s5, s3, 12
    s_mov_b32 s79, 0
    v_lshrrev_b32 v244, 1, v2
    v_and_b32 v245, 1, v2
    v_lshlrev_b32 v245, 7, v245
    v_lshl_or_b32 v246, v244, 13, v245
    s_lshl_b32 s80, s76, 2
    s_add_u32 s80, s80, s3
    s_lshl_b32 s80, s80, 8
    s_mul_i32 s81, s78, 81920
    s_lshl_b32 s100, s78, 18
    s_waitcnt lgkmcnt(0)
    s_cmp_lg_u32 s77, 0
    s_cbranch_scc1 L_nohelp
    s_add_u32 s32, s52, s80
    s_addc_u32 s33, s53, 0
    s_and_b32 s33, s33, 0xffff
    s_mov_b32 s34, 4186368
    s_mov_b32 s35, 0x20000
    buffer_load_dword v255, v246, s[32:35], s100 offen
    s_add_u32 s32, s46, s81
    s_addc_u32 s33, s47, 0
    s_and_b32 s33, s33, 0xffff
    s_mov_b32 s34, 81920
    s_mov_b32 s35, 0x20000
    s_mul_i32 s74, s3, 20
    v_add_u32 v247, s74, v244
    v_lshl_or_b32 v247, v247, 10, v245
    v_cmp_gt_u32 vcc, 40, v2
    v_mov_b32 v248, 0x7ffffff0
    s_nop 0
    v_cndmask_b32 v247, v248, v247, vcc
    buffer_load_dword v255, v247, s[32:35], 0 offen offset:256
    buffer_load_dword v255, v247, s[32:35], 0 offen offset:512
    buffer_load_dword v255, v247, s[32:35], 0 offen offset:768
L_nohelp:
    s_cmp_eq_u32 s77, 0
    s_cselect_b64 s[36:37], s[36:37], s[46:47]
    s_cselect_b64 s[42:43], s[42:43], s[52:53]
    s_add_u32 s16, s42, s80
    s_addc_u32 s17, s43, 0
    s_and_b32 s17, s17, 0xffff
    s_mov_b32 s18, 4186368
    s_mov_b32 s19, 0x20000
    s_add_u32 s24, s36, s81
    s_addc_u32 s25, s37, 0
    s_and_b32 s25, s25, 0xffff
    s_mov_b32 s26, 81920
    s_mov_b32 s27, 0x20000
    s_mov_b32 m0, s62
    s_nop 0
    buffer_load_dwordx4 v168, s[16:19], s79 offen offset:0 lds
    buffer_load_dwordx4 v170, s[16:19], s79 offen offset:2048 lds
    s_mov_b32 m0, s63
    s_nop 0
    buffer_load_dwordx4 v172, s[16:19], s79 offen offset:0 lds
    buffer_load_dwordx4 v174, s[16:19], s79 offen offset:2048 lds
    s_mov_b32 m0, s62
    s_nop 0
    buffer_load_dwordx4 v169, s[16:19], s79 offen offset:1024 lds
    buffer_load_dwordx4 v171, s[16:19], s79 offen offset:3072 lds
    s_mov_b32 m0, s63
    s_nop 0
    buffer_load_dwordx4 v173, s[16:19], s79 offen offset:1024 lds
    buffer_load_dwordx4 v175, s[16:19], s79 offen offset:3072 lds
    s_add_u32 s79, s79, 262144
    s_add_u32 m0, s4, 0
    s_add_u32 s75, s5, 0
    buffer_load_dwordx4 v196, s[24:27], s75 offen lds
    s_add_u32 m0, s4, 4096
    s_add_u32 s75, s5, 16384
    buffer_load_dwordx4 v196, s[24:27], s75 offen lds
    s_add_u32 m0, s4, 8192
    s_add_u32 s75, s5, 32768
    buffer_load_dwordx4 v196, s[24:27], s75 offen lds
    s_add_u32 m0, s4, 12288
    s_add_u32 s75, s5, 49152
    buffer_load_dwordx4 v196, s[24:27], s75 offen lds
    s_add_u32 m0, s4, 16384
    s_add_u32 s75, s5, 65536
    buffer_load_dwordx4 v196, s[24:27], s75 offen lds
    s_mov_b32 m0, s64
    s_nop 0
    buffer_load_dwordx4 v168, s[16:19], s79 offen offset:0 lds
    buffer_load_dwordx4 v170, s[16:19], s79 offen offset:2048 lds
    s_mov_b32 m0, s65
    s_nop 0
    buffer_load_dwordx4 v172, s[16:19], s79 offen offset:0 lds
    buffer_load_dwordx4 v174, s[16:19], s79 offen offset:2048 lds
    s_mov_b32 m0, s64
    s_nop 0
    buffer_load_dwordx4 v169, s[16:19], s79 offen offset:1024 lds
    buffer_load_dwordx4 v171, s[16:19], s79 offen offset:3072 lds
    s_mov_b32 m0, s65
    s_nop 0
    buffer_load_dwordx4 v173, s[16:19], s79 offen offset:1024 lds
    buffer_load_dwordx4 v175, s[16:19], s79 offen offset:3072 lds
    s_add_u32 s79, s79, 262144
    s_cmp_lg_u32 s77, 0
    s_cbranch_scc1 L_nohelp2
    buffer_load_dword v255, v246, s[16:19], s100 offen
L_nohelp2:
    s_cmp_lg_u32 s3, 0
    s_cbranch_scc1 L_noclr
    s_lshl_b32 s74, s77, 4
    s_add_u32 s74, s74, s78
    s_lshl_b32 s74, s74, 7
    s_add_u32 s74, s74, 25165824
    s_add_u32 s28, s60, s74
    s_addc_u32 s29, s61, 0
    s_and_b32 s29, s29, 0xffff
    s_mov_b32 s30, 64
    s_mov_b32 s31, 0x20000
    s_mov_b64 exec, 1
    v_mov_b32 v249, 0
    s_lshl_b32 s74, s76, 2
    buffer_store_dword v249, v249, s[28:31], s74 offen sc1
    buffer_store_dword v249, v249, s[28:31], s74 offen offset:32 sc1
    s_mov_b64 exec, -1
L_noclr:
    v_bfe_u32 v5, v2, 2, 2
    v_and_b32 v6, 3, v2
    v_lshl_add_u32 v234, v4, 8, v7
    v_xor_b32 v235, 0x80, v234
    v_add_u32 v236, 0x1000, v234
    v_add_u32 v237, 0x1000, v235
    v_lshlrev_b32 v242, 4, v2
    v_lshl_or_b32 v239, v244, 10, v245
    s_lshl_b32 s75, s3, 14
    s_add_u32 s66, s75, 65536
    s_add_u32 s67, s75, 69632
    s_add_u32 s68, s75, 73728
    s_add_u32 s69, s75, 77824
    v_and_b32 v244, 7, v2
    v_lshlrev_b32 v244, 1, v244
    v_xor_b32 v244, v244, v4
    v_lshlrev_b32 v244, 4, v244
    v_lshl_add_u32 v244, v3, 8, v244
    v_add_u32 v222, s75, v244
    v_add_u32 v192, 81920, v244
    v_xor_b32 v223, 64, v222
    v_xor_b32 v193, 64, v192
    v_xor_b32 v224, 128, v222
    v_xor_b32 v194, 128, v192
    v_xor_b32 v225, 192, v222
    v_xor_b32 v195, 192, v192
    v_and_b32 v244, 1, v4
    v_lshl_or_b32 v244, v244, 2, v5
    v_lshlrev_b32 v244, 1, v244
    v_lshrrev_b32 v1, 1, v6
    v_xor_b32 v1, v1, v244
    v_lshlrev_b32 v1, 4, v1
    v_and_b32 v244, 1, v6
    v_lshl_or_b32 v1, v244, 3, v1
    v_lshl_add_u32 v1, v5, 8, v1
    v_add_u32 v1, s75, v1
    v_lshl_add_u32 v226, v4, 11, v1
    v_xor_b32 v227, 32, v226
    v_xor_b32 v228, 64, v226
    v_xor_b32 v229, 96, v226
    v_xor_b32 v230, 128, v226
    v_xor_b32 v231, 160, v226
    v_xor_b32 v232, 192, v226
    v_xor_b32 v233, 224, v226
    v_add_u32 v240, 0x10000, v242
    v_add_u32 v241, 131072, v242
    s_lshl_b32 s80, s78, 3
    s_add_u32 s80, s80, s76
    s_lshl_b32 s81, s80, 2
    s_add_u32 s81, s81, s3
    s_cmp_eq_u32 s77, 0
    s_cselect_b32 s81, s80, s81
    s_cselect_b64 s[38:39], s[38:39], s[48:49]
    s_cselect_b64 s[40:41], s[40:41], s[50:51]
    s_cselect_b64 s[44:45], s[44:45], s[54:55]
    s_lshl_b32 s81, s81, 18
    s_add_u32 s8, s38, s81
    s_addc_u32 s9, s39, 0
    s_and_b32 s9, s9, 0xffff
    s_mov_b32 s10, 262144
    s_mov_b32 s11, 0x20000
    s_add_u32 s12, s40, s81
    s_addc_u32 s13, s41, 0
    s_and_b32 s13, s13, 0xffff
    s_mov_b32 s14, 262144
    s_mov_b32 s15, 0x20000
    s_lshl_b32 s80, s76, 19
    s_lshl_b32 s81, s3, 8
    s_add_u32 s80, s80, s81
    s_add_u32 s20, s44, s80
    s_addc_u32 s21, s45, 0
    s_and_b32 s21, s21, 0xffff
    s_mov_b32 s22, 523520
    s_mov_b32 s23, 0x20000
    s_lshl_b32 s80, s77, 4
    s_add_u32 s80, s80, s78
    s_lshl_b32 s80, s80, 3
    s_add_u32 s80, s80, s76
    s_mul_i32 s80, s80, 81920
    s_mul_i32 s81, s3, 20480
    s_add_u32 s80, s80, s81
    s_add_u32 s28, s60, s80
    s_addc_u32 s29, s61, 0
    s_and_b32 s29, s29, 0xffff
    s_mov_b32 s30, 20480
    s_mov_b32 s31, 0x20000
    s_mov_b32 s82, 0x3e0293ee
    s_mov_b32 s83, 0x3e0293ee
    s_mov_b32 s73, 0
    s_mul_i32 s80, s3, 1
    s_cmp_eq_u32 s77, 0
    s_cselect_b32 s80, 0, s80
    s_mul_i32 s81, s78, 0
    s_add_u32 s80, s80, s81
    s_and_b32 s80, s80, 31
    s_lshl_b32 s55, s80, 13
    s_mov_b32 s71, s55
    s_add_u32 s70, s55, 8192
    s_and_b32 s70, s70, 262143
    s_waitcnt vmcnt(8)
    s_barrier
    ds_read_b128 a[144:147], v192 offset:0
    ds_read_b128 a[148:151], v192 offset:4096
    ds_read_b128 a[152:155], v192 offset:8192
    ds_read_b128 a[156:159], v192 offset:12288
    ds_read_b128 a[160:163], v192 offset:16384
    ds_read_b64_tr_b16 a[80:81], v226 offset:0
    ds_read_b64_tr_b16 a[84:85], v227 offset:0
    ds_read_b64_tr_b16 a[88:89], v228 offset:0
    ds_read_b64_tr_b16 a[92:93], v229 offset:0
    ds_read_b64_tr_b16 a[96:97], v230 offset:0
    ds_read_b64_tr_b16 a[100:101], v231 offset:0
    ds_read_b64_tr_b16 a[104:105], v232 offset:0
    ds_read_b64_tr_b16 a[108:109], v233 offset:0
    ds_read_b64_tr_b16 a[82:83], v226 offset:1024
    ds_read_b64_tr_b16 a[86:87], v227 offset:1024
    ds_read_b64_tr_b16 a[90:91], v228 offset:1024
    ds_read_b64_tr_b16 a[94:95], v229 offset:1024
    ds_read_b64_tr_b16 a[98:99], v230 offset:1024
    ds_read_b64_tr_b16 a[102:103], v231 offset:1024
    ds_read_b64_tr_b16 a[106:107], v232 offset:1024
    ds_read_b64_tr_b16 a[110:111], v233 offset:1024
    s_waitcnt lgkmcnt(5)
    v_mfma_f32_16x16x32_bf16 v[8:11], a[80:83], a[144:147], 0
    s_mov_b32 m0, s62
    v_mfma_f32_16x16x32_bf16 v[12:15], a[80:83], a[148:151], 0
    buffer_load_dwordx4 v168, s[16:19], s79 offen offset:0 lds
    v_mfma_f32_16x16x32_bf16 v[16:19], a[80:83], a[152:155], 0
    v_mfma_f32_16x16x32_bf16 v[20:23], a[80:83], a[156:159], 0
    v_mfma_f32_16x16x32_bf16 v[24:27], a[80:83], a[160:163], 0
    v_mfma_f32_16x16x32_bf16 v[28:31], a[84:87], a[144:147], 0
    buffer_load_dwordx4 v170, s[16:19], s79 offen offset:2048 lds
    v_mfma_f32_16x16x32_bf16 v[32:35], a[84:87], a[148:151], 0
    v_mfma_f32_16x16x32_bf16 v[36:39], a[84:87], a[152:155], 0
    v_mfma_f32_16x16x32_bf16 v[40:43], a[84:87], a[156:159], 0
    s_mov_b32 m0, s63
    v_mfma_f32_16x16x32_bf16 v[44:47], a[84:87], a[160:163], 0
    buffer_load_dwordx4 v172, s[16:19], s79 offen offset:0 lds
    v_mfma_f32_16x16x32_bf16 v[48:51], a[88:91], a[144:147], 0
    s_waitcnt lgkmcnt(0)
    v_mfma_f32_16x16x32_bf16 v[52:55], a[88:91], a[148:151], 0
    v_mfma_f32_16x16x32_bf16 v[56:59], a[88:91], a[152:155], 0
    v_mfma_f32_16x16x32_bf16 v[60:63], a[88:91], a[156:159], 0
    buffer_load_dwordx4 v174, s[16:19], s79 offen offset:2048 lds
    v_mfma_f32_16x16x32_bf16 v[64:67], a[88:91], a[160:163], 0
    ds_read_b128 a[164:167], v193 offset:0
    v_mfma_f32_16x16x32_bf16 v[68:71], a[92:95], a[144:147], 0
    ds_read_b128 a[168:171], v193 offset:4096
    v_mfma_f32_16x16x32_bf16 v[72:75], a[92:95], a[148:151], 0
    s_mov_b32 m0, s62
    ds_read_b128 a[172:175], v193 offset:8192
    v_mfma_f32_16x16x32_bf16 v[76:79], a[92:95], a[152:155], 0
    buffer_load_dwordx4 v169, s[16:19], s79 offen offset:1024 lds
    v_mfma_f32_16x16x32_bf16 v[80:83], a[92:95], a[156:159], 0
    ds_read_b128 a[176:179], v193 offset:12288
    v_mfma_f32_16x16x32_bf16 v[84:87], a[92:95], a[160:163], 0
    ds_read_b128 a[180:183], v193 offset:16384
    v_mfma_f32_16x16x32_bf16 v[88:91], a[96:99], a[144:147], 0
    s_waitcnt vmcnt(9)
    ds_read_b64_tr_b16 a[112:113], v226 offset:8192
    v_mfma_f32_16x16x32_bf16 v[92:95], a[96:99], a[148:151], 0
    buffer_load_dwordx4 v171, s[16:19], s79 offen offset:3072 lds
    v_mfma_f32_16x16x32_bf16 v[96:99], a[96:99], a[152:155], 0
    ds_read_b64_tr_b16 a[116:117], v227 offset:8192
    v_mfma_f32_16x16x32_bf16 v[100:103], a[96:99], a[156:159], 0
    ds_read_b64_tr_b16 a[120:121], v228 offset:8192
    v_mfma_f32_16x16x32_bf16 v[104:107], a[96:99], a[160:163], 0
    s_mov_b32 m0, s63
    ds_read_b64_tr_b16 a[124:125], v229 offset:8192
    v_mfma_f32_16x16x32_bf16 v[108:111], a[100:103], a[144:147], 0
    buffer_load_dwordx4 v173, s[16:19], s79 offen offset:1024 lds
    v_mfma_f32_16x16x32_bf16 v[112:115], a[100:103], a[148:151], 0
    ds_read_b64_tr_b16 a[128:129], v230 offset:8192
    v_mfma_f32_16x16x32_bf16 v[116:119], a[100:103], a[152:155], 0
    ds_read_b64_tr_b16 a[132:133], v231 offset:8192
    v_mfma_f32_16x16x32_bf16 v[120:123], a[100:103], a[156:159], 0
    ds_read_b64_tr_b16 a[136:137], v232 offset:8192
    v_mfma_f32_16x16x32_bf16 v[124:127], a[100:103], a[160:163], 0
    buffer_load_dwordx4 v175, s[16:19], s79 offen offset:3072 lds
    v_mfma_f32_16x16x32_bf16 v[128:131], a[104:107], a[144:147], 0
    s_add_u32 s79, s79, 262144
    s_add_u32 s75, s5, 256
    ds_read_b64_tr_b16 a[140:141], v233 offset:8192
    v_mfma_f32_16x16x32_bf16 v[132:135], a[104:107], a[148:151], 0
    s_add_u32 m0, s4, 20480
    s_waitcnt vmcnt(8)
    ds_read_b64_tr_b16 a[114:115], v226 offset:9216
    v_mfma_f32_16x16x32_bf16 v[136:139], a[104:107], a[152:155], 0
    buffer_load_dwordx4 v196, s[24:27], s75 offen lds
    v_mfma_f32_16x16x32_bf16 v[140:143], a[104:107], a[156:159], 0
    s_add_u32 s75, s5, 16640
    ds_read_b64_tr_b16 a[118:119], v227 offset:9216
    v_mfma_f32_16x16x32_bf16 v[144:147], a[104:107], a[160:163], 0
    s_add_u32 m0, s4, 24576
    ds_read_b64_tr_b16 a[122:123], v228 offset:9216
    v_mfma_f32_16x16x32_bf16 v[148:151], a[108:111], a[144:147], 0
    buffer_load_dwordx4 v196, s[24:27], s75 offen lds
    v_mfma_f32_16x16x32_bf16 v[152:155], a[108:111], a[148:151], 0
    s_add_u32 s75, s5, 33024
    ds_read_b64_tr_b16 a[126:127], v229 offset:9216
    v_mfma_f32_16x16x32_bf16 v[156:159], a[108:111], a[152:155], 0
    s_add_u32 m0, s4, 28672
    ds_read_b64_tr_b16 a[130:131], v230 offset:9216
    ds_read_b64_tr_b16 a[134:135], v231 offset:9216
    v_mfma_f32_16x16x32_bf16 v[160:163], a[108:111], a[156:159], 0
    buffer_load_dwordx4 v196, s[24:27], s75 offen lds
    v_mfma_f32_16x16x32_bf16 v[164:167], a[108:111], a[160:163], 0
    ds_read_b64_tr_b16 a[138:139], v232 offset:9216
    ds_read_b64_tr_b16 a[142:143], v233 offset:9216
    s_waitcnt lgkmcnt(5)
    v_mfma_f32_16x16x32_bf16 v[8:11], a[112:115], a[164:167], v[8:11]
    s_mov_b32 m0, s64
    v_mfma_f32_16x16x32_bf16 v[12:15], a[112:115], a[168:171], v[12:15]
    buffer_load_dwordx4 v168, s[16:19], s79 offen offset:0 lds
    v_mfma_f32_16x16x32_bf16 v[16:19], a[112:115], a[172:175], v[16:19]
    v_mfma_f32_16x16x32_bf16 v[20:23], a[112:115], a[176:179], v[20:23]
    v_mfma_f32_16x16x32_bf16 v[24:27], a[112:115], a[180:183], v[24:27]
    v_mfma_f32_16x16x32_bf16 v[28:31], a[116:119], a[164:167], v[28:31]
    buffer_load_dwordx4 v170, s[16:19], s79 offen offset:2048 lds
    v_mfma_f32_16x16x32_bf16 v[32:35], a[116:119], a[168:171], v[32:35]
    v_mfma_f32_16x16x32_bf16 v[36:39], a[116:119], a[172:175], v[36:39]
    v_mfma_f32_16x16x32_bf16 v[40:43], a[116:119], a[176:179], v[40:43]
    s_mov_b32 m0, s65
    v_mfma_f32_16x16x32_bf16 v[44:47], a[116:119], a[180:183], v[44:47]
    buffer_load_dwordx4 v172, s[16:19], s79 offen offset:0 lds
    v_mfma_f32_16x16x32_bf16 v[48:51], a[120:123], a[164:167], v[48:51]
    s_waitcnt lgkmcnt(0)
    v_mfma_f32_16x16x32_bf16 v[52:55], a[120:123], a[168:171], v[52:55]
    v_mfma_f32_16x16x32_bf16 v[56:59], a[120:123], a[172:175], v[56:59]
    v_mfma_f32_16x16x32_bf16 v[60:63], a[120:123], a[176:179], v[60:63]
    buffer_load_dwordx4 v174, s[16:19], s79 offen offset:2048 lds
    v_mfma_f32_16x16x32_bf16 v[64:67], a[120:123], a[180:183], v[64:67]
    ds_read_b128 a[144:147], v194 offset:0
    v_mfma_f32_16x16x32_bf16 v[68:71], a[124:127], a[164:167], v[68:71]
    ds_read_b128 a[148:151], v194 offset:4096
    v_mfma_f32_16x16x32_bf16 v[72:75], a[124:127], a[168:171], v[72:75]
    s_mov_b32 m0, s64
    ds_read_b128 a[152:155], v194 offset:8192
    v_mfma_f32_16x16x32_bf16 v[76:79], a[124:127], a[172:175], v[76:79]
    buffer_load_dwordx4 v169, s[16:19], s79 offen offset:1024 lds
    v_mfma_f32_16x16x32_bf16 v[80:83], a[124:127], a[176:179], v[80:83]
    ds_read_b128 a[156:159], v194 offset:12288
    v_mfma_f32_16x16x32_bf16 v[84:87], a[124:127], a[180:183], v[84:87]
    ds_read_b128 a[160:163], v194 offset:16384
    v_mfma_f32_16x16x32_bf16 v[88:91], a[128:131], a[164:167], v[88:91]
    s_waitcnt vmcnt(12)
    ds_read_b64_tr_b16 a[80:81], v226 offset:0
    v_mfma_f32_16x16x32_bf16 v[92:95], a[128:131], a[168:171], v[92:95]
    buffer_load_dwordx4 v171, s[16:19], s79 offen offset:3072 lds
    v_mfma_f32_16x16x32_bf16 v[96:99], a[128:131], a[172:175], v[96:99]
    ds_read_b64_tr_b16 a[84:85], v227 offset:0
    v_mfma_f32_16x16x32_bf16 v[100:103], a[128:131], a[176:179], v[100:103]
    ds_read_b64_tr_b16 a[88:89], v228 offset:0
    v_mfma_f32_16x16x32_bf16 v[104:107], a[128:131], a[180:183], v[104:107]
    s_mov_b32 m0, s65
    ds_read_b64_tr_b16 a[92:93], v229 offset:0
    v_mfma_f32_16x16x32_bf16 v[108:111], a[132:135], a[164:167], v[108:111]
    buffer_load_dwordx4 v173, s[16:19], s79 offen offset:1024 lds
    v_mfma_f32_16x16x32_bf16 v[112:115], a[132:135], a[168:171], v[112:115]
    ds_read_b64_tr_b16 a[96:97], v230 offset:0
    v_mfma_f32_16x16x32_bf16 v[116:119], a[132:135], a[172:175], v[116:119]
    ds_read_b64_tr_b16 a[100:101], v231 offset:0
    v_mfma_f32_16x16x32_bf16 v[120:123], a[132:135], a[176:179], v[120:123]
    ds_read_b64_tr_b16 a[104:105], v232 offset:0
    v_mfma_f32_16x16x32_bf16 v[124:127], a[132:135], a[180:183], v[124:127]
    buffer_load_dwordx4 v175, s[16:19], s79 offen offset:3072 lds
    v_mfma_f32_16x16x32_bf16 v[128:131], a[136:139], a[164:167], v[128:131]
    s_add_u32 s79, s79, 262144
    s_add_u32 s75, s5, 49408
    ds_read_b64_tr_b16 a[108:109], v233 offset:0
    v_mfma_f32_16x16x32_bf16 v[132:135], a[136:139], a[168:171], v[132:135]
    s_add_u32 m0, s4, 32768
    s_waitcnt vmcnt(11)
    ds_read_b64_tr_b16 a[82:83], v226 offset:1024
    v_mfma_f32_16x16x32_bf16 v[136:139], a[136:139], a[172:175], v[136:139]
    buffer_load_dwordx4 v196, s[24:27], s75 offen lds
    v_mfma_f32_16x16x32_bf16 v[140:143], a[136:139], a[176:179], v[140:143]
    s_add_u32 s75, s5, 65792
    ds_read_b64_tr_b16 a[86:87], v227 offset:1024
    v_mfma_f32_16x16x32_bf16 v[144:147], a[136:139], a[180:183], v[144:147]
    s_add_u32 m0, s4, 36864
    ds_read_b64_tr_b16 a[90:91], v228 offset:1024
    v_mfma_f32_16x16x32_bf16 v[148:151], a[140:143], a[164:167], v[148:151]
    buffer_load_dwordx4 v196, s[24:27], s75 offen lds
    v_mfma_f32_16x16x32_bf16 v[152:155], a[140:143], a[168:171], v[152:155]
    ds_read_b64_tr_b16 a[94:95], v229 offset:1024
    v_mfma_f32_16x16x32_bf16 v[156:159], a[140:143], a[172:175], v[156:159]
    ds_read_b64_tr_b16 a[98:99], v230 offset:1024
    v_mfma_f32_16x16x32_bf16 v[160:163], a[140:143], a[176:179], v[160:163]
    ds_read_b64_tr_b16 a[102:103], v231 offset:1024
    v_mfma_f32_16x16x32_bf16 v[164:167], a[140:143], a[180:183], v[164:167]
    ds_read_b64_tr_b16 a[106:107], v232 offset:1024
    ds_read_b64_tr_b16 a[110:111], v233 offset:1024
    s_waitcnt lgkmcnt(5)
    v_mfma_f32_16x16x32_bf16 v[8:11], a[80:83], a[144:147], v[8:11]
    s_mov_b32 m0, s62
    v_mfma_f32_16x16x32_bf16 v[12:15], a[80:83], a[148:151], v[12:15]
    buffer_load_dwordx4 v168, s[16:19], s79 offen offset:0 lds
    v_mfma_f32_16x16x32_bf16 v[16:19], a[80:83], a[152:155], v[16:19]
    v_mfma_f32_16x16x32_bf16 v[20:23], a[80:83], a[156:159], v[20:23]
    v_mfma_f32_16x16x32_bf16 v[24:27], a[80:83], a[160:163], v[24:27]
    v_mfma_f32_16x16x32_bf16 v[28:31], a[84:87], a[144:147], v[28:31]
    buffer_load_dwordx4 v170, s[16:19], s79 offen offset:2048 lds
    v_mfma_f32_16x16x32_bf16 v[32:35], a[84:87], a[148:151], v[32:35]
    v_mfma_f32_16x16x32_bf16 v[36:39], a[84:87], a[152:155], v[36:39]
    v_mfma_f32_16x16x32_bf16 v[40:43], a[84:87], a[156:159], v[40:43]
    s_mov_b32 m0, s63
    v_mfma_f32_16x16x32_bf16 v[44:47], a[84:87], a[160:163], v[44:47]
    buffer_load_dwordx4 v172, s[16:19], s79 offen offset:0 lds
    v_mfma_f32_16x16x32_bf16 v[48:51], a[88:91], a[144:147], v[48:51]
    s_waitcnt lgkmcnt(0)
    v_mfma_f32_16x16x32_bf16 v[52:55], a[88:91], a[148:151], v[52:55]
    v_mfma_f32_16x16x32_bf16 v[56:59], a[88:91], a[152:155], v[56:59]
    v_mfma_f32_16x16x32_bf16 v[60:63], a[88:91], a[156:159], v[60:63]
    buffer_load_dwordx4 v174, s[16:19], s79 offen offset:2048 lds
    v_mfma_f32_16x16x32_bf16 v[64:67], a[88:91], a[160:163], v[64:67]
    ds_read_b128 a[164:167], v195 offset:0
    v_mfma_f32_16x16x32_bf16 v[68:71], a[92:95], a[144:147], v[68:71]
    ds_read_b128 a[168:171], v195 offset:4096
    v_mfma_f32_16x16x32_bf16 v[72:75], a[92:95], a[148:151], v[72:75]
    s_mov_b32 m0, s62
    ds_read_b128 a[172:175], v195 offset:8192
    v_mfma_f32_16x16x32_bf16 v[76:79], a[92:95], a[152:155], v[76:79]
    buffer_load_dwordx4 v169, s[16:19], s79 offen offset:1024 lds
    v_mfma_f32_16x16x32_bf16 v[80:83], a[92:95], a[156:159], v[80:83]
    ds_read_b128 a[176:179], v195 offset:12288
    v_mfma_f32_16x16x32_bf16 v[84:87], a[92:95], a[160:163], v[84:87]
    ds_read_b128 a[180:183], v195 offset:16384
    v_mfma_f32_16x16x32_bf16 v[88:91], a[96:99], a[144:147], v[88:91]
    s_waitcnt vmcnt(11)
    ds_read_b64_tr_b16 a[112:113], v226 offset:8192
    v_mfma_f32_16x16x32_bf16 v[92:95], a[96:99], a[148:151], v[92:95]
    buffer_load_dwordx4 v171, s[16:19], s79 offen offset:3072 lds
    v_mfma_f32_16x16x32_bf16 v[96:99], a[96:99], a[152:155], v[96:99]
    ds_read_b64_tr_b16 a[116:117], v227 offset:8192
    v_mfma_f32_16x16x32_bf16 v[100:103], a[96:99], a[156:159], v[100:103]
    ds_read_b64_tr_b16 a[120:121], v228 offset:8192
    v_mfma_f32_16x16x32_bf16 v[104:107], a[96:99], a[160:163], v[104:107]
    s_mov_b32 m0, s63
    ds_read_b64_tr_b16 a[124:125], v229 offset:8192
    v_mfma_f32_16x16x32_bf16 v[108:111], a[100:103], a[144:147], v[108:111]
    buffer_load_dwordx4 v173, s[16:19], s79 offen offset:1024 lds
    v_mfma_f32_16x16x32_bf16 v[112:115], a[100:103], a[148:151], v[112:115]
    ds_read_b64_tr_b16 a[128:129], v230 offset:8192
    v_mfma_f32_16x16x32_bf16 v[116:119], a[100:103], a[152:155], v[116:119]
    ds_read_b64_tr_b16 a[132:133], v231 offset:8192
    v_mfma_f32_16x16x32_bf16 v[120:123], a[100:103], a[156:159], v[120:123]
    ds_read_b64_tr_b16 a[136:137], v232 offset:8192
    v_mfma_f32_16x16x32_bf16 v[124:127], a[100:103], a[160:163], v[124:127]
    buffer_load_dwordx4 v175, s[16:19], s79 offen offset:3072 lds
    v_mfma_f32_16x16x32_bf16 v[128:131], a[104:107], a[144:147], v[128:131]
    s_add_u32 s79, s79, 262144
    ds_read_b64_tr_b16 a[140:141], v233 offset:8192
    v_mfma_f32_16x16x32_bf16 v[132:135], a[104:107], a[148:151], v[132:135]
    s_waitcnt vmcnt(10)
    ds_read_b64_tr_b16 a[114:115], v226 offset:9216
    v_mfma_f32_16x16x32_bf16 v[136:139], a[104:107], a[152:155], v[136:139]
    ds_read_b64_tr_b16 a[118:119], v227 offset:9216
    v_mfma_f32_16x16x32_bf16 v[140:143], a[104:107], a[156:159], v[140:143]
    ds_read_b64_tr_b16 a[122:123], v228 offset:9216
    v_mfma_f32_16x16x32_bf16 v[144:147], a[104:107], a[160:163], v[144:147]
    ds_read_b64_tr_b16 a[126:127], v229 offset:9216
    v_mfma_f32_16x16x32_bf16 v[148:151], a[108:111], a[144:147], v[148:151]
    ds_read_b64_tr_b16 a[130:131], v230 offset:9216
    v_mfma_f32_16x16x32_bf16 v[152:155], a[108:111], a[148:151], v[152:155]
    ds_read_b64_tr_b16 a[134:135], v231 offset:9216
    v_mfma_f32_16x16x32_bf16 v[156:159], a[108:111], a[152:155], v[156:159]
    ds_read_b64_tr_b16 a[138:139], v232 offset:9216
    v_mfma_f32_16x16x32_bf16 v[160:163], a[108:111], a[156:159], v[160:163]
    ds_read_b64_tr_b16 a[142:143], v233 offset:9216
    v_mfma_f32_16x16x32_bf16 v[164:167], a[108:111], a[160:163], v[164:167]
    s_waitcnt lgkmcnt(5)
    v_mfma_f32_16x16x32_bf16 v[8:11], a[112:115], a[164:167], v[8:11]
    s_mov_b32 m0, s64
    v_mfma_f32_16x16x32_bf16 v[12:15], a[112:115], a[168:171], v[12:15]
    buffer_load_dwordx4 v168, s[16:19], s79 offen offset:0 lds
    v_mfma_f32_16x16x32_bf16 v[16:19], a[112:115], a[172:175], v[16:19]
    v_mfma_f32_16x16x32_bf16 v[20:23], a[112:115], a[176:179], v[20:23]
    v_mfma_f32_16x16x32_bf16 v[24:27], a[112:115], a[180:183], v[24:27]
    v_mfma_f32_16x16x32_bf16 v[28:31], a[116:119], a[164:167], v[28:31]
    buffer_load_dwordx4 v170, s[16:19], s79 offen offset:2048 lds
    v_mfma_f32_16x16x32_bf16 v[32:35], a[116:119], a[168:171], v[32:35]
    v_mfma_f32_16x16x32_bf16 v[36:39], a[116:119], a[172:175], v[36:39]
    v_mfma_f32_16x16x32_bf16 v[40:43], a[116:119], a[176:179], v[40:43]
    s_mov_b32 m0, s65
    v_mfma_f32_16x16x32_bf16 v[44:47], a[116:119], a[180:183], v[44:47]
    buffer_load_dwordx4 v172, s[16:19], s79 offen offset:0 lds
    v_mfma_f32_16x16x32_bf16 v[48:51], a[120:123], a[164:167], v[48:51]
    s_waitcnt lgkmcnt(0)
    v_mfma_f32_16x16x32_bf16 v[52:55], a[120:123], a[168:171], v[52:55]
    s_waitcnt vmcnt(11)
    v_mfma_f32_16x16x32_bf16 v[56:59], a[120:123], a[172:175], v[56:59]
    s_barrier
    v_mfma_f32_16x16x32_bf16 v[60:63], a[120:123], a[176:179], v[60:63]
    buffer_load_dwordx4 v174, s[16:19], s79 offen offset:2048 lds
    v_mfma_f32_16x16x32_bf16 v[64:67], a[120:123], a[180:183], v[64:67]
    ds_read_b128 a[144:147], v192 offset:20480
    v_mfma_f32_16x16x32_bf16 v[68:71], a[124:127], a[164:167], v[68:71]
    ds_read_b128 a[148:151], v192 offset:24576
    v_mfma_f32_16x16x32_bf16 v[72:75], a[124:127], a[168:171], v[72:75]
    s_mov_b32 m0, s64
    ds_read_b128 a[152:155], v192 offset:28672
    v_mfma_f32_16x16x32_bf16 v[76:79], a[124:127], a[172:175], v[76:79]
    buffer_load_dwordx4 v169, s[16:19], s79 offen offset:1024 lds
    v_mfma_f32_16x16x32_bf16 v[80:83], a[124:127], a[176:179], v[80:83]
    ds_read_b128 a[156:159], v192 offset:32768
    v_mfma_f32_16x16x32_bf16 v[84:87], a[124:127], a[180:183], v[84:87]
    ds_read_b128 a[160:163], v192 offset:36864
    v_mfma_f32_16x16x32_bf16 v[88:91], a[128:131], a[164:167], v[88:91]
    s_waitcnt vmcnt(9)
    ds_read_b64_tr_b16 a[80:81], v226 offset:0
    v_mfma_f32_16x16x32_bf16 v[92:95], a[128:131], a[168:171], v[92:95]
    buffer_load_dwordx4 v171, s[16:19], s79 offen offset:3072 lds
    v_mfma_f32_16x16x32_bf16 v[96:99], a[128:131], a[172:175], v[96:99]
    ds_read_b64_tr_b16 a[84:85], v227 offset:0
    v_mfma_f32_16x16x32_bf16 v[100:103], a[128:131], a[176:179], v[100:103]
    ds_read_b64_tr_b16 a[88:89], v228 offset:0
    v_mfma_f32_16x16x32_bf16 v[104:107], a[128:131], a[180:183], v[104:107]
    s_mov_b32 m0, s65
    ds_read_b64_tr_b16 a[92:93], v229 offset:0
    v_mfma_f32_16x16x32_bf16 v[108:111], a[132:135], a[164:167], v[108:111]
    buffer_load_dwordx4 v173, s[16:19], s79 offen offset:1024 lds
    v_mfma_f32_16x16x32_bf16 v[112:115], a[132:135], a[168:171], v[112:115]
    ds_read_b64_tr_b16 a[96:97], v230 offset:0
    v_mfma_f32_16x16x32_bf16 v[116:119], a[132:135], a[172:175], v[116:119]
    ds_read_b64_tr_b16 a[100:101], v231 offset:0
    v_mfma_f32_16x16x32_bf16 v[120:123], a[132:135], a[176:179], v[120:123]
    ds_read_b64_tr_b16 a[104:105], v232 offset:0
    v_mfma_f32_16x16x32_bf16 v[124:127], a[132:135], a[180:183], v[124:127]
    buffer_load_dwordx4 v175, s[16:19], s79 offen offset:3072 lds
    v_mfma_f32_16x16x32_bf16 v[128:131], a[136:139], a[164:167], v[128:131]
    s_add_u32 s79, s79, 262144
    s_add_u32 s75, s5, 512
    ds_read_b64_tr_b16 a[108:109], v233 offset:0
    v_mfma_f32_16x16x32_bf16 v[132:135], a[136:139], a[168:171], v[132:135]
    s_add_u32 m0, s4, 40960
    s_waitcnt vmcnt(8)
    ds_read_b64_tr_b16 a[82:83], v226 offset:1024
    v_mfma_f32_16x16x32_bf16 v[136:139], a[136:139], a[172:175], v[136:139]
    buffer_load_dwordx4 v196, s[24:27], s75 offen lds
    v_mfma_f32_16x16x32_bf16 v[140:143], a[136:139], a[176:179], v[140:143]
    s_add_u32 s75, s5, 16896
    ds_read_b64_tr_b16 a[86:87], v227 offset:1024
    v_mfma_f32_16x16x32_bf16 v[144:147], a[136:139], a[180:183], v[144:147]
    s_add_u32 m0, s4, 45056
    ds_read_b64_tr_b16 a[90:91], v228 offset:1024
    v_mfma_f32_16x16x32_bf16 v[148:151], a[140:143], a[164:167], v[148:151]
    buffer_load_dwordx4 v196, s[24:27], s75 offen lds
    v_mfma_f32_16x16x32_bf16 v[152:155], a[140:143], a[168:171], v[152:155]
    ds_read_b64_tr_b16 a[94:95], v229 offset:1024
    v_mfma_f32_16x16x32_bf16 v[156:159], a[140:143], a[172:175], v[156:159]
    ds_read_b64_tr_b16 a[98:99], v230 offset:1024
    v_mfma_f32_16x16x32_bf16 v[160:163], a[140:143], a[176:179], v[160:163]
    ds_read_b64_tr_b16 a[102:103], v231 offset:1024
    v_mfma_f32_16x16x32_bf16 v[164:167], a[140:143], a[180:183], v[164:167]
    ds_read_b64_tr_b16 a[106:107], v232 offset:1024
    ds_read_b64_tr_b16 a[110:111], v233 offset:1024
    s_waitcnt lgkmcnt(5)
    v_mfma_f32_16x16x32_bf16 v[8:11], a[80:83], a[144:147], v[8:11]
    s_mov_b32 m0, s62
    v_mfma_f32_16x16x32_bf16 v[12:15], a[80:83], a[148:151], v[12:15]
    buffer_load_dwordx4 v168, s[16:19], s79 offen offset:0 lds
    v_mfma_f32_16x16x32_bf16 v[16:19], a[80:83], a[152:155], v[16:19]
    v_mfma_f32_16x16x32_bf16 v[20:23], a[80:83], a[156:159], v[20:23]
    v_mfma_f32_16x16x32_bf16 v[24:27], a[80:83], a[160:163], v[24:27]
    v_mfma_f32_16x16x32_bf16 v[28:31], a[84:87], a[144:147], v[28:31]
    buffer_load_dwordx4 v170, s[16:19], s79 offen offset:2048 lds
    v_mfma_f32_16x16x32_bf16 v[32:35], a[84:87], a[148:151], v[32:35]
    v_mfma_f32_16x16x32_bf16 v[36:39], a[84:87], a[152:155], v[36:39]
    v_mfma_f32_16x16x32_bf16 v[40:43], a[84:87], a[156:159], v[40:43]
    s_mov_b32 m0, s63
    v_mfma_f32_16x16x32_bf16 v[44:47], a[84:87], a[160:163], v[44:47]
    buffer_load_dwordx4 v172, s[16:19], s79 offen offset:0 lds
    v_mfma_f32_16x16x32_bf16 v[48:51], a[88:91], a[144:147], v[48:51]
    s_waitcnt lgkmcnt(0)
    v_mfma_f32_16x16x32_bf16 v[52:55], a[88:91], a[148:151], v[52:55]
    v_mfma_f32_16x16x32_bf16 v[56:59], a[88:91], a[152:155], v[56:59]
    v_mfma_f32_16x16x32_bf16 v[60:63], a[88:91], a[156:159], v[60:63]
    buffer_load_dwordx4 v174, s[16:19], s79 offen offset:2048 lds
    v_mfma_f32_16x16x32_bf16 v[64:67], a[88:91], a[160:163], v[64:67]
    ds_read_b128 a[164:167], v193 offset:20480
    v_mfma_f32_16x16x32_bf16 v[68:71], a[92:95], a[144:147], v[68:71]
    ds_read_b128 a[168:171], v193 offset:24576
    v_mfma_f32_16x16x32_bf16 v[72:75], a[92:95], a[148:151], v[72:75]
    s_mov_b32 m0, s62
    ds_read_b128 a[172:175], v193 offset:28672
    v_mfma_f32_16x16x32_bf16 v[76:79], a[92:95], a[152:155], v[76:79]
    buffer_load_dwordx4 v169, s[16:19], s79 offen offset:1024 lds
    v_mfma_f32_16x16x32_bf16 v[80:83], a[92:95], a[156:159], v[80:83]
    ds_read_b128 a[176:179], v193 offset:32768
    v_mfma_f32_16x16x32_bf16 v[84:87], a[92:95], a[160:163], v[84:87]
    ds_read_b128 a[180:183], v193 offset:36864
    v_mfma_f32_16x16x32_bf16 v[88:91], a[96:99], a[144:147], v[88:91]
    s_waitcnt vmcnt(11)
    ds_read_b64_tr_b16 a[112:113], v226 offset:8192
    v_mfma_f32_16x16x32_bf16 v[92:95], a[96:99], a[148:151], v[92:95]
    buffer_load_dwordx4 v171, s[16:19], s79 offen offset:3072 lds
    v_mfma_f32_16x16x32_bf16 v[96:99], a[96:99], a[152:155], v[96:99]
    ds_read_b64_tr_b16 a[116:117], v227 offset:8192
    v_mfma_f32_16x16x32_bf16 v[100:103], a[96:99], a[156:159], v[100:103]
    ds_read_b64_tr_b16 a[120:121], v228 offset:8192
    v_mfma_f32_16x16x32_bf16 v[104:107], a[96:99], a[160:163], v[104:107]
    s_mov_b32 m0, s63
    ds_read_b64_tr_b16 a[124:125], v229 offset:8192
    v_mfma_f32_16x16x32_bf16 v[108:111], a[100:103], a[144:147], v[108:111]
    buffer_load_dwordx4 v173, s[16:19], s79 offen offset:1024 lds
    v_mfma_f32_16x16x32_bf16 v[112:115], a[100:103], a[148:151], v[112:115]
    ds_read_b64_tr_b16 a[128:129], v230 offset:8192
    v_mfma_f32_16x16x32_bf16 v[116:119], a[100:103], a[152:155], v[116:119]
    ds_read_b64_tr_b16 a[132:133], v231 offset:8192
    v_mfma_f32_16x16x32_bf16 v[120:123], a[100:103], a[156:159], v[120:123]
    ds_read_b64_tr_b16 a[136:137], v232 offset:8192
    v_mfma_f32_16x16x32_bf16 v[124:127], a[100:103], a[160:163], v[124:127]
    buffer_load_dwordx4 v175, s[16:19], s79 offen offset:3072 lds
    v_mfma_f32_16x16x32_bf16 v[128:131], a[104:107], a[144:147], v[128:131]
    s_add_u32 s79, s79, 262144
    s_add_u32 s75, s5, 33280
    ds_read_b64_tr_b16 a[140:141], v233 offset:8192
    v_mfma_f32_16x16x32_bf16 v[132:135], a[104:107], a[148:151], v[132:135]
    s_add_u32 m0, s4, 49152
    s_waitcnt vmcnt(10)
    ds_read_b64_tr_b16 a[114:115], v226 offset:9216
    v_mfma_f32_16x16x32_bf16 v[136:139], a[104:107], a[152:155], v[136:139]
    buffer_load_dwordx4 v196, s[24:27], s75 offen lds
    v_mfma_f32_16x16x32_bf16 v[140:143], a[104:107], a[156:159], v[140:143]
    s_add_u32 s75, s5, 49664
    ds_read_b64_tr_b16 a[118:119], v227 offset:9216
    v_mfma_f32_16x16x32_bf16 v[144:147], a[104:107], a[160:163], v[144:147]
    s_add_u32 m0, s4, 53248
    ds_read_b64_tr_b16 a[122:123], v228 offset:9216
    v_mfma_f32_16x16x32_bf16 v[148:151], a[108:111], a[144:147], v[148:151]
    buffer_load_dwordx4 v196, s[24:27], s75 offen lds
    v_mfma_f32_16x16x32_bf16 v[152:155], a[108:111], a[148:151], v[152:155]
    ds_read_b64_tr_b16 a[126:127], v229 offset:9216
    v_mfma_f32_16x16x32_bf16 v[156:159], a[108:111], a[152:155], v[156:159]
    ds_read_b64_tr_b16 a[130:131], v230 offset:9216
    v_mfma_f32_16x16x32_bf16 v[160:163], a[108:111], a[156:159], v[160:163]
    ds_read_b64_tr_b16 a[134:135], v231 offset:9216
    v_mfma_f32_16x16x32_bf16 v[164:167], a[108:111], a[160:163], v[164:167]
    ds_read_b64_tr_b16 a[138:139], v232 offset:9216
    ds_read_b64_tr_b16 a[142:143], v233 offset:9216
    s_waitcnt lgkmcnt(5)
    v_mfma_f32_16x16x32_bf16 v[8:11], a[112:115], a[164:167], v[8:11]
    s_mov_b32 m0, s64
    v_mfma_f32_16x16x32_bf16 v[12:15], a[112:115], a[168:171], v[12:15]
    buffer_load_dwordx4 v168, s[16:19], s79 offen offset:0 lds
    v_mfma_f32_16x16x32_bf16 v[16:19], a[112:115], a[172:175], v[16:19]
    v_mfma_f32_16x16x32_bf16 v[20:23], a[112:115], a[176:179], v[20:23]
    v_mfma_f32_16x16x32_bf16 v[24:27], a[112:115], a[180:183], v[24:27]
    v_mfma_f32_16x16x32_bf16 v[28:31], a[116:119], a[164:167], v[28:31]
    buffer_load_dwordx4 v170, s[16:19], s79 offen offset:2048 lds
    v_mfma_f32_16x16x32_bf16 v[32:35], a[116:119], a[168:171], v[32:35]
    v_mfma_f32_16x16x32_bf16 v[36:39], a[116:119], a[172:175], v[36:39]
    v_mfma_f32_16x16x32_bf16 v[40:43], a[116:119], a[176:179], v[40:43]
    s_mov_b32 m0, s65
    v_mfma_f32_16x16x32_bf16 v[44:47], a[116:119], a[180:183], v[44:47]
    buffer_load_dwordx4 v172, s[16:19], s79 offen offset:0 lds
    v_mfma_f32_16x16x32_bf16 v[48:51], a[120:123], a[164:167], v[48:51]
    s_waitcnt lgkmcnt(0)
    v_mfma_f32_16x16x32_bf16 v[52:55], a[120:123], a[168:171], v[52:55]
    v_mfma_f32_16x16x32_bf16 v[56:59], a[120:123], a[172:175], v[56:59]
    v_mfma_f32_16x16x32_bf16 v[60:63], a[120:123], a[176:179], v[60:63]
    buffer_load_dwordx4 v174, s[16:19], s79 offen offset:2048 lds
    v_mfma_f32_16x16x32_bf16 v[64:67], a[120:123], a[180:183], v[64:67]
    ds_read_b128 a[144:147], v194 offset:20480
    v_mfma_f32_16x16x32_bf16 v[68:71], a[124:127], a[164:167], v[68:71]
    ds_read_b128 a[148:151], v194 offset:24576
    v_mfma_f32_16x16x32_bf16 v[72:75], a[124:127], a[168:171], v[72:75]
    s_mov_b32 m0, s64
    ds_read_b128 a[152:155], v194 offset:28672
    v_mfma_f32_16x16x32_bf16 v[76:79], a[124:127], a[172:175], v[76:79]
    buffer_load_dwordx4 v169, s[16:19], s79 offen offset:1024 lds
    v_mfma_f32_16x16x32_bf16 v[80:83], a[124:127], a[176:179], v[80:83]
    ds_read_b128 a[156:159], v194 offset:32768
    v_mfma_f32_16x16x32_bf16 v[84:87], a[124:127], a[180:183], v[84:87]
    ds_read_b128 a[160:163], v194 offset:36864
    v_mfma_f32_16x16x32_bf16 v[88:91], a[128:131], a[164:167], v[88:91]
    s_waitcnt vmcnt(11)
    ds_read_b64_tr_b16 a[80:81], v226 offset:0
    v_mfma_f32_16x16x32_bf16 v[92:95], a[128:131], a[168:171], v[92:95]
    buffer_load_dwordx4 v171, s[16:19], s79 offen offset:3072 lds
    v_mfma_f32_16x16x32_bf16 v[96:99], a[128:131], a[172:175], v[96:99]
    ds_read_b64_tr_b16 a[84:85], v227 offset:0
    v_mfma_f32_16x16x32_bf16 v[100:103], a[128:131], a[176:179], v[100:103]
    ds_read_b64_tr_b16 a[88:89], v228 offset:0
    v_mfma_f32_16x16x32_bf16 v[104:107], a[128:131], a[180:183], v[104:107]
    s_mov_b32 m0, s65
    ds_read_b64_tr_b16 a[92:93], v229 offset:0
    v_mfma_f32_16x16x32_bf16 v[108:111], a[132:135], a[164:167], v[108:111]
    buffer_load_dwordx4 v173, s[16:19], s79 offen offset:1024 lds
    v_mfma_f32_16x16x32_bf16 v[112:115], a[132:135], a[168:171], v[112:115]
    ds_read_b64_tr_b16 a[96:97], v230 offset:0
    v_mfma_f32_16x16x32_bf16 v[116:119], a[132:135], a[172:175], v[116:119]
    ds_read_b64_tr_b16 a[100:101], v231 offset:0
    v_mfma_f32_16x16x32_bf16 v[120:123], a[132:135], a[176:179], v[120:123]
    ds_read_b64_tr_b16 a[104:105], v232 offset:0
    v_mfma_f32_16x16x32_bf16 v[124:127], a[132:135], a[180:183], v[124:127]
    buffer_load_dwordx4 v175, s[16:19], s79 offen offset:3072 lds
    v_mfma_f32_16x16x32_bf16 v[128:131], a[136:139], a[164:167], v[128:131]
    s_add_u32 s79, s79, 262144
    s_add_u32 s75, s5, 66048
    ds_read_b64_tr_b16 a[108:109], v233 offset:0
    v_mfma_f32_16x16x32_bf16 v[132:135], a[136:139], a[168:171], v[132:135]
    s_add_u32 m0, s4, 57344
    s_waitcnt vmcnt(10)
    ds_read_b64_tr_b16 a[82:83], v226 offset:1024
    v_mfma_f32_16x16x32_bf16 v[136:139], a[136:139], a[172:175], v[136:139]
    buffer_load_dwordx4 v196, s[24:27], s75 offen lds
    v_mfma_f32_16x16x32_bf16 v[140:143], a[136:139], a[176:179], v[140:143]
    ds_read_b64_tr_b16 a[86:87], v227 offset:1024
    v_mfma_f32_16x16x32_bf16 v[144:147], a[136:139], a[180:183], v[144:147]
    ds_read_b64_tr_b16 a[90:91], v228 offset:1024
    v_mfma_f32_16x16x32_bf16 v[148:151], a[140:143], a[164:167], v[148:151]
    ds_read_b64_tr_b16 a[94:95], v229 offset:1024
    v_mfma_f32_16x16x32_bf16 v[152:155], a[140:143], a[168:171], v[152:155]
    ds_read_b64_tr_b16 a[98:99], v230 offset:1024
    v_mfma_f32_16x16x32_bf16 v[156:159], a[140:143], a[172:175], v[156:159]
    ds_read_b64_tr_b16 a[102:103], v231 offset:1024
    v_mfma_f32_16x16x32_bf16 v[160:163], a[140:143], a[176:179], v[160:163]
    ds_read_b64_tr_b16 a[106:107], v232 offset:1024
    v_mfma_f32_16x16x32_bf16 v[164:167], a[140:143], a[180:183], v[164:167]
    ds_read_b64_tr_b16 a[110:111], v233 offset:1024
    s_waitcnt lgkmcnt(5)
    v_mfma_f32_16x16x32_bf16 v[8:11], a[80:83], a[144:147], v[8:11]
    s_mov_b32 m0, s62
    v_mfma_f32_16x16x32_bf16 v[12:15], a[80:83], a[148:151], v[12:15]
    buffer_load_dwordx4 v168, s[16:19], s79 offen offset:0 lds
    v_mfma_f32_16x16x32_bf16 v[16:19], a[80:83], a[152:155], v[16:19]
    v_mfma_f32_16x16x32_bf16 v[20:23], a[80:83], a[156:159], v[20:23]
    v_mfma_f32_16x16x32_bf16 v[24:27], a[80:83], a[160:163], v[24:27]
    v_mfma_f32_16x16x32_bf16 v[28:31], a[84:87], a[144:147], v[28:31]
    buffer_load_dwordx4 v170, s[16:19], s79 offen offset:2048 lds
    v_mfma_f32_16x16x32_bf16 v[32:35], a[84:87], a[148:151], v[32:35]
    v_mfma_f32_16x16x32_bf16 v[36:39], a[84:87], a[152:155], v[36:39]
    v_mfma_f32_16x16x32_bf16 v[40:43], a[84:87], a[156:159], v[40:43]
    s_mov_b32 m0, s63
    v_mfma_f32_16x16x32_bf16 v[44:47], a[84:87], a[160:163], v[44:47]
    buffer_load_dwordx4 v172, s[16:19], s79 offen offset:0 lds
    v_mfma_f32_16x16x32_bf16 v[48:51], a[88:91], a[144:147], v[48:51]
    s_waitcnt lgkmcnt(0)
    v_mfma_f32_16x16x32_bf16 v[52:55], a[88:91], a[148:151], v[52:55]
    v_mfma_f32_16x16x32_bf16 v[56:59], a[88:91], a[152:155], v[56:59]
    v_mfma_f32_16x16x32_bf16 v[60:63], a[88:91], a[156:159], v[60:63]
    buffer_load_dwordx4 v174, s[16:19], s79 offen offset:2048 lds
    v_mfma_f32_16x16x32_bf16 v[64:67], a[88:91], a[160:163], v[64:67]
    ds_read_b128 a[164:167], v195 offset:20480
    v_mfma_f32_16x16x32_bf16 v[68:71], a[92:95], a[144:147], v[68:71]
    ds_read_b128 a[168:171], v195 offset:24576
    v_mfma_f32_16x16x32_bf16 v[72:75], a[92:95], a[148:151], v[72:75]
    s_mov_b32 m0, s62
    ds_read_b128 a[172:175], v195 offset:28672
    v_mfma_f32_16x16x32_bf16 v[76:79], a[92:95], a[152:155], v[76:79]
    buffer_load_dwordx4 v169, s[16:19], s79 offen offset:1024 lds
    v_mfma_f32_16x16x32_bf16 v[80:83], a[92:95], a[156:159], v[80:83]
    ds_read_b128 a[176:179], v195 offset:32768
    v_mfma_f32_16x16x32_bf16 v[84:87], a[92:95], a[160:163], v[84:87]
    ds_read_b128 a[180:183], v195 offset:36864
    v_mfma_f32_16x16x32_bf16 v[88:91], a[96:99], a[144:147], v[88:91]
    s_waitcnt vmcnt(10)
    ds_read_b64_tr_b16 a[112:113], v226 offset:8192
    v_mfma_f32_16x16x32_bf16 v[92:95], a[96:99], a[148:151], v[92:95]
    buffer_load_dwordx4 v171, s[16:19], s79 offen offset:3072 lds
    v_mfma_f32_16x16x32_bf16 v[96:99], a[96:99], a[152:155], v[96:99]
    ds_read_b64_tr_b16 a[116:117], v227 offset:8192
    v_mfma_f32_16x16x32_bf16 v[100:103], a[96:99], a[156:159], v[100:103]
    ds_read_b64_tr_b16 a[120:121], v228 offset:8192
    v_mfma_f32_16x16x32_bf16 v[104:107], a[96:99], a[160:163], v[104:107]
    s_mov_b32 m0, s63
    ds_read_b64_tr_b16 a[124:125], v229 offset:8192
    v_mfma_f32_16x16x32_bf16 v[108:111], a[100:103], a[144:147], v[108:111]
    buffer_load_dwordx4 v173, s[16:19], s79 offen offset:1024 lds
    v_mfma_f32_16x16x32_bf16 v[112:115], a[100:103], a[148:151], v[112:115]
    ds_read_b64_tr_b16 a[128:129], v230 offset:8192
    v_mfma_f32_16x16x32_bf16 v[116:119], a[100:103], a[152:155], v[116:119]
    ds_read_b64_tr_b16 a[132:133], v231 offset:8192
    v_mfma_f32_16x16x32_bf16 v[120:123], a[100:103], a[156:159], v[120:123]
    ds_read_b64_tr_b16 a[136:137], v232 offset:8192
    v_mfma_f32_16x16x32_bf16 v[124:127], a[100:103], a[160:163], v[124:127]
    buffer_load_dwordx4 v175, s[16:19], s79 offen offset:3072 lds
    v_mfma_f32_16x16x32_bf16 v[128:131], a[104:107], a[144:147], v[128:131]
    s_add_u32 s79, s79, 262144
    ds_read_b64_tr_b16 a[140:141], v233 offset:8192
    v_mfma_f32_16x16x32_bf16 v[132:135], a[104:107], a[148:151], v[132:135]
    s_waitcnt vmcnt(9)
    ds_read_b64_tr_b16 a[114:115], v226 offset:9216
    v_mfma_f32_16x16x32_bf16 v[136:139], a[104:107], a[152:155], v[136:139]
    ds_read_b64_tr_b16 a[118:119], v227 offset:9216
    v_mfma_f32_16x16x32_bf16 v[140:143], a[104:107], a[156:159], v[140:143]
    ds_read_b64_tr_b16 a[122:123], v228 offset:9216
    v_mfma_f32_16x16x32_bf16 v[144:147], a[104:107], a[160:163], v[144:147]
    ds_read_b64_tr_b16 a[126:127], v229 offset:9216
    v_mfma_f32_16x16x32_bf16 v[148:151], a[108:111], a[144:147], v[148:151]
    ds_read_b64_tr_b16 a[130:131], v230 offset:9216
    v_mfma_f32_16x16x32_bf16 v[152:155], a[108:111], a[148:151], v[152:155]
    ds_read_b64_tr_b16 a[134:135], v231 offset:9216
    v_mfma_f32_16x16x32_bf16 v[156:159], a[108:111], a[152:155], v[156:159]
    ds_read_b64_tr_b16 a[138:139], v232 offset:9216
    v_mfma_f32_16x16x32_bf16 v[160:163], a[108:111], a[156:159], v[160:163]
    ds_read_b64_tr_b16 a[142:143], v233 offset:9216
    v_mfma_f32_16x16x32_bf16 v[164:167], a[108:111], a[160:163], v[164:167]
    s_waitcnt lgkmcnt(5)
    v_mfma_f32_16x16x32_bf16 v[8:11], a[112:115], a[164:167], v[8:11]
    s_mov_b32 m0, s64
    v_mfma_f32_16x16x32_bf16 v[12:15], a[112:115], a[168:171], v[12:15]
    buffer_load_dwordx4 v168, s[16:19], s79 offen offset:0 lds
    v_mfma_f32_16x16x32_bf16 v[16:19], a[112:115], a[172:175], v[16:19]
    v_mfma_f32_16x16x32_bf16 v[20:23], a[112:115], a[176:179], v[20:23]
    v_mfma_f32_16x16x32_bf16 v[24:27], a[112:115], a[180:183], v[24:27]
    v_mfma_f32_16x16x32_bf16 v[28:31], a[116:119], a[164:167], v[28:31]
    buffer_load_dwordx4 v170, s[16:19], s79 offen offset:2048 lds
    v_mfma_f32_16x16x32_bf16 v[32:35], a[116:119], a[168:171], v[32:35]
    v_mfma_f32_16x16x32_bf16 v[36:39], a[116:119], a[172:175], v[36:39]
    v_mfma_f32_16x16x32_bf16 v[40:43], a[116:119], a[176:179], v[40:43]
    s_mov_b32 m0, s65
    v_mfma_f32_16x16x32_bf16 v[44:47], a[116:119], a[180:183], v[44:47]
    buffer_load_dwordx4 v172, s[16:19], s79 offen offset:0 lds
    v_mfma_f32_16x16x32_bf16 v[48:51], a[120:123], a[164:167], v[48:51]
    s_waitcnt lgkmcnt(0)
    v_add_u32 v192, 40960, v192
    v_add_u32 v193, 40960, v193
    v_mfma_f32_16x16x32_bf16 v[52:55], a[120:123], a[168:171], v[52:55]
    s_waitcnt vmcnt(11)
    v_mfma_f32_16x16x32_bf16 v[56:59], a[120:123], a[172:175], v[56:59]
    s_barrier
    v_add_u32 v194, 40960, v194
    v_add_u32 v195, 40960, v195
    v_mfma_f32_16x16x32_bf16 v[60:63], a[120:123], a[176:179], v[60:63]
    buffer_load_dwordx4 v174, s[16:19], s79 offen offset:2048 lds
    v_mfma_f32_16x16x32_bf16 v[64:67], a[120:123], a[180:183], v[64:67]
    ds_read_b128 a[144:147], v192 offset:0
    v_mfma_f32_16x16x32_bf16 v[68:71], a[124:127], a[164:167], v[68:71]
    ds_read_b128 a[148:151], v192 offset:4096
    v_mfma_f32_16x16x32_bf16 v[72:75], a[124:127], a[168:171], v[72:75]
    s_mov_b32 m0, s64
    ds_read_b128 a[152:155], v192 offset:8192
    v_mfma_f32_16x16x32_bf16 v[76:79], a[124:127], a[172:175], v[76:79]
    buffer_load_dwordx4 v169, s[16:19], s79 offen offset:1024 lds
    v_mfma_f32_16x16x32_bf16 v[80:83], a[124:127], a[176:179], v[80:83]
    ds_read_b128 a[156:159], v192 offset:12288
    v_mfma_f32_16x16x32_bf16 v[84:87], a[124:127], a[180:183], v[84:87]
    ds_read_b128 a[160:163], v192 offset:16384
    v_mfma_f32_16x16x32_bf16 v[88:91], a[128:131], a[164:167], v[88:91]
    s_waitcnt vmcnt(9)
    ds_read_b64_tr_b16 a[80:81], v226 offset:0
    v_mfma_f32_16x16x32_bf16 v[92:95], a[128:131], a[168:171], v[92:95]
    buffer_load_dwordx4 v171, s[16:19], s79 offen offset:3072 lds
    v_mfma_f32_16x16x32_bf16 v[96:99], a[128:131], a[172:175], v[96:99]
    ds_read_b64_tr_b16 a[84:85], v227 offset:0
    v_mfma_f32_16x16x32_bf16 v[100:103], a[128:131], a[176:179], v[100:103]
    ds_read_b64_tr_b16 a[88:89], v228 offset:0
    v_mfma_f32_16x16x32_bf16 v[104:107], a[128:131], a[180:183], v[104:107]
    s_mov_b32 m0, s65
    ds_read_b64_tr_b16 a[92:93], v229 offset:0
    v_mfma_f32_16x16x32_bf16 v[108:111], a[132:135], a[164:167], v[108:111]
    buffer_load_dwordx4 v173, s[16:19], s79 offen offset:1024 lds
    v_mfma_f32_16x16x32_bf16 v[112:115], a[132:135], a[168:171], v[112:115]
    ds_read_b64_tr_b16 a[96:97], v230 offset:0
    v_mfma_f32_16x16x32_bf16 v[116:119], a[132:135], a[172:175], v[116:119]
    ds_read_b64_tr_b16 a[100:101], v231 offset:0
    v_mfma_f32_16x16x32_bf16 v[120:123], a[132:135], a[176:179], v[120:123]
    ds_read_b64_tr_b16 a[104:105], v232 offset:0
    v_mfma_f32_16x16x32_bf16 v[124:127], a[132:135], a[180:183], v[124:127]
    buffer_load_dwordx4 v175, s[16:19], s79 offen offset:3072 lds
    v_mfma_f32_16x16x32_bf16 v[128:131], a[136:139], a[164:167], v[128:131]
    s_add_u32 s79, s79, 262144
    s_add_u32 s75, s5, 768
    ds_read_b64_tr_b16 a[108:109], v233 offset:0
    v_mfma_f32_16x16x32_bf16 v[132:135], a[136:139], a[168:171], v[132:135]
    s_add_u32 m0, s4, 61440
    s_waitcnt vmcnt(8)
    ds_read_b64_tr_b16 a[82:83], v226 offset:1024
    v_mfma_f32_16x16x32_bf16 v[136:139], a[136:139], a[172:175], v[136:139]
    buffer_load_dwordx4 v196, s[24:27], s75 offen lds
    v_mfma_f32_16x16x32_bf16 v[140:143], a[136:139], a[176:179], v[140:143]
    s_add_u32 s75, s5, 17152
    ds_read_b64_tr_b16 a[86:87], v227 offset:1024
    v_mfma_f32_16x16x32_bf16 v[144:147], a[136:139], a[180:183], v[144:147]
    s_add_u32 m0, s4, 65536
    ds_read_b64_tr_b16 a[90:91], v228 offset:1024
    v_mfma_f32_16x16x32_bf16 v[148:151], a[140:143], a[164:167], v[148:151]
    buffer_load_dwordx4 v196, s[24:27], s75 offen lds
    v_mfma_f32_16x16x32_bf16 v[152:155], a[140:143], a[168:171], v[152:155]
    ds_read_b64_tr_b16 a[94:95], v229 offset:1024
    v_mfma_f32_16x16x32_bf16 v[156:159], a[140:143], a[172:175], v[156:159]
    ds_read_b64_tr_b16 a[98:99], v230 offset:1024
    v_mfma_f32_16x16x32_bf16 v[160:163], a[140:143], a[176:179], v[160:163]
    ds_read_b64_tr_b16 a[102:103], v231 offset:1024
    v_mfma_f32_16x16x32_bf16 v[164:167], a[140:143], a[180:183], v[164:167]
    ds_read_b64_tr_b16 a[106:107], v232 offset:1024
    ds_read_b64_tr_b16 a[110:111], v233 offset:1024
    s_waitcnt lgkmcnt(5)
    v_mfma_f32_16x16x32_bf16 v[8:11], a[80:83], a[144:147], v[8:11]
    s_mov_b32 m0, s62
    v_mfma_f32_16x16x32_bf16 v[12:15], a[80:83], a[148:151], v[12:15]
    buffer_load_dwordx4 v168, s[16:19], s79 offen offset:0 lds
    v_mfma_f32_16x16x32_bf16 v[16:19], a[80:83], a[152:155], v[16:19]
    v_mfma_f32_16x16x32_bf16 v[20:23], a[80:83], a[156:159], v[20:23]
    v_mfma_f32_16x16x32_bf16 v[24:27], a[80:83], a[160:163], v[24:27]
    v_mfma_f32_16x16x32_bf16 v[28:31], a[84:87], a[144:147], v[28:31]
    buffer_load_dwordx4 v170, s[16:19], s79 offen offset:2048 lds
    v_mfma_f32_16x16x32_bf16 v[32:35], a[84:87], a[148:151], v[32:35]
    v_mfma_f32_16x16x32_bf16 v[36:39], a[84:87], a[152:155], v[36:39]
    v_mfma_f32_16x16x32_bf16 v[40:43], a[84:87], a[156:159], v[40:43]
    s_mov_b32 m0, s63
    v_mfma_f32_16x16x32_bf16 v[44:47], a[84:87], a[160:163], v[44:47]
    buffer_load_dwordx4 v172, s[16:19], s79 offen offset:0 lds
    v_mfma_f32_16x16x32_bf16 v[48:51], a[88:91], a[144:147], v[48:51]
    s_waitcnt lgkmcnt(0)
    v_mfma_f32_16x16x32_bf16 v[52:55], a[88:91], a[148:151], v[52:55]
    v_mfma_f32_16x16x32_bf16 v[56:59], a[88:91], a[152:155], v[56:59]
    v_mfma_f32_16x16x32_bf16 v[60:63], a[88:91], a[156:159], v[60:63]
    buffer_load_dwordx4 v174, s[16:19], s79 offen offset:2048 lds
    v_mfma_f32_16x16x32_bf16 v[64:67], a[88:91], a[160:163], v[64:67]
    ds_read_b128 a[164:167], v193 offset:0
    v_mfma_f32_16x16x32_bf16 v[68:71], a[92:95], a[144:147], v[68:71]
    ds_read_b128 a[168:171], v193 offset:4096
    v_mfma_f32_16x16x32_bf16 v[72:75], a[92:95], a[148:151], v[72:75]
    s_mov_b32 m0, s62
    ds_read_b128 a[172:175], v193 offset:8192
    v_mfma_f32_16x16x32_bf16 v[76:79], a[92:95], a[152:155], v[76:79]
    buffer_load_dwordx4 v169, s[16:19], s79 offen offset:1024 lds
    v_mfma_f32_16x16x32_bf16 v[80:83], a[92:95], a[156:159], v[80:83]
    ds_read_b128 a[176:179], v193 offset:12288
    v_mfma_f32_16x16x32_bf16 v[84:87], a[92:95], a[160:163], v[84:87]
    ds_read_b128 a[180:183], v193 offset:16384
    v_mfma_f32_16x16x32_bf16 v[88:91], a[96:99], a[144:147], v[88:91]
    s_waitcnt vmcnt(11)
    ds_read_b64_tr_b16 a[112:113], v226 offset:8192
    v_mfma_f32_16x16x32_bf16 v[92:95], a[96:99], a[148:151], v[92:95]
    buffer_load_dwordx4 v171, s[16:19], s79 offen offset:3072 lds
    v_mfma_f32_16x16x32_bf16 v[96:99], a[96:99], a[152:155], v[96:99]
    ds_read_b64_tr_b16 a[116:117], v227 offset:8192
    v_mfma_f32_16x16x32_bf16 v[100:103], a[96:99], a[156:159], v[100:103]
    ds_read_b64_tr_b16 a[120:121], v228 offset:8192
    v_mfma_f32_16x16x32_bf16 v[104:107], a[96:99], a[160:163], v[104:107]
    s_mov_b32 m0, s63
    ds_read_b64_tr_b16 a[124:125], v229 offset:8192
    v_mfma_f32_16x16x32_bf16 v[108:111], a[100:103], a[144:147], v[108:111]
    buffer_load_dwordx4 v173, s[16:19], s79 offen offset:1024 lds
    v_mfma_f32_16x16x32_bf16 v[112:115], a[100:103], a[148:151], v[112:115]
    ds_read_b64_tr_b16 a[128:129], v230 offset:8192
    v_mfma_f32_16x16x32_bf16 v[116:119], a[100:103], a[152:155], v[116:119]
    ds_read_b64_tr_b16 a[132:133], v231 offset:8192
    v_mfma_f32_16x16x32_bf16 v[120:123], a[100:103], a[156:159], v[120:123]
    ds_read_b64_tr_b16 a[136:137], v232 offset:8192
    v_mfma_f32_16x16x32_bf16 v[124:127], a[100:103], a[160:163], v[124:127]
    buffer_load_dwordx4 v175, s[16:19], s79 offen offset:3072 lds
    v_mfma_f32_16x16x32_bf16 v[128:131], a[104:107], a[144:147], v[128:131]
    s_add_u32 s79, s79, 262144
    s_add_u32 s75, s5, 33536
    ds_read_b64_tr_b16 a[140:141], v233 offset:8192
    v_mfma_f32_16x16x32_bf16 v[132:135], a[104:107], a[148:151], v[132:135]
    s_add_u32 m0, s4, 69632
    s_waitcnt vmcnt(10)
    ds_read_b64_tr_b16 a[114:115], v226 offset:9216
    v_mfma_f32_16x16x32_bf16 v[136:139], a[104:107], a[152:155], v[136:139]
    buffer_load_dwordx4 v196, s[24:27], s75 offen lds
    v_mfma_f32_16x16x32_bf16 v[140:143], a[104:107], a[156:159], v[140:143]
    s_add_u32 s75, s5, 49920
    ds_read_b64_tr_b16 a[118:119], v227 offset:9216
    v_mfma_f32_16x16x32_bf16 v[144:147], a[104:107], a[160:163], v[144:147]
    s_add_u32 m0, s4, 73728
    ds_read_b64_tr_b16 a[122:123], v228 offset:9216
    v_mfma_f32_16x16x32_bf16 v[148:151], a[108:111], a[144:147], v[148:151]
    buffer_load_dwordx4 v196, s[24:27], s75 offen lds
    v_mfma_f32_16x16x32_bf16 v[152:155], a[108:111], a[148:151], v[152:155]
    ds_read_b64_tr_b16 a[126:127], v229 offset:9216
    v_mfma_f32_16x16x32_bf16 v[156:159], a[108:111], a[152:155], v[156:159]
    ds_read_b64_tr_b16 a[130:131], v230 offset:9216
    v_mfma_f32_16x16x32_bf16 v[160:163], a[108:111], a[156:159], v[160:163]
    ds_read_b64_tr_b16 a[134:135], v231 offset:9216
    v_mfma_f32_16x16x32_bf16 v[164:167], a[108:111], a[160:163], v[164:167]
    ds_read_b64_tr_b16 a[138:139], v232 offset:9216
    ds_read_b64_tr_b16 a[142:143], v233 offset:9216
    s_waitcnt lgkmcnt(5)
    v_mfma_f32_16x16x32_bf16 v[8:11], a[112:115], a[164:167], v[8:11]
    s_mov_b32 m0, s64
    v_mfma_f32_16x16x32_bf16 v[12:15], a[112:115], a[168:171], v[12:15]
    buffer_load_dwordx4 v168, s[16:19], s79 offen offset:0 lds
    v_mfma_f32_16x16x32_bf16 v[16:19], a[112:115], a[172:175], v[16:19]
    v_mfma_f32_16x16x32_bf16 v[20:23], a[112:115], a[176:179], v[20:23]
    v_mfma_f32_16x16x32_bf16 v[24:27], a[112:115], a[180:183], v[24:27]
    v_mfma_f32_16x16x32_bf16 v[28:31], a[116:119], a[164:167], v[28:31]
    buffer_load_dwordx4 v170, s[16:19], s79 offen offset:2048 lds
    v_mfma_f32_16x16x32_bf16 v[32:35], a[116:119], a[168:171], v[32:35]
    v_mfma_f32_16x16x32_bf16 v[36:39], a[116:119], a[172:175], v[36:39]
    v_mfma_f32_16x16x32_bf16 v[40:43], a[116:119], a[176:179], v[40:43]
    s_mov_b32 m0, s65
    v_mfma_f32_16x16x32_bf16 v[44:47], a[116:119], a[180:183], v[44:47]
    buffer_load_dwordx4 v172, s[16:19], s79 offen offset:0 lds
    v_mfma_f32_16x16x32_bf16 v[48:51], a[120:123], a[164:167], v[48:51]
    s_waitcnt lgkmcnt(0)
    v_mfma_f32_16x16x32_bf16 v[52:55], a[120:123], a[168:171], v[52:55]
    v_mfma_f32_16x16x32_bf16 v[56:59], a[120:123], a[172:175], v[56:59]
    v_mfma_f32_16x16x32_bf16 v[60:63], a[120:123], a[176:179], v[60:63]
    buffer_load_dwordx4 v174, s[16:19], s79 offen offset:2048 lds
    v_mfma_f32_16x16x32_bf16 v[64:67], a[120:123], a[180:183], v[64:67]
    ds_read_b128 a[144:147], v194 offset:0
    v_mfma_f32_16x16x32_bf16 v[68:71], a[124:127], a[164:167], v[68:71]
    ds_read_b128 a[148:151], v194 offset:4096
    v_mfma_f32_16x16x32_bf16 v[72:75], a[124:127], a[168:171], v[72:75]
    s_mov_b32 m0, s64
    ds_read_b128 a[152:155], v194 offset:8192
    v_mfma_f32_16x16x32_bf16 v[76:79], a[124:127], a[172:175], v[76:79]
    buffer_load_dwordx4 v169, s[16:19], s79 offen offset:1024 lds
    v_mfma_f32_16x16x32_bf16 v[80:83], a[124:127], a[176:179], v[80:83]
    ds_read_b128 a[156:159], v194 offset:12288
    v_mfma_f32_16x16x32_bf16 v[84:87], a[124:127], a[180:183], v[84:87]
    ds_read_b128 a[160:163], v194 offset:16384
    v_mfma_f32_16x16x32_bf16 v[88:91], a[128:131], a[164:167], v[88:91]
    s_waitcnt vmcnt(11)
    ds_read_b64_tr_b16 a[80:81], v226 offset:0
    v_mfma_f32_16x16x32_bf16 v[92:95], a[128:131], a[168:171], v[92:95]
    buffer_load_dwordx4 v171, s[16:19], s79 offen offset:3072 lds
    v_mfma_f32_16x16x32_bf16 v[96:99], a[128:131], a[172:175], v[96:99]
    ds_read_b64_tr_b16 a[84:85], v227 offset:0
    v_mfma_f32_16x16x32_bf16 v[100:103], a[128:131], a[176:179], v[100:103]
    ds_read_b64_tr_b16 a[88:89], v228 offset:0
    v_mfma_f32_16x16x32_bf16 v[104:107], a[128:131], a[180:183], v[104:107]
    s_mov_b32 m0, s65
    ds_read_b64_tr_b16 a[92:93], v229 offset:0
    v_mfma_f32_16x16x32_bf16 v[108:111], a[132:135], a[164:167], v[108:111]
    buffer_load_dwordx4 v173, s[16:19], s79 offen offset:1024 lds
    v_mfma_f32_16x16x32_bf16 v[112:115], a[132:135], a[168:171], v[112:115]
    ds_read_b64_tr_b16 a[96:97], v230 offset:0
    v_mfma_f32_16x16x32_bf16 v[116:119], a[132:135], a[172:175], v[116:119]
    ds_read_b64_tr_b16 a[100:101], v231 offset:0
    v_mfma_f32_16x16x32_bf16 v[120:123], a[132:135], a[176:179], v[120:123]
    ds_read_b64_tr_b16 a[104:105], v232 offset:0
    v_mfma_f32_16x16x32_bf16 v[124:127], a[132:135], a[180:183], v[124:127]
    buffer_load_dwordx4 v175, s[16:19], s79 offen offset:3072 lds
    v_mfma_f32_16x16x32_bf16 v[128:131], a[136:139], a[164:167], v[128:131]
    s_add_u32 s79, s79, 262144
    s_add_u32 s75, s5, 66304
    ds_read_b64_tr_b16 a[108:109], v233 offset:0
    v_mfma_f32_16x16x32_bf16 v[132:135], a[136:139], a[168:171], v[132:135]
    s_add_u32 m0, s4, 77824
    s_waitcnt vmcnt(10)
    ds_read_b64_tr_b16 a[82:83], v226 offset:1024
    v_mfma_f32_16x16x32_bf16 v[136:139], a[136:139], a[172:175], v[136:139]
    buffer_load_dwordx4 v196, s[24:27], s75 offen lds
    v_mfma_f32_16x16x32_bf16 v[140:143], a[136:139], a[176:179], v[140:143]
    ds_read_b64_tr_b16 a[86:87], v227 offset:1024
    v_mfma_f32_16x16x32_bf16 v[144:147], a[136:139], a[180:183], v[144:147]
    ds_read_b64_tr_b16 a[90:91], v228 offset:1024
    v_mfma_f32_16x16x32_bf16 v[148:151], a[140:143], a[164:167], v[148:151]
    ds_read_b64_tr_b16 a[94:95], v229 offset:1024
    v_mfma_f32_16x16x32_bf16 v[152:155], a[140:143], a[168:171], v[152:155]
    ds_read_b64_tr_b16 a[98:99], v230 offset:1024
    v_mfma_f32_16x16x32_bf16 v[156:159], a[140:143], a[172:175], v[156:159]
    ds_read_b64_tr_b16 a[102:103], v231 offset:1024
    v_mfma_f32_16x16x32_bf16 v[160:163], a[140:143], a[176:179], v[160:163]
    ds_read_b64_tr_b16 a[106:107], v232 offset:1024
    v_mfma_f32_16x16x32_bf16 v[164:167], a[140:143], a[180:183], v[164:167]
    ds_read_b64_tr_b16 a[110:111], v233 offset:1024
    s_waitcnt lgkmcnt(5)
    v_mfma_f32_16x16x32_bf16 v[8:11], a[80:83], a[144:147], v[8:11]
    s_mov_b32 m0, s62
    v_mfma_f32_16x16x32_bf16 v[12:15], a[80:83], a[148:151], v[12:15]
    buffer_load_dwordx4 v168, s[16:19], s79 offen offset:0 lds
    v_mfma_f32_16x16x32_bf16 v[16:19], a[80:83], a[152:155], v[16:19]
    v_mfma_f32_16x16x32_bf16 v[20:23], a[80:83], a[156:159], v[20:23]
    v_mfma_f32_16x16x32_bf16 v[24:27], a[80:83], a[160:163], v[24:27]
    v_mfma_f32_16x16x32_bf16 v[28:31], a[84:87], a[144:147], v[28:31]
    buffer_load_dwordx4 v170, s[16:19], s79 offen offset:2048 lds
    v_mfma_f32_16x16x32_bf16 v[32:35], a[84:87], a[148:151], v[32:35]
    v_mfma_f32_16x16x32_bf16 v[36:39], a[84:87], a[152:155], v[36:39]
    v_mfma_f32_16x16x32_bf16 v[40:43], a[84:87], a[156:159], v[40:43]
    s_mov_b32 m0, s63
    v_mfma_f32_16x16x32_bf16 v[44:47], a[84:87], a[160:163], v[44:47]
    buffer_load_dwordx4 v172, s[16:19], s79 offen offset:0 lds
    v_mfma_f32_16x16x32_bf16 v[48:51], a[88:91], a[144:147], v[48:51]
    s_waitcnt lgkmcnt(0)
    v_mfma_f32_16x16x32_bf16 v[52:55], a[88:91], a[148:151], v[52:55]
    v_mfma_f32_16x16x32_bf16 v[56:59], a[88:91], a[152:155], v[56:59]
    v_mfma_f32_16x16x32_bf16 v[60:63], a[88:91], a[156:159], v[60:63]
    buffer_load_dwordx4 v174, s[16:19], s79 offen offset:2048 lds
    v_mfma_f32_16x16x32_bf16 v[64:67], a[88:91], a[160:163], v[64:67]
    ds_read_b128 a[164:167], v195 offset:0
    v_mfma_f32_16x16x32_bf16 v[68:71], a[92:95], a[144:147], v[68:71]
    ds_read_b128 a[168:171], v195 offset:4096
    v_mfma_f32_16x16x32_bf16 v[72:75], a[92:95], a[148:151], v[72:75]
    s_mov_b32 m0, s62
    ds_read_b128 a[172:175], v195 offset:8192
    v_mfma_f32_16x16x32_bf16 v[76:79], a[92:95], a[152:155], v[76:79]
    buffer_load_dwordx4 v169, s[16:19], s79 offen offset:1024 lds
    v_mfma_f32_16x16x32_bf16 v[80:83], a[92:95], a[156:159], v[80:83]
    ds_read_b128 a[176:179], v195 offset:12288
    v_mfma_f32_16x16x32_bf16 v[84:87], a[92:95], a[160:163], v[84:87]
    ds_read_b128 a[180:183], v195 offset:16384
    v_mfma_f32_16x16x32_bf16 v[88:91], a[96:99], a[144:147], v[88:91]
    s_waitcnt vmcnt(10)
    ds_read_b64_tr_b16 a[112:113], v226 offset:8192
    v_mfma_f32_16x16x32_bf16 v[92:95], a[96:99], a[148:151], v[92:95]
    buffer_load_dwordx4 v171, s[16:19], s79 offen offset:3072 lds
    v_mfma_f32_16x16x32_bf16 v[96:99], a[96:99], a[152:155], v[96:99]
    ds_read_b64_tr_b16 a[116:117], v227 offset:8192
    v_mfma_f32_16x16x32_bf16 v[100:103], a[96:99], a[156:159], v[100:103]
    ds_read_b64_tr_b16 a[120:121], v228 offset:8192
    v_mfma_f32_16x16x32_bf16 v[104:107], a[96:99], a[160:163], v[104:107]
    s_mov_b32 m0, s63
    ds_read_b64_tr_b16 a[124:125], v229 offset:8192
    v_mfma_f32_16x16x32_bf16 v[108:111], a[100:103], a[144:147], v[108:111]
    buffer_load_dwordx4 v173, s[16:19], s79 offen offset:1024 lds
    v_mfma_f32_16x16x32_bf16 v[112:115], a[100:103], a[148:151], v[112:115]
    ds_read_b64_tr_b16 a[128:129], v230 offset:8192
    v_mfma_f32_16x16x32_bf16 v[116:119], a[100:103], a[152:155], v[116:119]
    ds_read_b64_tr_b16 a[132:133], v231 offset:8192
    v_mfma_f32_16x16x32_bf16 v[120:123], a[100:103], a[156:159], v[120:123]
    ds_read_b64_tr_b16 a[136:137], v232 offset:8192
    v_mfma_f32_16x16x32_bf16 v[124:127], a[100:103], a[160:163], v[124:127]
    buffer_load_dwordx4 v175, s[16:19], s79 offen offset:3072 lds
    v_mfma_f32_16x16x32_bf16 v[128:131], a[104:107], a[144:147], v[128:131]
    s_add_u32 s79, s79, 262144
    ds_read_b64_tr_b16 a[140:141], v233 offset:8192
    v_mfma_f32_16x16x32_bf16 v[132:135], a[104:107], a[148:151], v[132:135]
    s_waitcnt vmcnt(9)
    ds_read_b64_tr_b16 a[114:115], v226 offset:9216
    v_mfma_f32_16x16x32_bf16 v[136:139], a[104:107], a[152:155], v[136:139]
    ds_read_b64_tr_b16 a[118:119], v227 offset:9216
    v_mfma_f32_16x16x32_bf16 v[140:143], a[104:107], a[156:159], v[140:143]
    ds_read_b64_tr_b16 a[122:123], v228 offset:9216
    v_mfma_f32_16x16x32_bf16 v[144:147], a[104:107], a[160:163], v[144:147]
    ds_read_b64_tr_b16 a[126:127], v229 offset:9216
    v_mfma_f32_16x16x32_bf16 v[148:151], a[108:111], a[144:147], v[148:151]
    ds_read_b64_tr_b16 a[130:131], v230 offset:9216
    v_mfma_f32_16x16x32_bf16 v[152:155], a[108:111], a[148:151], v[152:155]
    ds_read_b64_tr_b16 a[134:135], v231 offset:9216
    v_mfma_f32_16x16x32_bf16 v[156:159], a[108:111], a[152:155], v[156:159]
    ds_read_b64_tr_b16 a[138:139], v232 offset:9216
    v_mfma_f32_16x16x32_bf16 v[160:163], a[108:111], a[156:159], v[160:163]
    ds_read_b64_tr_b16 a[142:143], v233 offset:9216
    v_mfma_f32_16x16x32_bf16 v[164:167], a[108:111], a[160:163], v[164:167]
    s_waitcnt lgkmcnt(5)
    v_mfma_f32_16x16x32_bf16 v[8:11], a[112:115], a[164:167], v[8:11]
    s_mov_b32 m0, s64
    v_mfma_f32_16x16x32_bf16 v[12:15], a[112:115], a[168:171], v[12:15]
    buffer_load_dwordx4 v168, s[16:19], s79 offen offset:0 lds
    v_mfma_f32_16x16x32_bf16 v[16:19], a[112:115], a[172:175], v[16:19]
    v_mfma_f32_16x16x32_bf16 v[20:23], a[112:115], a[176:179], v[20:23]
    v_mfma_f32_16x16x32_bf16 v[24:27], a[112:115], a[180:183], v[24:27]
    v_mfma_f32_16x16x32_bf16 v[28:31], a[116:119], a[164:167], v[28:31]
    buffer_load_dwordx4 v170, s[16:19], s79 offen offset:2048 lds
    v_mfma_f32_16x16x32_bf16 v[32:35], a[116:119], a[168:171], v[32:35]
    v_mfma_f32_16x16x32_bf16 v[36:39], a[116:119], a[172:175], v[36:39]
    v_mfma_f32_16x16x32_bf16 v[40:43], a[116:119], a[176:179], v[40:43]
    s_mov_b32 m0, s65
    v_mfma_f32_16x16x32_bf16 v[44:47], a[116:119], a[180:183], v[44:47]
    buffer_load_dwordx4 v172, s[16:19], s79 offen offset:0 lds
    v_mfma_f32_16x16x32_bf16 v[48:51], a[120:123], a[164:167], v[48:51]
    s_waitcnt lgkmcnt(0)
    v_mfma_f32_16x16x32_bf16 v[52:55], a[120:123], a[168:171], v[52:55]
    s_waitcnt vmcnt(11)
    v_mfma_f32_16x16x32_bf16 v[56:59], a[120:123], a[172:175], v[56:59]
    s_barrier
    v_mfma_f32_16x16x32_bf16 v[60:63], a[120:123], a[176:179], v[60:63]
    buffer_load_dwordx4 v174, s[16:19], s79 offen offset:2048 lds
    v_mfma_f32_16x16x32_bf16 v[64:67], a[120:123], a[180:183], v[64:67]
    ds_read_b128 a[144:147], v192 offset:20480
    v_mfma_f32_16x16x32_bf16 v[68:71], a[124:127], a[164:167], v[68:71]
    ds_read_b128 a[148:151], v192 offset:24576
    v_mfma_f32_16x16x32_bf16 v[72:75], a[124:127], a[168:171], v[72:75]
    s_mov_b32 m0, s64
    ds_read_b128 a[152:155], v192 offset:28672
    v_mfma_f32_16x16x32_bf16 v[76:79], a[124:127], a[172:175], v[76:79]
    buffer_load_dwordx4 v169, s[16:19], s79 offen offset:1024 lds
    v_mfma_f32_16x16x32_bf16 v[80:83], a[124:127], a[176:179], v[80:83]
    ds_read_b128 a[156:159], v192 offset:32768
    v_mfma_f32_16x16x32_bf16 v[84:87], a[124:127], a[180:183], v[84:87]
    ds_read_b128 a[160:163], v192 offset:36864
    v_mfma_f32_16x16x32_bf16 v[88:91], a[128:131], a[164:167], v[88:91]
    s_waitcnt vmcnt(9)
    ds_read_b64_tr_b16 a[80:81], v226 offset:0
    v_mfma_f32_16x16x32_bf16 v[92:95], a[128:131], a[168:171], v[92:95]
    buffer_load_dwordx4 v171, s[16:19], s79 offen offset:3072 lds
    v_mfma_f32_16x16x32_bf16 v[96:99], a[128:131], a[172:175], v[96:99]
    ds_read_b64_tr_b16 a[84:85], v227 offset:0
    v_mfma_f32_16x16x32_bf16 v[100:103], a[128:131], a[176:179], v[100:103]
    ds_read_b64_tr_b16 a[88:89], v228 offset:0
    v_mfma_f32_16x16x32_bf16 v[104:107], a[128:131], a[180:183], v[104:107]
    s_mov_b32 m0, s65
    ds_read_b64_tr_b16 a[92:93], v229 offset:0
    v_mfma_f32_16x16x32_bf16 v[108:111], a[132:135], a[164:167], v[108:111]
    buffer_load_dwordx4 v173, s[16:19], s79 offen offset:1024 lds
    v_mfma_f32_16x16x32_bf16 v[112:115], a[132:135], a[168:171], v[112:115]
    ds_read_b64_tr_b16 a[96:97], v230 offset:0
    v_mfma_f32_16x16x32_bf16 v[116:119], a[132:135], a[172:175], v[116:119]
    ds_read_b64_tr_b16 a[100:101], v231 offset:0
    v_mfma_f32_16x16x32_bf16 v[120:123], a[132:135], a[176:179], v[120:123]
    ds_read_b64_tr_b16 a[104:105], v232 offset:0
    v_mfma_f32_16x16x32_bf16 v[124:127], a[132:135], a[180:183], v[124:127]
    buffer_load_dwordx4 v175, s[16:19], s79 offen offset:3072 lds
    v_mfma_f32_16x16x32_bf16 v[128:131], a[136:139], a[164:167], v[128:131]
    s_add_u32 s79, s79, 262144
    ds_read_b64_tr_b16 a[108:109], v233 offset:0
    v_mfma_f32_16x16x32_bf16 v[132:135], a[136:139], a[168:171], v[132:135]
    s_waitcnt vmcnt(8)
    ds_read_b64_tr_b16 a[82:83], v226 offset:1024
    v_mfma_f32_16x16x32_bf16 v[136:139], a[136:139], a[172:175], v[136:139]
    ds_read_b64_tr_b16 a[86:87], v227 offset:1024
    v_mfma_f32_16x16x32_bf16 v[140:143], a[136:139], a[176:179], v[140:143]
    ds_read_b64_tr_b16 a[90:91], v228 offset:1024
    v_mfma_f32_16x16x32_bf16 v[144:147], a[136:139], a[180:183], v[144:147]
    ds_read_b64_tr_b16 a[94:95], v229 offset:1024
    v_mfma_f32_16x16x32_bf16 v[148:151], a[140:143], a[164:167], v[148:151]
    ds_read_b64_tr_b16 a[98:99], v230 offset:1024
    v_mfma_f32_16x16x32_bf16 v[152:155], a[140:143], a[168:171], v[152:155]
    ds_read_b64_tr_b16 a[102:103], v231 offset:1024
    v_mfma_f32_16x16x32_bf16 v[156:159], a[140:143], a[172:175], v[156:159]
    ds_read_b64_tr_b16 a[106:107], v232 offset:1024
    v_mfma_f32_16x16x32_bf16 v[160:163], a[140:143], a[176:179], v[160:163]
    ds_read_b64_tr_b16 a[110:111], v233 offset:1024
    v_mfma_f32_16x16x32_bf16 v[164:167], a[140:143], a[180:183], v[164:167]
    s_waitcnt lgkmcnt(5)
    v_mfma_f32_16x16x32_bf16 v[8:11], a[80:83], a[144:147], v[8:11]
    s_mov_b32 m0, s62
    v_mfma_f32_16x16x32_bf16 v[12:15], a[80:83], a[148:151], v[12:15]
    buffer_load_dwordx4 v168, s[16:19], s79 offen offset:0 lds
    v_mfma_f32_16x16x32_bf16 v[16:19], a[80:83], a[152:155], v[16:19]
    v_mfma_f32_16x16x32_bf16 v[20:23], a[80:83], a[156:159], v[20:23]
    v_mfma_f32_16x16x32_bf16 v[24:27], a[80:83], a[160:163], v[24:27]
    v_mfma_f32_16x16x32_bf16 v[28:31], a[84:87], a[144:147], v[28:31]
    buffer_load_dwordx4 v170, s[16:19], s79 offen offset:2048 lds
    v_mfma_f32_16x16x32_bf16 v[32:35], a[84:87], a[148:151], v[32:35]
    v_mfma_f32_16x16x32_bf16 v[36:39], a[84:87], a[152:155], v[36:39]
    v_mfma_f32_16x16x32_bf16 v[40:43], a[84:87], a[156:159], v[40:43]
    s_mov_b32 m0, s63
    v_mfma_f32_16x16x32_bf16 v[44:47], a[84:87], a[160:163], v[44:47]
    buffer_load_dwordx4 v172, s[16:19], s79 offen offset:0 lds
    v_mfma_f32_16x16x32_bf16 v[48:51], a[88:91], a[144:147], v[48:51]
    s_waitcnt lgkmcnt(0)
    v_mfma_f32_16x16x32_bf16 v[52:55], a[88:91], a[148:151], v[52:55]
    v_mfma_f32_16x16x32_bf16 v[56:59], a[88:91], a[152:155], v[56:59]
    v_mfma_f32_16x16x32_bf16 v[60:63], a[88:91], a[156:159], v[60:63]
    buffer_load_dwordx4 v174, s[16:19], s79 offen offset:2048 lds
    v_mfma_f32_16x16x32_bf16 v[64:67], a[88:91], a[160:163], v[64:67]
    ds_read_b128 a[164:167], v193 offset:20480
    v_mfma_f32_16x16x32_bf16 v[68:71], a[92:95], a[144:147], v[68:71]
    ds_read_b128 a[168:171], v193 offset:24576
    v_mfma_f32_16x16x32_bf16 v[72:75], a[92:95], a[148:151], v[72:75]
    s_mov_b32 m0, s62
    ds_read_b128 a[172:175], v193 offset:28672
    v_mfma_f32_16x16x32_bf16 v[76:79], a[92:95], a[152:155], v[76:79]
    buffer_load_dwordx4 v169, s[16:19], s79 offen offset:1024 lds
    v_mfma_f32_16x16x32_bf16 v[80:83], a[92:95], a[156:159], v[80:83]
    ds_read_b128 a[176:179], v193 offset:32768
    v_mfma_f32_16x16x32_bf16 v[84:87], a[92:95], a[160:163], v[84:87]
    ds_read_b128 a[180:183], v193 offset:36864
    v_mfma_f32_16x16x32_bf16 v[88:91], a[96:99], a[144:147], v[88:91]
    s_waitcnt vmcnt(9)
    ds_read_b64_tr_b16 a[112:113], v226 offset:8192
    v_mfma_f32_16x16x32_bf16 v[92:95], a[96:99], a[148:151], v[92:95]
    buffer_load_dwordx4 v171, s[16:19], s79 offen offset:3072 lds
    v_mfma_f32_16x16x32_bf16 v[96:99], a[96:99], a[152:155], v[96:99]
    ds_read_b64_tr_b16 a[116:117], v227 offset:8192
    v_mfma_f32_16x16x32_bf16 v[100:103], a[96:99], a[156:159], v[100:103]
    ds_read_b64_tr_b16 a[120:121], v228 offset:8192
    v_mfma_f32_16x16x32_bf16 v[104:107], a[96:99], a[160:163], v[104:107]
    s_mov_b32 m0, s63
    ds_read_b64_tr_b16 a[124:125], v229 offset:8192
    v_mfma_f32_16x16x32_bf16 v[108:111], a[100:103], a[144:147], v[108:111]
    buffer_load_dwordx4 v173, s[16:19], s79 offen offset:1024 lds
    v_mfma_f32_16x16x32_bf16 v[112:115], a[100:103], a[148:151], v[112:115]
    ds_read_b64_tr_b16 a[128:129], v230 offset:8192
    v_mfma_f32_16x16x32_bf16 v[116:119], a[100:103], a[152:155], v[116:119]
    ds_read_b64_tr_b16 a[132:133], v231 offset:8192
    v_mfma_f32_16x16x32_bf16 v[120:123], a[100:103], a[156:159], v[120:123]
    ds_read_b64_tr_b16 a[136:137], v232 offset:8192
    v_mfma_f32_16x16x32_bf16 v[124:127], a[100:103], a[160:163], v[124:127]
    buffer_load_dwordx4 v175, s[16:19], s79 offen offset:3072 lds
    v_mfma_f32_16x16x32_bf16 v[128:131], a[104:107], a[144:147], v[128:131]
    s_add_u32 s79, s79, 262144
    ds_read_b64_tr_b16 a[140:141], v233 offset:8192
    v_mfma_f32_16x16x32_bf16 v[132:135], a[104:107], a[148:151], v[132:135]
    s_waitcnt vmcnt(8)
    ds_read_b64_tr_b16 a[114:115], v226 offset:9216
    v_mfma_f32_16x16x32_bf16 v[136:139], a[104:107], a[152:155], v[136:139]
    ds_read_b64_tr_b16 a[118:119], v227 offset:9216
    v_mfma_f32_16x16x32_bf16 v[140:143], a[104:107], a[156:159], v[140:143]
    ds_read_b64_tr_b16 a[122:123], v228 offset:9216
    v_mfma_f32_16x16x32_bf16 v[144:147], a[104:107], a[160:163], v[144:147]
    ds_read_b64_tr_b16 a[126:127], v229 offset:9216
    v_mfma_f32_16x16x32_bf16 v[148:151], a[108:111], a[144:147], v[148:151]
    ds_read_b64_tr_b16 a[130:131], v230 offset:9216
    v_mfma_f32_16x16x32_bf16 v[152:155], a[108:111], a[148:151], v[152:155]
    ds_read_b64_tr_b16 a[134:135], v231 offset:9216
    v_mfma_f32_16x16x32_bf16 v[156:159], a[108:111], a[152:155], v[156:159]
    ds_read_b64_tr_b16 a[138:139], v232 offset:9216
    v_mfma_f32_16x16x32_bf16 v[160:163], a[108:111], a[156:159], v[160:163]
    ds_read_b64_tr_b16 a[142:143], v233 offset:9216
    v_mfma_f32_16x16x32_bf16 v[164:167], a[108:111], a[160:163], v[164:167]
    s_waitcnt lgkmcnt(5)
    v_mfma_f32_16x16x32_bf16 v[8:11], a[112:115], a[164:167], v[8:11]
    s_mov_b32 m0, s64
    v_mfma_f32_16x16x32_bf16 v[12:15], a[112:115], a[168:171], v[12:15]
    buffer_load_dwordx4 v168, s[16:19], s79 offen offset:0 lds
    v_mfma_f32_16x16x32_bf16 v[16:19], a[112:115], a[172:175], v[16:19]
    v_mfma_f32_16x16x32_bf16 v[20:23], a[112:115], a[176:179], v[20:23]
    v_mfma_f32_16x16x32_bf16 v[24:27], a[112:115], a[180:183], v[24:27]
    v_mfma_f32_16x16x32_bf16 v[28:31], a[116:119], a[164:167], v[28:31]
    buffer_load_dwordx4 v170, s[16:19], s79 offen offset:2048 lds
    v_mfma_f32_16x16x32_bf16 v[32:35], a[116:119], a[168:171], v[32:35]
    v_mfma_f32_16x16x32_bf16 v[36:39], a[116:119], a[172:175], v[36:39]
    v_mfma_f32_16x16x32_bf16 v[40:43], a[116:119], a[176:179], v[40:43]
    s_mov_b32 m0, s65
    v_mfma_f32_16x16x32_bf16 v[44:47], a[116:119], a[180:183], v[44:47]
    buffer_load_dwordx4 v172, s[16:19], s79 offen offset:0 lds
    v_mfma_f32_16x16x32_bf16 v[48:51], a[120:123], a[164:167], v[48:51]
    s_waitcnt lgkmcnt(0)
    v_mfma_f32_16x16x32_bf16 v[52:55], a[120:123], a[168:171], v[52:55]
    v_mfma_f32_16x16x32_bf16 v[56:59], a[120:123], a[172:175], v[56:59]
    v_mfma_f32_16x16x32_bf16 v[60:63], a[120:123], a[176:179], v[60:63]
    buffer_load_dwordx4 v174, s[16:19], s79 offen offset:2048 lds
    v_mfma_f32_16x16x32_bf16 v[64:67], a[120:123], a[180:183], v[64:67]
    ds_read_b128 a[144:147], v194 offset:20480
    v_mfma_f32_16x16x32_bf16 v[68:71], a[124:127], a[164:167], v[68:71]
    ds_read_b128 a[148:151], v194 offset:24576
    v_mfma_f32_16x16x32_bf16 v[72:75], a[124:127], a[168:171], v[72:75]
    s_mov_b32 m0, s64
    ds_read_b128 a[152:155], v194 offset:28672
    v_mfma_f32_16x16x32_bf16 v[76:79], a[124:127], a[172:175], v[76:79]
    buffer_load_dwordx4 v169, s[16:19], s79 offen offset:1024 lds
    v_mfma_f32_16x16x32_bf16 v[80:83], a[124:127], a[176:179], v[80:83]
    ds_read_b128 a[156:159], v194 offset:32768
    v_mfma_f32_16x16x32_bf16 v[84:87], a[124:127], a[180:183], v[84:87]
    ds_read_b128 a[160:163], v194 offset:36864
    v_mfma_f32_16x16x32_bf16 v[88:91], a[128:131], a[164:167], v[88:91]
    s_waitcnt vmcnt(9)
    ds_read_b64_tr_b16 a[80:81], v226 offset:0
    v_mfma_f32_16x16x32_bf16 v[92:95], a[128:131], a[168:171], v[92:95]
    buffer_load_dwordx4 v171, s[16:19], s79 offen offset:3072 lds
    v_mfma_f32_16x16x32_bf16 v[96:99], a[128:131], a[172:175], v[96:99]
    ds_read_b64_tr_b16 a[84:85], v227 offset:0
    v_mfma_f32_16x16x32_bf16 v[100:103], a[128:131], a[176:179], v[100:103]
    ds_read_b64_tr_b16 a[88:89], v228 offset:0
    v_mfma_f32_16x16x32_bf16 v[104:107], a[128:131], a[180:183], v[104:107]
    s_mov_b32 m0, s65
    ds_read_b64_tr_b16 a[92:93], v229 offset:0
    v_mfma_f32_16x16x32_bf16 v[108:111], a[132:135], a[164:167], v[108:111]
    buffer_load_dwordx4 v173, s[16:19], s79 offen offset:1024 lds
    v_mfma_f32_16x16x32_bf16 v[112:115], a[132:135], a[168:171], v[112:115]
    ds_read_b64_tr_b16 a[96:97], v230 offset:0
    v_mfma_f32_16x16x32_bf16 v[116:119], a[132:135], a[172:175], v[116:119]
    ds_read_b64_tr_b16 a[100:101], v231 offset:0
    v_mfma_f32_16x16x32_bf16 v[120:123], a[132:135], a[176:179], v[120:123]
    ds_read_b64_tr_b16 a[104:105], v232 offset:0
    v_mfma_f32_16x16x32_bf16 v[124:127], a[132:135], a[180:183], v[124:127]
    buffer_load_dwordx4 v175, s[16:19], s79 offen offset:3072 lds
    v_mfma_f32_16x16x32_bf16 v[128:131], a[136:139], a[164:167], v[128:131]
    s_add_u32 s79, s79, 262144
    ds_read_b64_tr_b16 a[108:109], v233 offset:0
    v_mfma_f32_16x16x32_bf16 v[132:135], a[136:139], a[168:171], v[132:135]
    s_waitcnt vmcnt(8)
    ds_read_b64_tr_b16 a[82:83], v226 offset:1024
    v_mfma_f32_16x16x32_bf16 v[136:139], a[136:139], a[172:175], v[136:139]
    ds_read_b64_tr_b16 a[86:87], v227 offset:1024
    v_mfma_f32_16x16x32_bf16 v[140:143], a[136:139], a[176:179], v[140:143]
    ds_read_b64_tr_b16 a[90:91], v228 offset:1024
    v_mfma_f32_16x16x32_bf16 v[144:147], a[136:139], a[180:183], v[144:147]
    ds_read_b64_tr_b16 a[94:95], v229 offset:1024
    v_mfma_f32_16x16x32_bf16 v[148:151], a[140:143], a[164:167], v[148:151]
    ds_read_b64_tr_b16 a[98:99], v230 offset:1024
    v_mfma_f32_16x16x32_bf16 v[152:155], a[140:143], a[168:171], v[152:155]
    ds_read_b64_tr_b16 a[102:103], v231 offset:1024
    v_mfma_f32_16x16x32_bf16 v[156:159], a[140:143], a[172:175], v[156:159]
    ds_read_b64_tr_b16 a[106:107], v232 offset:1024
    v_mfma_f32_16x16x32_bf16 v[160:163], a[140:143], a[176:179], v[160:163]
    ds_read_b64_tr_b16 a[110:111], v233 offset:1024
    v_mfma_f32_16x16x32_bf16 v[164:167], a[140:143], a[180:183], v[164:167]
L_k14:
    s_waitcnt lgkmcnt(0)
    v_mfma_f32_16x16x32_bf16 v[8:11], a[80:83], a[144:147], v[8:11]
    s_mov_b32 m0, s62
    v_mfma_f32_16x16x32_bf16 v[12:15], a[80:83], a[148:151], v[12:15]
    buffer_load_dwordx4 v234, s[8:11], s71 offen offset:0 nt lds
    v_mfma_f32_16x16x32_bf16 v[16:19], a[80:83], a[152:155], v[16:19]
    v_mfma_f32_16x16x32_bf16 v[20:23], a[80:83], a[156:159], v[20:23]
    v_mfma_f32_16x16x32_bf16 v[24:27], a[80:83], a[160:163], v[24:27]
    v_mfma_f32_16x16x32_bf16 v[28:31], a[84:87], a[144:147], v[28:31]
    buffer_load_dwordx4 v235, s[8:11], s71 offen offset:1024 nt lds
    v_mfma_f32_16x16x32_bf16 v[32:35], a[84:87], a[148:151], v[32:35]
    v_mfma_f32_16x16x32_bf16 v[36:39], a[84:87], a[152:155], v[36:39]
    v_mfma_f32_16x16x32_bf16 v[40:43], a[84:87], a[156:159], v[40:43]
    v_mfma_f32_16x16x32_bf16 v[44:47], a[84:87], a[160:163], v[44:47]
    buffer_load_dwordx4 v234, s[8:11], s71 offen offset:2048 nt lds
    v_mfma_f32_16x16x32_bf16 v[48:51], a[88:91], a[144:147], v[48:51]
    s_waitcnt lgkmcnt(0)
    v_mfma_f32_16x16x32_bf16 v[52:55], a[88:91], a[148:151], v[52:55]
    v_mfma_f32_16x16x32_bf16 v[56:59], a[88:91], a[152:155], v[56:59]
    v_mfma_f32_16x16x32_bf16 v[60:63], a[88:91], a[156:159], v[60:63]
    buffer_load_dwordx4 v235, s[8:11], s71 offen offset:3072 nt lds
    v_mfma_f32_16x16x32_bf16 v[64:67], a[88:91], a[160:163], v[64:67]
    ds_read_b128 a[164:167], v195 offset:20480
    v_mfma_f32_16x16x32_bf16 v[68:71], a[92:95], a[144:147], v[68:71]
    ds_read_b128 a[168:171], v195 offset:24576
    v_mfma_f32_16x16x32_bf16 v[72:75], a[92:95], a[148:151], v[72:75]
    s_mov_b32 m0, s63
    ds_read_b128 a[172:175], v195 offset:28672
    v_mfma_f32_16x16x32_bf16 v[76:79], a[92:95], a[152:155], v[76:79]
    buffer_load_dwordx4 v236, s[8:11], s71 offen offset:0 nt lds
    v_mfma_f32_16x16x32_bf16 v[80:83], a[92:95], a[156:159], v[80:83]
    ds_read_b128 a[176:179], v195 offset:32768
    v_mfma_f32_16x16x32_bf16 v[84:87], a[92:95], a[160:163], v[84:87]
    ds_read_b128 a[180:183], v195 offset:36864
    v_mfma_f32_16x16x32_bf16 v[88:91], a[96:99], a[144:147], v[88:91]
    s_waitcnt vmcnt(9)
    ds_read_b64_tr_b16 a[112:113], v226 offset:8192
    v_mfma_f32_16x16x32_bf16 v[92:95], a[96:99], a[148:151], v[92:95]
    buffer_load_dwordx4 v237, s[8:11], s71 offen offset:1024 nt lds
    v_mfma_f32_16x16x32_bf16 v[96:99], a[96:99], a[152:155], v[96:99]
    ds_read_b64_tr_b16 a[116:117], v227 offset:8192
    v_mfma_f32_16x16x32_bf16 v[100:103], a[96:99], a[156:159], v[100:103]
    ds_read_b64_tr_b16 a[120:121], v228 offset:8192
    v_mfma_f32_16x16x32_bf16 v[104:107], a[96:99], a[160:163], v[104:107]
    ds_read_b64_tr_b16 a[124:125], v229 offset:8192
    v_mfma_f32_16x16x32_bf16 v[108:111], a[100:103], a[144:147], v[108:111]
    buffer_load_dwordx4 v236, s[8:11], s71 offen offset:2048 nt lds
    v_mfma_f32_16x16x32_bf16 v[112:115], a[100:103], a[148:151], v[112:115]
    ds_read_b64_tr_b16 a[128:129], v230 offset:8192
    v_mfma_f32_16x16x32_bf16 v[116:119], a[100:103], a[152:155], v[116:119]
    ds_read_b64_tr_b16 a[132:133], v231 offset:8192
    v_mfma_f32_16x16x32_bf16 v[120:123], a[100:103], a[156:159], v[120:123]
    ds_read_b64_tr_b16 a[136:137], v232 offset:8192
    v_mfma_f32_16x16x32_bf16 v[124:127], a[100:103], a[160:163], v[124:127]
    buffer_load_dwordx4 v237, s[8:11], s71 offen offset:3072 nt lds
    v_mfma_f32_16x16x32_bf16 v[128:131], a[104:107], a[144:147], v[128:131]
    ds_read_b64_tr_b16 a[140:141], v233 offset:8192
    v_mfma_f32_16x16x32_bf16 v[132:135], a[104:107], a[148:151], v[132:135]
    s_waitcnt vmcnt(8)
    ds_read_b64_tr_b16 a[114:115], v226 offset:9216
    v_mfma_f32_16x16x32_bf16 v[136:139], a[104:107], a[152:155], v[136:139]
    ds_read_b64_tr_b16 a[118:119], v227 offset:9216
    v_mfma_f32_16x16x32_bf16 v[140:143], a[104:107], a[156:159], v[140:143]
    ds_read_b64_tr_b16 a[122:123], v228 offset:9216
    v_mfma_f32_16x16x32_bf16 v[144:147], a[104:107], a[160:163], v[144:147]
    ds_read_b64_tr_b16 a[126:127], v229 offset:9216
    v_mfma_f32_16x16x32_bf16 v[148:151], a[108:111], a[144:147], v[148:151]
    ds_read_b64_tr_b16 a[130:131], v230 offset:9216
    v_mfma_f32_16x16x32_bf16 v[152:155], a[108:111], a[148:151], v[152:155]
    ds_read_b64_tr_b16 a[134:135], v231 offset:9216
    v_mfma_f32_16x16x32_bf16 v[156:159], a[108:111], a[152:155], v[156:159]
    ds_read_b64_tr_b16 a[138:139], v232 offset:9216
    v_mfma_f32_16x16x32_bf16 v[160:163], a[108:111], a[156:159], v[160:163]
    ds_read_b64_tr_b16 a[142:143], v233 offset:9216
    v_mfma_f32_16x16x32_bf16 v[164:167], a[108:111], a[160:163], v[164:167]
    s_waitcnt lgkmcnt(0)
    s_mov_b32 m0, s66
    v_mfma_f32_16x16x32_bf16 v[8:11], a[112:115], a[164:167], v[8:11]
    buffer_load_dwordx4 v234, s[12:15], s71 offen offset:0 nt lds
    v_mfma_f32_16x16x32_bf16 v[28:31], a[116:119], a[164:167], v[28:31]
    v_lshl_add_u32 v226, v4, 10, v1
    v_mfma_f32_16x16x32_bf16 v[48:51], a[120:123], a[164:167], v[48:51]
    v_add_u32 v226, 0x10000, v226
    v_mfma_f32_16x16x32_bf16 v[68:71], a[124:127], a[164:167], v[68:71]
    v_xor_b32 v227, 32, v226
    v_mfma_f32_16x16x32_bf16 v[88:91], a[128:131], a[164:167], v[88:91]
    buffer_load_dwordx4 v235, s[12:15], s71 offen offset:1024 nt lds
    v_mfma_f32_16x16x32_bf16 v[108:111], a[132:135], a[164:167], v[108:111]
    v_xor_b32 v228, 64, v226
    v_mfma_f32_16x16x32_bf16 v[128:131], a[136:139], a[164:167], v[128:131]
    v_xor_b32 v229, 96, v226
    v_mfma_f32_16x16x32_bf16 v[148:151], a[140:143], a[164:167], v[148:151]
    v_xor_b32 v230, 128, v226
    v_mfma_f32_16x16x32_bf16 v[12:15], a[112:115], a[168:171], v[12:15]
    buffer_load_dwordx4 v234, s[12:15], s71 offen offset:2048 nt lds
    v_mfma_f32_16x16x32_bf16 v[32:35], a[116:119], a[168:171], v[32:35]
    v_xor_b32 v231, 160, v226
    v_mfma_f32_16x16x32_bf16 v[52:55], a[120:123], a[168:171], v[52:55]
    v_xor_b32 v232, 192, v226
    v_mfma_f32_16x16x32_bf16 v[72:75], a[124:127], a[168:171], v[72:75]
    v_xor_b32 v233, 224, v226
    v_pk_mul_f32 v[8:9], v[8:9], s[82:83]
    v_pk_mul_f32 v[10:11], v[10:11], s[82:83]
    v_pk_mul_f32 v[28:29], v[28:29], s[82:83]
    v_pk_mul_f32 v[30:31], v[30:31], s[82:83]
    v_pk_mul_f32 v[48:49], v[48:49], s[82:83]
    v_pk_mul_f32 v[50:51], v[50:51], s[82:83]
    v_pk_mul_f32 v[68:69], v[68:69], s[82:83]
    v_pk_mul_f32 v[70:71], v[70:71], s[82:83]
    v_pk_mul_f32 v[88:89], v[88:89], s[82:83]
    v_pk_mul_f32 v[90:91], v[90:91], s[82:83]
    v_pk_mul_f32 v[108:109], v[108:109], s[82:83]
    v_pk_mul_f32 v[110:111], v[110:111], s[82:83]
    v_pk_mul_f32 v[128:129], v[128:129], s[82:83]
    v_pk_mul_f32 v[130:131], v[130:131], s[82:83]
    v_pk_mul_f32 v[148:149], v[148:149], s[82:83]
    v_pk_mul_f32 v[150:151], v[150:151], s[82:83]
    v_cvt_pk_bf16_f32 v244, v8, v9
    v_cvt_pk_bf16_f32 v246, v28, v29
    v_cvt_pk_bf16_f32 v245, v10, v11
    v_mfma_f32_16x16x32_bf16 v[92:95], a[128:131], a[168:171], v[92:95]
    v_cvt_pk_bf16_f32 v247, v30, v31
    v_cvt_pk_bf16_f32 v248, v48, v49
    v_cvt_pk_bf16_f32 v250, v68, v69
    v_mfma_f32_16x16x32_bf16 v[112:115], a[132:135], a[168:171], v[112:115]
    v_cvt_pk_bf16_f32 v249, v50, v51
    v_cvt_pk_bf16_f32 v251, v70, v71
    v_permlane32_swap_b32 v244, v246
    v_mfma_f32_16x16x32_bf16 v[132:135], a[136:139], a[168:171], v[132:135]
    buffer_load_dwordx4 v235, s[12:15], s71 offen offset:3072 nt lds
    v_permlane32_swap_b32 v245, v247
    v_permlane32_swap_b32 v248, v250
    v_mfma_f32_16x16x32_bf16 v[152:155], a[140:143], a[168:171], v[152:155]
    v_permlane32_swap_b32 v249, v251
    v_permlane16_swap_b32 v244, v246
    v_mfma_f32_16x16x32_bf16 v[16:19], a[112:115], a[172:175], v[16:19]
    v_permlane16_swap_b32 v245, v247
    v_permlane16_swap_b32 v248, v250
    s_mov_b32 m0, s67
    v_mfma_f32_16x16x32_bf16 v[36:39], a[116:119], a[172:175], v[36:39]
    buffer_load_dwordx4 v236, s[12:15], s71 offen offset:0 nt lds
    v_permlane16_swap_b32 v249, v251
    v_accvgpr_write_b32 a0, v244
    v_mfma_f32_16x16x32_bf16 v[56:59], a[120:123], a[172:175], v[56:59]
    v_accvgpr_write_b32 a1, v245
    v_accvgpr_write_b32 a2, v246
    v_accvgpr_write_b32 a3, v247
    v_mfma_f32_16x16x32_bf16 v[76:79], a[124:127], a[172:175], v[76:79]
    v_accvgpr_write_b32 a4, v248
    v_accvgpr_write_b32 a5, v249
    v_accvgpr_write_b32 a6, v250
    v_mfma_f32_16x16x32_bf16 v[96:99], a[128:131], a[172:175], v[96:99]
    buffer_load_dwordx4 v237, s[12:15], s71 offen offset:1024 nt lds
    v_accvgpr_write_b32 a7, v251
    v_cvt_pk_bf16_f32 v244, v88, v89
    v_cvt_pk_bf16_f32 v246, v108, v109
    v_mfma_f32_16x16x32_bf16 v[116:119], a[132:135], a[172:175], v[116:119]
    v_cvt_pk_bf16_f32 v245, v90, v91
    v_cvt_pk_bf16_f32 v247, v110, v111
    v_cvt_pk_bf16_f32 v248, v128, v129
    v_mfma_f32_16x16x32_bf16 v[136:139], a[136:139], a[172:175], v[136:139]
    v_cvt_pk_bf16_f32 v250, v148, v149
    v_cvt_pk_bf16_f32 v249, v130, v131
    v_cvt_pk_bf16_f32 v251, v150, v151
    v_mfma_f32_16x16x32_bf16 v[156:159], a[140:143], a[172:175], v[156:159]
    buffer_load_dwordx4 v236, s[12:15], s71 offen offset:2048 nt lds
    v_permlane32_swap_b32 v244, v246
    v_permlane32_swap_b32 v245, v247
    v_permlane32_swap_b32 v248, v250
    v_permlane32_swap_b32 v249, v251
    v_permlane16_swap_b32 v244, v246
    v_permlane16_swap_b32 v245, v247
    buffer_load_dwordx4 v237, s[12:15], s71 offen offset:3072 nt lds
    v_permlane16_swap_b32 v248, v250
    v_permlane16_swap_b32 v249, v251
    v_accvgpr_write_b32 a8, v244
    v_accvgpr_write_b32 a9, v245
    v_accvgpr_write_b32 a10, v246
    v_accvgpr_write_b32 a11, v247
    v_accvgpr_write_b32 a12, v248
    v_accvgpr_write_b32 a13, v249
    v_accvgpr_write_b32 a14, v250
    v_accvgpr_write_b32 a15, v251
    s_waitcnt vmcnt(8)
    ds_read_b128 a[80:83], v222 offset:0
    ds_read_b128 a[96:99], v222 offset:4096
    ds_read_b128 a[84:87], v223 offset:0
    ds_read_b128 a[100:103], v223 offset:4096
    ds_read_b128 a[88:91], v224 offset:0
    ds_read_b128 a[104:107], v224 offset:4096
    ds_read_b128 a[92:95], v225 offset:0
    ds_read_b128 a[108:111], v225 offset:4096
    v_pk_mul_f32 v[12:13], v[12:13], s[82:83]
    v_pk_mul_f32 v[14:15], v[14:15], s[82:83]
    v_pk_mul_f32 v[32:33], v[32:33], s[82:83]
    v_pk_mul_f32 v[34:35], v[34:35], s[82:83]
    v_pk_mul_f32 v[52:53], v[52:53], s[82:83]
    v_pk_mul_f32 v[54:55], v[54:55], s[82:83]
    v_pk_mul_f32 v[72:73], v[72:73], s[82:83]
    v_pk_mul_f32 v[74:75], v[74:75], s[82:83]
    v_pk_mul_f32 v[92:93], v[92:93], s[82:83]
    v_pk_mul_f32 v[94:95], v[94:95], s[82:83]
    v_pk_mul_f32 v[112:113], v[112:113], s[82:83]
    v_pk_mul_f32 v[114:115], v[114:115], s[82:83]
    v_pk_mul_f32 v[132:133], v[132:133], s[82:83]
    v_pk_mul_f32 v[134:135], v[134:135], s[82:83]
    v_pk_mul_f32 v[152:153], v[152:153], s[82:83]
    v_pk_mul_f32 v[154:155], v[154:155], s[82:83]
    v_cvt_pk_bf16_f32 v244, v12, v13
    v_cvt_pk_bf16_f32 v246, v32, v33
    v_cvt_pk_bf16_f32 v245, v14, v15
    v_mfma_f32_16x16x32_bf16 v[20:23], a[112:115], a[176:179], v[20:23]
    v_cvt_pk_bf16_f32 v247, v34, v35
    v_cvt_pk_bf16_f32 v248, v52, v53
    v_cvt_pk_bf16_f32 v250, v72, v73
    v_mfma_f32_16x16x32_bf16 v[40:43], a[116:119], a[176:179], v[40:43]
    v_cvt_pk_bf16_f32 v249, v54, v55
    v_cvt_pk_bf16_f32 v251, v74, v75
    v_permlane32_swap_b32 v244, v246
    s_mov_b32 m0, s64
    v_mfma_f32_16x16x32_bf16 v[60:63], a[120:123], a[176:179], v[60:63]
    buffer_load_dwordx4 v234, s[8:11], s70 offen offset:0 nt lds
    v_permlane32_swap_b32 v245, v247
    v_permlane32_swap_b32 v248, v250
    v_mfma_f32_16x16x32_bf16 v[80:83], a[124:127], a[176:179], v[80:83]
    v_permlane32_swap_b32 v249, v251
    v_permlane16_swap_b32 v244, v246
    v_mfma_f32_16x16x32_bf16 v[100:103], a[128:131], a[176:179], v[100:103]
    v_permlane16_swap_b32 v245, v247
    v_permlane16_swap_b32 v248, v250
    v_mfma_f32_16x16x32_bf16 v[120:123], a[132:135], a[176:179], v[120:123]
    buffer_load_dwordx4 v235, s[8:11], s70 offen offset:1024 nt lds
    v_permlane16_swap_b32 v249, v251
    v_accvgpr_write_b32 a16, v244
    v_mfma_f32_16x16x32_bf16 v[140:143], a[136:139], a[176:179], v[140:143]
    v_accvgpr_write_b32 a17, v245
    v_accvgpr_write_b32 a18, v246
    v_accvgpr_write_b32 a19, v247
    v_mfma_f32_16x16x32_bf16 v[160:163], a[140:143], a[176:179], v[160:163]
    v_accvgpr_write_b32 a20, v248
    v_accvgpr_write_b32 a21, v249
    v_accvgpr_write_b32 a22, v250
    buffer_load_dwordx4 v234, s[8:11], s70 offen offset:2048 nt lds
    v_accvgpr_write_b32 a23, v251
    v_cvt_pk_bf16_f32 v244, v92, v93
    v_cvt_pk_bf16_f32 v246, v112, v113
    v_cvt_pk_bf16_f32 v245, v94, v95
    v_cvt_pk_bf16_f32 v247, v114, v115
    v_cvt_pk_bf16_f32 v248, v132, v133
    v_cvt_pk_bf16_f32 v250, v152, v153
    v_cvt_pk_bf16_f32 v249, v134, v135
    v_cvt_pk_bf16_f32 v251, v154, v155
    buffer_load_dwordx4 v235, s[8:11], s70 offen offset:3072 nt lds
    v_permlane32_swap_b32 v244, v246
    v_permlane32_swap_b32 v245, v247
    v_permlane32_swap_b32 v248, v250
    v_permlane32_swap_b32 v249, v251
    v_permlane16_swap_b32 v244, v246
    v_permlane16_swap_b32 v245, v247
    s_mov_b32 m0, s65
    s_nop 0
    buffer_load_dwordx4 v236, s[8:11], s70 offen offset:0 nt lds
    v_permlane16_swap_b32 v248, v250
    v_permlane16_swap_b32 v249, v251
    v_accvgpr_write_b32 a24, v244
    v_accvgpr_write_b32 a25, v245
    v_accvgpr_write_b32 a26, v246
    v_accvgpr_write_b32 a27, v247
    v_accvgpr_write_b32 a28, v248
    v_accvgpr_write_b32 a29, v249
    v_accvgpr_write_b32 a30, v250
    v_accvgpr_write_b32 a31, v251
    s_waitcnt lgkmcnt(0)
    s_add_u32 s71, s55, 16384
    s_and_b32 s71, s71, 262143
    v_pk_mul_f32 v[16:17], v[16:17], s[82:83]
    v_pk_mul_f32 v[18:19], v[18:19], s[82:83]
    v_pk_mul_f32 v[36:37], v[36:37], s[82:83]
    v_pk_mul_f32 v[38:39], v[38:39], s[82:83]
    v_pk_mul_f32 v[56:57], v[56:57], s[82:83]
    v_pk_mul_f32 v[58:59], v[58:59], s[82:83]
    v_pk_mul_f32 v[76:77], v[76:77], s[82:83]
    v_pk_mul_f32 v[78:79], v[78:79], s[82:83]
    v_pk_mul_f32 v[96:97], v[96:97], s[82:83]
    v_pk_mul_f32 v[98:99], v[98:99], s[82:83]
    v_pk_mul_f32 v[116:117], v[116:117], s[82:83]
    v_pk_mul_f32 v[118:119], v[118:119], s[82:83]
    v_pk_mul_f32 v[136:137], v[136:137], s[82:83]
    v_pk_mul_f32 v[138:139], v[138:139], s[82:83]
    v_pk_mul_f32 v[156:157], v[156:157], s[82:83]
    v_pk_mul_f32 v[158:159], v[158:159], s[82:83]
    v_cvt_pk_bf16_f32 v244, v16, v17
    v_cvt_pk_bf16_f32 v246, v36, v37
    v_cvt_pk_bf16_f32 v245, v18, v19
    v_mfma_f32_16x16x32_bf16 v[24:27], a[112:115], a[180:183], v[24:27]
    v_cvt_pk_bf16_f32 v247, v38, v39
    v_cvt_pk_bf16_f32 v248, v56, v57
    v_cvt_pk_bf16_f32 v250, v76, v77
    v_mfma_f32_16x16x32_bf16 v[44:47], a[116:119], a[180:183], v[44:47]
    v_cvt_pk_bf16_f32 v249, v58, v59
    v_cvt_pk_bf16_f32 v251, v78, v79
    v_permlane32_swap_b32 v244, v246
    v_mfma_f32_16x16x32_bf16 v[64:67], a[120:123], a[180:183], v[64:67]
    buffer_load_dwordx4 v237, s[8:11], s70 offen offset:1024 nt lds
    v_permlane32_swap_b32 v245, v247
    v_permlane32_swap_b32 v248, v250
    v_mfma_f32_16x16x32_bf16 v[84:87], a[124:127], a[180:183], v[84:87]
    v_permlane32_swap_b32 v249, v251
    v_permlane16_swap_b32 v244, v246
    v_mfma_f32_16x16x32_bf16 v[104:107], a[128:131], a[180:183], v[104:107]
    v_permlane16_swap_b32 v245, v247
    v_permlane16_swap_b32 v248, v250
    v_mfma_f32_16x16x32_bf16 v[124:127], a[132:135], a[180:183], v[124:127]
    buffer_load_dwordx4 v236, s[8:11], s70 offen offset:2048 nt lds
    v_permlane16_swap_b32 v249, v251
    v_accvgpr_write_b32 a32, v244
    v_mfma_f32_16x16x32_bf16 v[144:147], a[136:139], a[180:183], v[144:147]
    v_accvgpr_write_b32 a33, v245
    v_accvgpr_write_b32 a34, v246
    v_accvgpr_write_b32 a35, v247
    v_mfma_f32_16x16x32_bf16 v[164:167], a[140:143], a[180:183], v[164:167]
    v_accvgpr_write_b32 a36, v248
    v_accvgpr_write_b32 a37, v249
    v_accvgpr_write_b32 a38, v250
    v_mfma_f32_16x16x32_bf16 v[168:171], a[80:83], a[0:3], 0
    buffer_load_dwordx4 v237, s[8:11], s70 offen offset:3072 nt lds
    v_accvgpr_write_b32 a39, v251
    v_cvt_pk_bf16_f32 v244, v96, v97
    v_cvt_pk_bf16_f32 v246, v116, v117
    v_mfma_f32_16x16x32_bf16 v[168:171], a[84:87], a[4:7], v[168:171]
    v_cvt_pk_bf16_f32 v245, v98, v99
    v_cvt_pk_bf16_f32 v247, v118, v119
    v_cvt_pk_bf16_f32 v248, v136, v137
    v_mfma_f32_16x16x32_bf16 v[168:171], a[88:91], a[8:11], v[168:171]
    v_cvt_pk_bf16_f32 v250, v156, v157
    v_cvt_pk_bf16_f32 v249, v138, v139
    v_cvt_pk_bf16_f32 v251, v158, v159
    s_mov_b32 m0, s68
    v_mfma_f32_16x16x32_bf16 v[168:171], a[92:95], a[12:15], v[168:171]
    buffer_load_dwordx4 v234, s[12:15], s70 offen offset:0 nt lds
    v_permlane32_swap_b32 v244, v246
    v_permlane32_swap_b32 v245, v247
    v_permlane32_swap_b32 v248, v250
    v_permlane32_swap_b32 v249, v251
    v_permlane16_swap_b32 v244, v246
    v_permlane16_swap_b32 v245, v247
    buffer_load_dwordx4 v235, s[12:15], s70 offen offset:1024 nt lds
    v_permlane16_swap_b32 v248, v250
    v_permlane16_swap_b32 v249, v251
    v_accvgpr_write_b32 a40, v244
    v_accvgpr_write_b32 a41, v245
    v_accvgpr_write_b32 a42, v246
    v_accvgpr_write_b32 a43, v247
    v_accvgpr_write_b32 a44, v248
    v_accvgpr_write_b32 a45, v249
    v_accvgpr_write_b32 a46, v250
    v_accvgpr_write_b32 a47, v251
    v_pk_mul_f32 v[20:21], v[20:21], s[82:83]
    v_pk_mul_f32 v[22:23], v[22:23], s[82:83]
    v_pk_mul_f32 v[40:41], v[40:41], s[82:83]
    v_pk_mul_f32 v[42:43], v[42:43], s[82:83]
    v_pk_mul_f32 v[60:61], v[60:61], s[82:83]
    v_pk_mul_f32 v[62:63], v[62:63], s[82:83]
    v_pk_mul_f32 v[80:81], v[80:81], s[82:83]
    v_pk_mul_f32 v[82:83], v[82:83], s[82:83]
    v_pk_mul_f32 v[100:101], v[100:101], s[82:83]
    v_pk_mul_f32 v[102:103], v[102:103], s[82:83]
    v_pk_mul_f32 v[120:121], v[120:121], s[82:83]
    v_pk_mul_f32 v[122:123], v[122:123], s[82:83]
    v_pk_mul_f32 v[140:141], v[140:141], s[82:83]
    v_pk_mul_f32 v[142:143], v[142:143], s[82:83]
    v_pk_mul_f32 v[160:161], v[160:161], s[82:83]
    v_pk_mul_f32 v[162:163], v[162:163], s[82:83]
    v_cvt_pk_bf16_f32 v244, v20, v21
    v_cvt_pk_bf16_f32 v246, v40, v41
    v_cvt_pk_bf16_f32 v245, v22, v23
    v_mfma_f32_16x16x32_bf16 v[172:175], a[80:83], a[16:19], 0
    v_cvt_pk_bf16_f32 v247, v42, v43
    v_cvt_pk_bf16_f32 v248, v60, v61
    v_cvt_pk_bf16_f32 v250, v80, v81
    v_mfma_f32_16x16x32_bf16 v[172:175], a[84:87], a[20:23], v[172:175]
    v_cvt_pk_bf16_f32 v249, v62, v63
    v_cvt_pk_bf16_f32 v251, v82, v83
    v_max3_f32 v212, v168, v169, v170
    v_mfma_f32_16x16x32_bf16 v[172:175], a[88:91], a[24:27], v[172:175]
    buffer_load_dwordx4 v234, s[12:15], s70 offen offset:2048 nt lds
    v_max_f32 v212, v212, v171
    v_permlane32_swap_b32 v244, v246
    v_mfma_f32_16x16x32_bf16 v[172:175], a[92:95], a[28:31], v[172:175]
    v_permlane32_swap_b32 v245, v247
    v_permlane32_swap_b32 v248, v250
    v_permlane32_swap_b32 v249, v251
    v_permlane16_swap_b32 v244, v246
    buffer_load_dwordx4 v235, s[12:15], s70 offen offset:3072 nt lds
    v_permlane16_swap_b32 v245, v247
    v_permlane16_swap_b32 v248, v250
    v_permlane16_swap_b32 v249, v251
    v_accvgpr_write_b32 a48, v244
    v_accvgpr_write_b32 a49, v245
    v_accvgpr_write_b32 a50, v246
    v_accvgpr_write_b32 a51, v247
    s_mov_b32 m0, s69
    s_nop 0
    buffer_load_dwordx4 v236, s[12:15], s70 offen offset:0 nt lds
    v_accvgpr_write_b32 a52, v248
    v_accvgpr_write_b32 a53, v249
    v_accvgpr_write_b32 a54, v250
    v_accvgpr_write_b32 a55, v251
    v_cvt_pk_bf16_f32 v244, v100, v101
    v_cvt_pk_bf16_f32 v246, v120, v121
    v_cvt_pk_bf16_f32 v245, v102, v103
    v_cvt_pk_bf16_f32 v247, v122, v123
    v_cvt_pk_bf16_f32 v248, v140, v141
    buffer_load_dwordx4 v237, s[12:15], s70 offen offset:1024 nt lds
    v_cvt_pk_bf16_f32 v250, v160, v161
    v_cvt_pk_bf16_f32 v249, v142, v143
    v_cvt_pk_bf16_f32 v251, v162, v163
    v_permlane32_swap_b32 v244, v246
    v_permlane32_swap_b32 v245, v247
    v_permlane32_swap_b32 v248, v250
    v_permlane32_swap_b32 v249, v251
    buffer_load_dwordx4 v236, s[12:15], s70 offen offset:2048 nt lds
    v_permlane16_swap_b32 v244, v246
    v_permlane16_swap_b32 v245, v247
    v_permlane16_swap_b32 v248, v250
    v_permlane16_swap_b32 v249, v251
    v_accvgpr_write_b32 a56, v244
    v_accvgpr_write_b32 a57, v245
    v_accvgpr_write_b32 a58, v246
    buffer_load_dwordx4 v237, s[12:15], s70 offen offset:3072 nt lds
    v_accvgpr_write_b32 a59, v247
    v_accvgpr_write_b32 a60, v248
    v_accvgpr_write_b32 a61, v249
    v_accvgpr_write_b32 a62, v250
    v_accvgpr_write_b32 a63, v251
    v_pk_mul_f32 v[24:25], v[24:25], s[82:83]
    v_pk_mul_f32 v[26:27], v[26:27], s[82:83]
    v_pk_mul_f32 v[44:45], v[44:45], s[82:83]
    v_pk_mul_f32 v[46:47], v[46:47], s[82:83]
    v_pk_mul_f32 v[64:65], v[64:65], s[82:83]
    v_pk_mul_f32 v[66:67], v[66:67], s[82:83]
    v_pk_mul_f32 v[84:85], v[84:85], s[82:83]
    v_pk_mul_f32 v[86:87], v[86:87], s[82:83]
    v_pk_mul_f32 v[104:105], v[104:105], s[82:83]
    v_pk_mul_f32 v[106:107], v[106:107], s[82:83]
    v_pk_mul_f32 v[124:125], v[124:125], s[82:83]
    v_pk_mul_f32 v[126:127], v[126:127], s[82:83]
    v_pk_mul_f32 v[144:145], v[144:145], s[82:83]
    v_pk_mul_f32 v[146:147], v[146:147], s[82:83]
    v_pk_mul_f32 v[164:165], v[164:165], s[82:83]
    v_pk_mul_f32 v[166:167], v[166:167], s[82:83]
    v_cvt_pk_bf16_f32 v244, v24, v25
    v_cvt_pk_bf16_f32 v246, v44, v45
    v_cvt_pk_bf16_f32 v245, v26, v27
    v_mfma_f32_16x16x32_bf16 v[176:179], a[80:83], a[32:35], 0
    v_cvt_pk_bf16_f32 v247, v46, v47
    v_cvt_pk_bf16_f32 v248, v64, v65
    v_cvt_pk_bf16_f32 v250, v84, v85
    v_mfma_f32_16x16x32_bf16 v[176:179], a[84:87], a[36:39], v[176:179]
    v_cvt_pk_bf16_f32 v249, v66, v67
    v_cvt_pk_bf16_f32 v251, v86, v87
    v_max3_f32 v213, v172, v173, v174
    s_mov_b32 m0, s62
    v_mfma_f32_16x16x32_bf16 v[176:179], a[88:91], a[40:43], v[176:179]
    buffer_load_dwordx4 v234, s[8:11], s71 offen offset:0 nt lds
    v_max_f32 v213, v213, v175
    v_permlane32_swap_b32 v244, v246
    v_mfma_f32_16x16x32_bf16 v[176:179], a[92:95], a[44:47], v[176:179]
    v_permlane32_swap_b32 v245, v247
    v_permlane32_swap_b32 v248, v250
    v_permlane32_swap_b32 v249, v251
    v_permlane16_swap_b32 v244, v246
    buffer_load_dwordx4 v235, s[8:11], s71 offen offset:1024 nt lds
    v_permlane16_swap_b32 v245, v247
    v_permlane16_swap_b32 v248, v250
    v_permlane16_swap_b32 v249, v251
    v_accvgpr_write_b32 a64, v244
    v_accvgpr_write_b32 a65, v245
    v_accvgpr_write_b32 a66, v246
    v_accvgpr_write_b32 a67, v247
    buffer_load_dwordx4 v234, s[8:11], s71 offen offset:2048 nt lds
    v_accvgpr_write_b32 a68, v248
    v_accvgpr_write_b32 a69, v249
    v_accvgpr_write_b32 a70, v250
    v_accvgpr_write_b32 a71, v251
    v_cvt_pk_bf16_f32 v244, v104, v105
    v_cvt_pk_bf16_f32 v246, v124, v125
    v_cvt_pk_bf16_f32 v245, v106, v107
    v_cvt_pk_bf16_f32 v247, v126, v127
    v_cvt_pk_bf16_f32 v248, v144, v145
    buffer_load_dwordx4 v235, s[8:11], s71 offen offset:3072 nt lds
    v_cvt_pk_bf16_f32 v250, v164, v165
    v_cvt_pk_bf16_f32 v249, v146, v147
    v_cvt_pk_bf16_f32 v251, v166, v167
    v_permlane32_swap_b32 v244, v246
    v_permlane32_swap_b32 v245, v247
    v_permlane32_swap_b32 v248, v250
    v_permlane32_swap_b32 v249, v251
    s_mov_b32 m0, s63
    s_nop 0
    buffer_load_dwordx4 v236, s[8:11], s71 offen offset:0 nt lds
    v_permlane16_swap_b32 v244, v246
    v_permlane16_swap_b32 v245, v247
    v_permlane16_swap_b32 v248, v250
    v_permlane16_swap_b32 v249, v251
    v_accvgpr_write_b32 a72, v244
    v_accvgpr_write_b32 a73, v245
    v_accvgpr_write_b32 a74, v246
    buffer_load_dwordx4 v237, s[8:11], s71 offen offset:1024 nt lds
    v_accvgpr_write_b32 a75, v247
    v_accvgpr_write_b32 a76, v248
    v_accvgpr_write_b32 a77, v249
    v_accvgpr_write_b32 a78, v250
    v_accvgpr_write_b32 a79, v251
    v_mfma_f32_16x16x32_bf16 v[180:183], a[80:83], a[48:51], 0
    buffer_load_dwordx4 v236, s[8:11], s71 offen offset:2048 nt lds
    v_mfma_f32_16x16x32_bf16 v[180:183], a[84:87], a[52:55], v[180:183]
    buffer_load_dwordx4 v237, s[8:11], s71 offen offset:3072 nt lds
    v_mfma_f32_16x16x32_bf16 v[180:183], a[88:91], a[56:59], v[180:183]
    v_mfma_f32_16x16x32_bf16 v[180:183], a[92:95], a[60:63], v[180:183]
    v_mfma_f32_16x16x32_bf16 v[168:171], a[80:83], a[64:67], 0
    v_mfma_f32_16x16x32_bf16 v[168:171], a[84:87], a[68:71], v[168:171]
    v_mfma_f32_16x16x32_bf16 v[168:171], a[88:91], a[72:75], v[168:171]
    v_mfma_f32_16x16x32_bf16 v[168:171], a[92:95], a[76:79], v[168:171]
    v_max3_f32 v214, v176, v177, v178
    v_max_f32 v214, v214, v179
    s_nop 1
    v_max3_f32 v215, v180, v181, v182
    v_max_f32 v215, v215, v183
    s_nop 1
    v_max3_f32 v216, v168, v169, v170
    v_max_f32 v216, v216, v171
    v_mov_b32 v217, v212
    v_mov_b32 v218, v213
    v_mov_b32 v219, v214
    v_mov_b32 v220, v215
    v_mov_b32 v221, v216
    v_permlane32_swap_b32 v217, v212
    v_permlane32_swap_b32 v218, v213
    v_permlane32_swap_b32 v219, v214
    v_permlane32_swap_b32 v220, v215
    v_permlane32_swap_b32 v221, v216
    v_max_f32 v212, v212, v217
    v_max_f32 v213, v213, v218
    v_max_f32 v214, v214, v219
    v_max_f32 v215, v215, v220
    v_max_f32 v216, v216, v221
    v_mov_b32 v217, v212
    v_mov_b32 v218, v213
    v_mov_b32 v219, v214
    v_mov_b32 v220, v215
    v_mov_b32 v221, v216
    v_permlane16_swap_b32 v217, v212
    v_permlane16_swap_b32 v218, v213
    v_permlane16_swap_b32 v219, v214
    v_permlane16_swap_b32 v220, v215
    v_permlane16_swap_b32 v221, v216
    v_max_f32 v212, v212, v217
    v_max_f32 v213, v213, v218
    v_max_f32 v214, v214, v219
    v_max_f32 v215, v215, v220
    v_max_f32 v216, v216, v221
    v_sub_f32 v192, 0, v212
    v_sub_f32 v193, 0, v212
    v_sub_f32 v194, 0, v212
    v_sub_f32 v195, 0, v212
    v_sub_f32 v196, 0, v213
    v_sub_f32 v197, 0, v213
    v_sub_f32 v198, 0, v213
    v_sub_f32 v199, 0, v213
    v_sub_f32 v200, 0, v214
    v_sub_f32 v201, 0, v214
    v_sub_f32 v202, 0, v214
    v_sub_f32 v203, 0, v214
    v_sub_f32 v204, 0, v215
    v_sub_f32 v205, 0, v215
    v_sub_f32 v206, 0, v215
    v_sub_f32 v207, 0, v215
    v_sub_f32 v208, 0, v216
    v_sub_f32 v209, 0, v216
    v_sub_f32 v210, 0, v216
    v_sub_f32 v211, 0, v216
    v_mov_b32 v212, 0
    v_mov_b32 v213, 0
    v_mov_b32 v214, 0
    v_mov_b32 v215, 0
    v_mov_b32 v216, 0
    v_mov_b32 v217, 0
    v_mov_b32 v218, 0
    v_mov_b32 v219, 0
    v_mov_b32 v220, 0
    v_mov_b32 v221, 0
    s_barrier
L_attn_start:
    s_waitcnt vmcnt(24)
    v_mfma_f32_16x16x32_bf16 v[168:171], a[80:83], a[0:3], v[192:195]
    ds_read_b64_tr_b16 a[112:113], v226 offset:0
    v_mfma_f32_16x16x32_bf16 v[172:175], a[96:99], a[0:3], v[192:195]
    ds_read_b64_tr_b16 a[114:115], v226 offset:4096
    v_mfma_f32_16x16x32_bf16 v[168:171], a[84:87], a[4:7], v[168:171]
    s_add_u32 s70, s55, 16384
    s_and_b32 s70, s70, 262143
    ds_read_b64_tr_b16 a[116:117], v227 offset:0
    v_mfma_f32_16x16x32_bf16 v[172:175], a[100:103], a[4:7], v[172:175]
    s_add_u32 s71, s55, 24576
    s_and_b32 s71, s71, 262143
    ds_read_b64_tr_b16 a[118:119], v227 offset:4096
    v_mfma_f32_16x16x32_bf16 v[168:171], a[88:91], a[8:11], v[168:171]
    s_lshl_b32 s79, s3, 17
    ds_read_b64_tr_b16 a[120:121], v228 offset:0
    v_mfma_f32_16x16x32_bf16 v[172:175], a[104:107], a[8:11], v[172:175]
    ds_read_b64_tr_b16 a[122:123], v228 offset:4096
    v_mfma_f32_16x16x32_bf16 v[168:171], a[92:95], a[12:15], v[168:171]
    ds_read_b64_tr_b16 a[124:125], v229 offset:0
    v_mfma_f32_16x16x32_bf16 v[172:175], a[108:111], a[12:15], v[172:175]
    ds_read_b64_tr_b16 a[126:127], v229 offset:4096
    v_mfma_f32_16x16x32_bf16 v[176:179], a[80:83], a[16:19], v[196:199]
    ds_read_b64_tr_b16 a[128:129], v230 offset:0
    v_mfma_f32_16x16x32_bf16 v[180:183], a[96:99], a[16:19], v[196:199]
    ds_read_b64_tr_b16 a[130:131], v230 offset:4096
    v_mfma_f32_16x16x32_bf16 v[176:179], a[84:87], a[20:23], v[176:179]
    ds_read_b64_tr_b16 a[132:133], v231 offset:0
    v_mfma_f32_16x16x32_bf16 v[180:183], a[100:103], a[20:23], v[180:183]
    ds_read_b64_tr_b16 a[134:135], v231 offset:4096
    v_exp_f32 v168, v168
    v_exp_f32 v169, v169
    v_exp_f32 v170, v170
    v_mfma_f32_16x16x32_bf16 v[176:179], a[88:91], a[24:27], v[176:179]
    ds_read_b64_tr_b16 a[136:137], v232 offset:0
    v_cvt_pk_bf16_f32 v184, v168, v169
    v_add_f32 v212, v212, v168
    v_add_f32 v217, v217, v169
    v_exp_f32 v171, v171
    v_add_f32 v212, v212, v170
    v_mfma_f32_16x16x32_bf16 v[180:183], a[104:107], a[24:27], v[180:183]
    ds_read_b64_tr_b16 a[138:139], v232 offset:4096
    v_exp_f32 v172, v172
    v_exp_f32 v173, v173
    v_cvt_pk_bf16_f32 v185, v170, v171
    v_add_f32 v217, v217, v171
    v_mfma_f32_16x16x32_bf16 v[176:179], a[92:95], a[28:31], v[176:179]
    ds_read_b64_tr_b16 a[140:141], v233 offset:0
    v_exp_f32 v174, v174
    v_exp_f32 v175, v175
    v_cvt_pk_bf16_f32 v186, v172, v173
    v_mfma_f32_16x16x32_bf16 v[180:183], a[108:111], a[28:31], v[180:183]
    ds_read_b64_tr_b16 a[142:143], v233 offset:4096
    v_cvt_pk_bf16_f32 v187, v174, v175
    v_add_f32 v212, v212, v172
    v_add_f32 v217, v217, v173
    v_add_f32 v212, v212, v174
    v_add_f32 v217, v217, v175
    s_or_b32 s75, s77, s73
    s_cmp_eq_u32 s75, 0
    s_cbranch_scc1 L_gqa
    v_mfma_f32_16x16x32_bf16 v[168:171], a[80:83], a[32:35], v[200:203]
    v_exp_f32 v176, v176
    v_mfma_f32_16x16x32_bf16 v[172:175], a[96:99], a[32:35], v[200:203]
    v_exp_f32 v177, v177
    v_mfma_f32_16x16x32_bf16 v[168:171], a[84:87], a[36:39], v[168:171]
    s_and_b32 s71, s71, 262143
    v_cvt_pk_bf16_f32 v188, v176, v177
    v_add_f32 v213, v213, v176
    v_mfma_f32_16x16x32_bf16 v[172:175], a[100:103], a[36:39], v[172:175]
    v_exp_f32 v178, v178
    v_mfma_f32_16x16x32_bf16 v[168:171], a[88:91], a[40:43], v[168:171]
    v_add_f32 v218, v218, v177
    v_add_f32 v213, v213, v178
    v_mfma_f32_16x16x32_bf16 v[172:175], a[104:107], a[40:43], v[172:175]
    v_exp_f32 v179, v179
    v_mfma_f32_16x16x32_bf16 v[168:171], a[92:95], a[44:47], v[168:171]
    v_cvt_pk_bf16_f32 v189, v178, v179
    v_add_f32 v218, v218, v179
    v_mfma_f32_16x16x32_bf16 v[172:175], a[108:111], a[44:47], v[172:175]
    s_waitcnt lgkmcnt(0)
    v_exp_f32 v180, v180
    v_mfma_f32_16x16x32_bf16 v[8:11], a[112:115], v[184:187], 0
    s_mov_b32 m0, s66
    v_exp_f32 v181, v181
    v_mfma_f32_16x16x32_bf16 v[28:31], a[116:119], v[184:187], 0
    buffer_load_dwordx4 v234, s[12:15], s70 offen offset:0 nt lds
    v_mfma_f32_16x16x32_bf16 v[48:51], a[120:123], v[184:187], 0
    v_exp_f32 v182, v182
    v_mfma_f32_16x16x32_bf16 v[68:71], a[124:127], v[184:187], 0
    v_exp_f32 v183, v183
    v_mfma_f32_16x16x32_bf16 v[88:91], a[128:131], v[184:187], 0
    v_cvt_pk_bf16_f32 v190, v180, v181
    v_cvt_pk_bf16_f32 v191, v182, v183
    v_mfma_f32_16x16x32_bf16 v[108:111], a[132:135], v[184:187], 0
    v_add_f32 v213, v213, v180
    v_add_f32 v218, v218, v181
    v_mfma_f32_16x16x32_bf16 v[128:131], a[136:139], v[184:187], 0
    buffer_load_dwordx4 v235, s[12:15], s70 offen offset:1024 nt lds
    v_mfma_f32_16x16x32_bf16 v[148:151], a[140:143], v[184:187], 0
    v_add_f32 v213, v213, v182
    v_add_f32 v218, v218, v183
    v_mfma_f32_16x16x32_bf16 v[176:179], a[80:83], a[48:51], v[204:207]
    v_exp_f32 v168, v168
    v_exp_f32 v169, v169
    v_mfma_f32_16x16x32_bf16 v[180:183], a[96:99], a[48:51], v[204:207]
    v_cvt_pk_bf16_f32 v184, v168, v169
    v_add_f32 v214, v214, v168
    v_add_f32 v219, v219, v169
    v_mfma_f32_16x16x32_bf16 v[176:179], a[84:87], a[52:55], v[176:179]
    v_exp_f32 v170, v170
    v_mfma_f32_16x16x32_bf16 v[180:183], a[100:103], a[52:55], v[180:183]
    buffer_load_dwordx4 v234, s[12:15], s70 offen offset:2048 nt lds
    v_mfma_f32_16x16x32_bf16 v[176:179], a[88:91], a[56:59], v[176:179]
    v_exp_f32 v171, v171
    v_mfma_f32_16x16x32_bf16 v[180:183], a[104:107], a[56:59], v[180:183]
    v_cvt_pk_bf16_f32 v185, v170, v171
    v_add_f32 v214, v214, v170
    v_mfma_f32_16x16x32_bf16 v[176:179], a[92:95], a[60:63], v[176:179]
    v_exp_f32 v172, v172
    v_mfma_f32_16x16x32_bf16 v[180:183], a[108:111], a[60:63], v[180:183]
    v_add_f32 v219, v219, v171
    v_add_f32 v214, v214, v172
    v_mfma_f32_16x16x32_bf16 v[12:15], a[112:115], v[188:191], 0
    buffer_load_dwordx4 v235, s[12:15], s70 offen offset:3072 nt lds
    v_mfma_f32_16x16x32_bf16 v[32:35], a[116:119], v[188:191], 0
    v_exp_f32 v173, v173
    v_mfma_f32_16x16x32_bf16 v[52:55], a[120:123], v[188:191], 0
    v_exp_f32 v174, v174
    v_mfma_f32_16x16x32_bf16 v[72:75], a[124:127], v[188:191], 0
    v_exp_f32 v175, v175
    v_mfma_f32_16x16x32_bf16 v[92:95], a[128:131], v[188:191], 0
    s_mov_b32 m0, s67
    v_cvt_pk_bf16_f32 v186, v172, v173
    v_cvt_pk_bf16_f32 v187, v174, v175
    v_mfma_f32_16x16x32_bf16 v[112:115], a[132:135], v[188:191], 0
    buffer_load_dwordx4 v236, s[12:15], s70 offen offset:0 nt lds
    v_mfma_f32_16x16x32_bf16 v[132:135], a[136:139], v[188:191], 0
    v_add_f32 v219, v219, v173
    v_add_f32 v214, v214, v174
    v_mfma_f32_16x16x32_bf16 v[152:155], a[140:143], v[188:191], 0
    s_waitcnt vmcnt(21)
    v_add_f32 v219, v219, v175
    v_mfma_f32_16x16x32_bf16 v[168:171], a[80:83], a[64:67], v[208:211]
    ds_read_b128 a[80:83], v222 offset:8192
    v_exp_f32 v176, v176
    v_mfma_f32_16x16x32_bf16 v[172:175], a[96:99], a[64:67], v[208:211]
    ds_read_b128 a[96:99], v222 offset:12288
    v_exp_f32 v177, v177
    v_mfma_f32_16x16x32_bf16 v[168:171], a[84:87], a[68:71], v[168:171]
    ds_read_b128 a[84:87], v223 offset:8192
    v_cvt_pk_bf16_f32 v188, v176, v177
    v_add_f32 v215, v215, v176
    v_mfma_f32_16x16x32_bf16 v[172:175], a[100:103], a[68:71], v[172:175]
    ds_read_b128 a[100:103], v223 offset:12288
    v_exp_f32 v178, v178
    v_mfma_f32_16x16x32_bf16 v[168:171], a[88:91], a[72:75], v[168:171]
    ds_read_b128 a[88:91], v224 offset:8192
    v_add_f32 v220, v220, v177
    v_add_f32 v215, v215, v178
    v_mfma_f32_16x16x32_bf16 v[172:175], a[104:107], a[72:75], v[172:175]
    ds_read_b128 a[104:107], v224 offset:12288
    v_exp_f32 v179, v179
    v_mfma_f32_16x16x32_bf16 v[168:171], a[92:95], a[76:79], v[168:171]
    ds_read_b128 a[92:95], v225 offset:8192
    v_cvt_pk_bf16_f32 v189, v178, v179
    v_add_f32 v220, v220, v179
    v_mfma_f32_16x16x32_bf16 v[172:175], a[108:111], a[76:79], v[172:175]
    ds_read_b128 a[108:111], v225 offset:12288
    v_exp_f32 v180, v180
    v_mfma_f32_16x16x32_bf16 v[16:19], a[112:115], v[184:187], 0
    v_exp_f32 v181, v181
    v_add_f32 v215, v215, v180
    v_mfma_f32_16x16x32_bf16 v[36:39], a[116:119], v[184:187], 0
    buffer_load_dwordx4 v237, s[12:15], s70 offen offset:1024 nt lds
    v_mfma_f32_16x16x32_bf16 v[56:59], a[120:123], v[184:187], 0
    v_exp_f32 v182, v182
    v_cvt_pk_bf16_f32 v190, v180, v181
    v_mfma_f32_16x16x32_bf16 v[76:79], a[124:127], v[184:187], 0
    v_exp_f32 v183, v183
    v_mfma_f32_16x16x32_bf16 v[96:99], a[128:131], v[184:187], 0
    buffer_load_dwordx4 v236, s[12:15], s70 offen offset:2048 nt lds
    v_mfma_f32_16x16x32_bf16 v[116:119], a[132:135], v[184:187], 0
    v_cvt_pk_bf16_f32 v191, v182, v183
    v_add_f32 v220, v220, v181
    v_mfma_f32_16x16x32_bf16 v[136:139], a[136:139], v[184:187], 0
    buffer_load_dwordx4 v237, s[12:15], s70 offen offset:3072 nt lds
    v_mfma_f32_16x16x32_bf16 v[156:159], a[140:143], v[184:187], 0
    s_waitcnt lgkmcnt(0)
    v_add_f32 v215, v215, v182
    v_add_f32 v220, v220, v183
    v_mfma_f32_16x16x32_bf16 v[176:179], a[80:83], a[0:3], v[192:195]
    s_mov_b32 m0, s64
    v_exp_f32 v168, v168
    v_exp_f32 v169, v169
    v_mfma_f32_16x16x32_bf16 v[180:183], a[96:99], a[0:3], v[192:195]
    buffer_load_dwordx4 v234, s[8:11], s71 offen offset:0 nt lds
    v_mfma_f32_16x16x32_bf16 v[176:179], a[84:87], a[4:7], v[176:179]
    v_cvt_pk_bf16_f32 v184, v168, v169
    v_add_f32 v216, v216, v168
    v_add_f32 v221, v221, v169
    v_mfma_f32_16x16x32_bf16 v[180:183], a[100:103], a[4:7], v[180:183]
    v_exp_f32 v170, v170
    v_exp_f32 v171, v171
    v_mfma_f32_16x16x32_bf16 v[176:179], a[88:91], a[8:11], v[176:179]
    buffer_load_dwordx4 v235, s[8:11], s71 offen offset:1024 nt lds
    v_mfma_f32_16x16x32_bf16 v[180:183], a[104:107], a[8:11], v[180:183]
    v_cvt_pk_bf16_f32 v185, v170, v171
    v_add_f32 v216, v216, v170
    v_add_f32 v221, v221, v171
    v_mfma_f32_16x16x32_bf16 v[176:179], a[92:95], a[12:15], v[176:179]
    v_exp_f32 v172, v172
    v_exp_f32 v173, v173
    v_mfma_f32_16x16x32_bf16 v[180:183], a[108:111], a[12:15], v[180:183]
    buffer_load_dwordx4 v234, s[8:11], s71 offen offset:2048 nt lds
    v_mfma_f32_16x16x32_bf16 v[20:23], a[112:115], v[188:191], 0
    v_cvt_pk_bf16_f32 v186, v172, v173
    v_add_f32 v216, v216, v172
    v_add_f32 v221, v221, v173
    v_mfma_f32_16x16x32_bf16 v[40:43], a[116:119], v[188:191], 0
    v_exp_f32 v174, v174
    v_mfma_f32_16x16x32_bf16 v[60:63], a[120:123], v[188:191], 0
    buffer_load_dwordx4 v235, s[8:11], s71 offen offset:3072 nt lds
    v_mfma_f32_16x16x32_bf16 v[80:83], a[124:127], v[188:191], 0
    v_exp_f32 v175, v175
    v_mfma_f32_16x16x32_bf16 v[100:103], a[128:131], v[188:191], 0
    s_mov_b32 m0, s65
    v_cvt_pk_bf16_f32 v187, v174, v175
    v_add_f32 v216, v216, v174
    v_mfma_f32_16x16x32_bf16 v[120:123], a[132:135], v[188:191], 0
    buffer_load_dwordx4 v236, s[8:11], s71 offen offset:0 nt lds
    v_mfma_f32_16x16x32_bf16 v[140:143], a[136:139], v[188:191], 0
    v_add_f32 v221, v221, v175
    v_mfma_f32_16x16x32_bf16 v[160:163], a[140:143], v[188:191], 0
    v_mfma_f32_16x16x32_bf16 v[168:171], a[80:83], a[16:19], v[196:199]
    buffer_load_dwordx4 v237, s[8:11], s71 offen offset:1024 nt lds
    v_mfma_f32_16x16x32_bf16 v[172:175], a[96:99], a[16:19], v[196:199]
    v_exp_f32 v176, v176
    v_exp_f32 v177, v177
    v_mfma_f32_16x16x32_bf16 v[168:171], a[84:87], a[20:23], v[168:171]
    v_cvt_pk_bf16_f32 v188, v176, v177
    v_add_f32 v212, v212, v176
    v_add_f32 v217, v217, v177
    v_mfma_f32_16x16x32_bf16 v[172:175], a[100:103], a[20:23], v[172:175]
    buffer_load_dwordx4 v236, s[8:11], s71 offen offset:2048 nt lds
    v_mfma_f32_16x16x32_bf16 v[168:171], a[88:91], a[24:27], v[168:171]
    v_exp_f32 v178, v178
    v_mfma_f32_16x16x32_bf16 v[172:175], a[104:107], a[24:27], v[172:175]
    v_exp_f32 v179, v179
    v_mfma_f32_16x16x32_bf16 v[168:171], a[92:95], a[28:31], v[168:171]
    buffer_load_dwordx4 v237, s[8:11], s71 offen offset:3072 nt lds
    v_mfma_f32_16x16x32_bf16 v[172:175], a[108:111], a[28:31], v[172:175]
    s_waitcnt vmcnt(24)
    v_cvt_pk_bf16_f32 v189, v178, v179
    v_add_f32 v212, v212, v178
    v_mfma_f32_16x16x32_bf16 v[24:27], a[112:115], v[184:187], 0
    ds_read_b64_tr_b16 a[112:113], v226 offset:8192
    ds_read_b64_tr_b16 a[114:115], v226 offset:12288
    v_exp_f32 v180, v180
    v_mfma_f32_16x16x32_bf16 v[44:47], a[116:119], v[184:187], 0
    ds_read_b64_tr_b16 a[116:117], v227 offset:8192
    ds_read_b64_tr_b16 a[118:119], v227 offset:12288
    v_add_f32 v217, v217, v179
    v_add_f32 v212, v212, v180
    v_mfma_f32_16x16x32_bf16 v[64:67], a[120:123], v[184:187], 0
    ds_read_b64_tr_b16 a[120:121], v228 offset:8192
    ds_read_b64_tr_b16 a[122:123], v228 offset:12288
    v_exp_f32 v181, v181
    v_mfma_f32_16x16x32_bf16 v[84:87], a[124:127], v[184:187], 0
    ds_read_b64_tr_b16 a[124:125], v229 offset:8192
    ds_read_b64_tr_b16 a[126:127], v229 offset:12288
    v_exp_f32 v182, v182
    v_mfma_f32_16x16x32_bf16 v[104:107], a[128:131], v[184:187], 0
    s_mov_b32 s70, s71
    ds_read_b64_tr_b16 a[128:129], v230 offset:8192
    ds_read_b64_tr_b16 a[130:131], v230 offset:12288
    v_exp_f32 v183, v183
    v_mfma_f32_16x16x32_bf16 v[124:127], a[132:135], v[184:187], 0
    s_add_u32 s71, s71, 8192
    ds_read_b64_tr_b16 a[132:133], v231 offset:8192
    ds_read_b64_tr_b16 a[134:135], v231 offset:12288
    v_cvt_pk_bf16_f32 v190, v180, v181
    v_cvt_pk_bf16_f32 v191, v182, v183
    v_mfma_f32_16x16x32_bf16 v[144:147], a[136:139], v[184:187], 0
    ds_read_b64_tr_b16 a[136:137], v232 offset:8192
    ds_read_b64_tr_b16 a[138:139], v232 offset:12288
    v_add_f32 v217, v217, v181
    v_add_f32 v212, v212, v182
    v_mfma_f32_16x16x32_bf16 v[164:167], a[140:143], v[184:187], 0
    ds_read_b64_tr_b16 a[140:141], v233 offset:8192
    ds_read_b64_tr_b16 a[142:143], v233 offset:12288
    v_add_f32 v217, v217, v183
    v_mfma_f32_16x16x32_bf16 v[176:179], a[80:83], a[32:35], v[200:203]
    v_exp_f32 v168, v168
    v_mfma_f32_16x16x32_bf16 v[180:183], a[96:99], a[32:35], v[200:203]
    v_exp_f32 v169, v169
    v_mfma_f32_16x16x32_bf16 v[176:179], a[84:87], a[36:39], v[176:179]
    s_and_b32 s71, s71, 262143
    v_cvt_pk_bf16_f32 v184, v168, v169
    v_add_f32 v213, v213, v168
    v_mfma_f32_16x16x32_bf16 v[180:183], a[100:103], a[36:39], v[180:183]
    v_exp_f32 v170, v170
    v_mfma_f32_16x16x32_bf16 v[176:179], a[88:91], a[40:43], v[176:179]
    v_add_f32 v218, v218, v169
    v_add_f32 v213, v213, v170
    v_mfma_f32_16x16x32_bf16 v[180:183], a[104:107], a[40:43], v[180:183]
    v_exp_f32 v171, v171
    v_mfma_f32_16x16x32_bf16 v[176:179], a[92:95], a[44:47], v[176:179]
    v_cvt_pk_bf16_f32 v185, v170, v171
    v_add_f32 v218, v218, v171
    v_mfma_f32_16x16x32_bf16 v[180:183], a[108:111], a[44:47], v[180:183]
    s_waitcnt lgkmcnt(0)
    v_exp_f32 v172, v172
    v_mfma_f32_16x16x32_bf16 v[8:11], a[112:115], v[188:191], v[8:11]
    s_mov_b32 m0, s68
    v_exp_f32 v173, v173
    v_mfma_f32_16x16x32_bf16 v[28:31], a[116:119], v[188:191], v[28:31]
    buffer_load_dwordx4 v234, s[12:15], s70 offen offset:0 nt lds
    v_mfma_f32_16x16x32_bf16 v[48:51], a[120:123], v[188:191], v[48:51]
    v_exp_f32 v174, v174
    v_mfma_f32_16x16x32_bf16 v[68:71], a[124:127], v[188:191], v[68:71]
    v_exp_f32 v175, v175
    v_mfma_f32_16x16x32_bf16 v[88:91], a[128:131], v[188:191], v[88:91]
    v_cvt_pk_bf16_f32 v186, v172, v173
    v_cvt_pk_bf16_f32 v187, v174, v175
    v_mfma_f32_16x16x32_bf16 v[108:111], a[132:135], v[188:191], v[108:111]
    v_add_f32 v213, v213, v172
    v_add_f32 v218, v218, v173
    v_mfma_f32_16x16x32_bf16 v[128:131], a[136:139], v[188:191], v[128:131]
    buffer_load_dwordx4 v235, s[12:15], s70 offen offset:1024 nt lds
    v_mfma_f32_16x16x32_bf16 v[148:151], a[140:143], v[188:191], v[148:151]
    v_add_f32 v213, v213, v174
    v_add_f32 v218, v218, v175
    v_mfma_f32_16x16x32_bf16 v[168:171], a[80:83], a[48:51], v[204:207]
    v_exp_f32 v176, v176
    v_exp_f32 v177, v177
    v_mfma_f32_16x16x32_bf16 v[172:175], a[96:99], a[48:51], v[204:207]
    v_cvt_pk_bf16_f32 v188, v176, v177
    v_add_f32 v214, v214, v176
    v_add_f32 v219, v219, v177
    v_mfma_f32_16x16x32_bf16 v[168:171], a[84:87], a[52:55], v[168:171]
    v_exp_f32 v178, v178
    v_mfma_f32_16x16x32_bf16 v[172:175], a[100:103], a[52:55], v[172:175]
    buffer_load_dwordx4 v234, s[12:15], s70 offen offset:2048 nt lds
    v_mfma_f32_16x16x32_bf16 v[168:171], a[88:91], a[56:59], v[168:171]
    v_exp_f32 v179, v179
    v_mfma_f32_16x16x32_bf16 v[172:175], a[104:107], a[56:59], v[172:175]
    v_cvt_pk_bf16_f32 v189, v178, v179
    v_add_f32 v214, v214, v178
    v_mfma_f32_16x16x32_bf16 v[168:171], a[92:95], a[60:63], v[168:171]
    v_exp_f32 v180, v180
    v_mfma_f32_16x16x32_bf16 v[172:175], a[108:111], a[60:63], v[172:175]
    v_add_f32 v219, v219, v179
    v_add_f32 v214, v214, v180
    v_mfma_f32_16x16x32_bf16 v[12:15], a[112:115], v[184:187], v[12:15]
    buffer_load_dwordx4 v235, s[12:15], s70 offen offset:3072 nt lds
    v_mfma_f32_16x16x32_bf16 v[32:35], a[116:119], v[184:187], v[32:35]
    v_exp_f32 v181, v181
    v_mfma_f32_16x16x32_bf16 v[52:55], a[120:123], v[184:187], v[52:55]
    v_exp_f32 v182, v182
    v_mfma_f32_16x16x32_bf16 v[72:75], a[124:127], v[184:187], v[72:75]
    v_exp_f32 v183, v183
    v_mfma_f32_16x16x32_bf16 v[92:95], a[128:131], v[184:187], v[92:95]
    s_mov_b32 m0, s69
    s_or_b32 s75, s3, s73
    s_cmp_lg_u32 s75, 0
    s_cbranch_scc1 L_noann1
    s_add_u32 s32, s58, 0
    s_addc_u32 s33, s59, 0
    s_and_b32 s33, s33, 0xffff
    s_mov_b32 s34, 256
    s_mov_b32 s35, 0x20000
    s_mov_b64 exec, 1
    v_mov_b32 v249, 0
    v_mov_b32 v250, 1
    buffer_atomic_add v250, v249, s[32:35], 0 offen sc1
    s_mov_b64 exec, -1
L_noann1:
    v_cvt_pk_bf16_f32 v190, v180, v181
    v_cvt_pk_bf16_f32 v191, v182, v183
    v_mfma_f32_16x16x32_bf16 v[112:115], a[132:135], v[184:187], v[112:115]
    buffer_load_dwordx4 v236, s[12:15], s70 offen offset:0 nt lds
    v_mfma_f32_16x16x32_bf16 v[132:135], a[136:139], v[184:187], v[132:135]
    v_add_f32 v219, v219, v181
    v_add_f32 v214, v214, v182
    v_mfma_f32_16x16x32_bf16 v[152:155], a[140:143], v[184:187], v[152:155]
    s_waitcnt vmcnt(21)
    v_add_f32 v219, v219, v183
    v_mfma_f32_16x16x32_bf16 v[176:179], a[80:83], a[64:67], v[208:211]
    ds_read_b128 a[80:83], v222 offset:0
    v_exp_f32 v168, v168
    v_mfma_f32_16x16x32_bf16 v[180:183], a[96:99], a[64:67], v[208:211]
    ds_read_b128 a[96:99], v222 offset:4096
    v_exp_f32 v169, v169
    v_mfma_f32_16x16x32_bf16 v[176:179], a[84:87], a[68:71], v[176:179]
    ds_read_b128 a[84:87], v223 offset:0
    v_cvt_pk_bf16_f32 v184, v168, v169
    v_add_f32 v215, v215, v168
    v_mfma_f32_16x16x32_bf16 v[180:183], a[100:103], a[68:71], v[180:183]
    ds_read_b128 a[100:103], v223 offset:4096
    v_exp_f32 v170, v170
    v_mfma_f32_16x16x32_bf16 v[176:179], a[88:91], a[72:75], v[176:179]
    ds_read_b128 a[88:91], v224 offset:0
    v_add_f32 v220, v220, v169
    v_add_f32 v215, v215, v170
    v_mfma_f32_16x16x32_bf16 v[180:183], a[104:107], a[72:75], v[180:183]
    ds_read_b128 a[104:107], v224 offset:4096
    v_exp_f32 v171, v171
    v_mfma_f32_16x16x32_bf16 v[176:179], a[92:95], a[76:79], v[176:179]
    ds_read_b128 a[92:95], v225 offset:0
    v_cvt_pk_bf16_f32 v185, v170, v171
    v_add_f32 v220, v220, v171
    v_mfma_f32_16x16x32_bf16 v[180:183], a[108:111], a[76:79], v[180:183]
    ds_read_b128 a[108:111], v225 offset:4096
    v_exp_f32 v172, v172
    v_mfma_f32_16x16x32_bf16 v[16:19], a[112:115], v[188:191], v[16:19]
    v_exp_f32 v173, v173
    v_add_f32 v215, v215, v172
    v_mfma_f32_16x16x32_bf16 v[36:39], a[116:119], v[188:191], v[36:39]
    buffer_load_dwordx4 v237, s[12:15], s70 offen offset:1024 nt lds
    v_mfma_f32_16x16x32_bf16 v[56:59], a[120:123], v[188:191], v[56:59]
    v_exp_f32 v174, v174
    v_cvt_pk_bf16_f32 v186, v172, v173
    v_mfma_f32_16x16x32_bf16 v[76:79], a[124:127], v[188:191], v[76:79]
    v_exp_f32 v175, v175
    v_mfma_f32_16x16x32_bf16 v[96:99], a[128:131], v[188:191], v[96:99]
    buffer_load_dwordx4 v236, s[12:15], s70 offen offset:2048 nt lds
    v_mfma_f32_16x16x32_bf16 v[116:119], a[132:135], v[188:191], v[116:119]
    v_cvt_pk_bf16_f32 v187, v174, v175
    v_add_f32 v220, v220, v173
    v_mfma_f32_16x16x32_bf16 v[136:139], a[136:139], v[188:191], v[136:139]
    buffer_load_dwordx4 v237, s[12:15], s70 offen offset:3072 nt lds
    v_mfma_f32_16x16x32_bf16 v[156:159], a[140:143], v[188:191], v[156:159]
    s_waitcnt lgkmcnt(0)
    v_add_f32 v215, v215, v174
    v_add_f32 v220, v220, v175
    v_mfma_f32_16x16x32_bf16 v[168:171], a[80:83], a[0:3], v[192:195]
    s_mov_b32 m0, s62
    v_exp_f32 v176, v176
    v_exp_f32 v177, v177
    v_mfma_f32_16x16x32_bf16 v[172:175], a[96:99], a[0:3], v[192:195]
    buffer_load_dwordx4 v234, s[8:11], s71 offen offset:0 nt lds
    v_mfma_f32_16x16x32_bf16 v[168:171], a[84:87], a[4:7], v[168:171]
    v_cvt_pk_bf16_f32 v188, v176, v177
    v_add_f32 v216, v216, v176
    v_add_f32 v221, v221, v177
    v_mfma_f32_16x16x32_bf16 v[172:175], a[100:103], a[4:7], v[172:175]
    v_exp_f32 v178, v178
    v_exp_f32 v179, v179
    v_mfma_f32_16x16x32_bf16 v[168:171], a[88:91], a[8:11], v[168:171]
    buffer_load_dwordx4 v235, s[8:11], s71 offen offset:1024 nt lds
    v_mfma_f32_16x16x32_bf16 v[172:175], a[104:107], a[8:11], v[172:175]
    v_cvt_pk_bf16_f32 v189, v178, v179
    v_add_f32 v216, v216, v178
    v_add_f32 v221, v221, v179
    v_mfma_f32_16x16x32_bf16 v[168:171], a[92:95], a[12:15], v[168:171]
    v_exp_f32 v180, v180
    v_exp_f32 v181, v181
    v_mfma_f32_16x16x32_bf16 v[172:175], a[108:111], a[12:15], v[172:175]
    buffer_load_dwordx4 v234, s[8:11], s71 offen offset:2048 nt lds
    v_mfma_f32_16x16x32_bf16 v[20:23], a[112:115], v[184:187], v[20:23]
    v_cvt_pk_bf16_f32 v190, v180, v181
    v_add_f32 v216, v216, v180
    v_add_f32 v221, v221, v181
    v_mfma_f32_16x16x32_bf16 v[40:43], a[116:119], v[184:187], v[40:43]
    v_exp_f32 v182, v182
    v_mfma_f32_16x16x32_bf16 v[60:63], a[120:123], v[184:187], v[60:63]
    buffer_load_dwordx4 v235, s[8:11], s71 offen offset:3072 nt lds
    v_mfma_f32_16x16x32_bf16 v[80:83], a[124:127], v[184:187], v[80:83]
    v_exp_f32 v183, v183
    v_mfma_f32_16x16x32_bf16 v[100:103], a[128:131], v[184:187], v[100:103]
    s_mov_b32 m0, s63
    v_cvt_pk_bf16_f32 v191, v182, v183
    v_add_f32 v216, v216, v182
    v_mfma_f32_16x16x32_bf16 v[120:123], a[132:135], v[184:187], v[120:123]
    buffer_load_dwordx4 v236, s[8:11], s71 offen offset:0 nt lds
    v_mfma_f32_16x16x32_bf16 v[140:143], a[136:139], v[184:187], v[140:143]
    v_add_f32 v221, v221, v183
    v_mfma_f32_16x16x32_bf16 v[160:163], a[140:143], v[184:187], v[160:163]
    v_mfma_f32_16x16x32_bf16 v[176:179], a[80:83], a[16:19], v[196:199]
    buffer_load_dwordx4 v237, s[8:11], s71 offen offset:1024 nt lds
    v_mfma_f32_16x16x32_bf16 v[180:183], a[96:99], a[16:19], v[196:199]
    v_exp_f32 v168, v168
    v_exp_f32 v169, v169
    v_mfma_f32_16x16x32_bf16 v[176:179], a[84:87], a[20:23], v[176:179]
    v_cvt_pk_bf16_f32 v184, v168, v169
    v_add_f32 v212, v212, v168
    v_add_f32 v217, v217, v169
    v_mfma_f32_16x16x32_bf16 v[180:183], a[100:103], a[20:23], v[180:183]
    buffer_load_dwordx4 v236, s[8:11], s71 offen offset:2048 nt lds
    v_mfma_f32_16x16x32_bf16 v[176:179], a[88:91], a[24:27], v[176:179]
    v_exp_f32 v170, v170
    v_mfma_f32_16x16x32_bf16 v[180:183], a[104:107], a[24:27], v[180:183]
    v_exp_f32 v171, v171
    v_mfma_f32_16x16x32_bf16 v[176:179], a[92:95], a[28:31], v[176:179]
    buffer_load_dwordx4 v237, s[8:11], s71 offen offset:3072 nt lds
    v_mfma_f32_16x16x32_bf16 v[180:183], a[108:111], a[28:31], v[180:183]
    s_waitcnt vmcnt(24)
    v_cvt_pk_bf16_f32 v185, v170, v171
    v_add_f32 v212, v212, v170
    v_mfma_f32_16x16x32_bf16 v[24:27], a[112:115], v[188:191], v[24:27]
    s_cmp_lg_u32 s73, 0
    ds_read_b64_tr_b16 a[112:113], v226 offset:0
    ds_read_b64_tr_b16 a[114:115], v226 offset:4096
    v_exp_f32 v172, v172
    v_mfma_f32_16x16x32_bf16 v[44:47], a[116:119], v[188:191], v[44:47]
    s_cbranch_scc1 L_nobar1
    s_barrier
L_nobar1:
    ds_read_b64_tr_b16 a[116:117], v227 offset:0
    ds_read_b64_tr_b16 a[118:119], v227 offset:4096
    v_add_f32 v217, v217, v171
    v_add_f32 v212, v212, v172
    v_mfma_f32_16x16x32_bf16 v[64:67], a[120:123], v[188:191], v[64:67]
    ds_read_b64_tr_b16 a[120:121], v228 offset:0
    ds_read_b64_tr_b16 a[122:123], v228 offset:4096
    v_exp_f32 v173, v173
    v_mfma_f32_16x16x32_bf16 v[84:87], a[124:127], v[188:191], v[84:87]
    ds_read_b64_tr_b16 a[124:125], v229 offset:0
    ds_read_b64_tr_b16 a[126:127], v229 offset:4096
    v_exp_f32 v174, v174
    v_mfma_f32_16x16x32_bf16 v[104:107], a[128:131], v[188:191], v[104:107]
    s_mov_b32 s70, s71
    ds_read_b64_tr_b16 a[128:129], v230 offset:0
    ds_read_b64_tr_b16 a[130:131], v230 offset:4096
    v_exp_f32 v175, v175
    v_mfma_f32_16x16x32_bf16 v[124:127], a[132:135], v[188:191], v[124:127]
    s_add_u32 s71, s71, 8192
    ds_read_b64_tr_b16 a[132:133], v231 offset:0
    ds_read_b64_tr_b16 a[134:135], v231 offset:4096
    v_cvt_pk_bf16_f32 v186, v172, v173
    v_cvt_pk_bf16_f32 v187, v174, v175
    v_mfma_f32_16x16x32_bf16 v[144:147], a[136:139], v[188:191], v[144:147]
    ds_read_b64_tr_b16 a[136:137], v232 offset:0
    ds_read_b64_tr_b16 a[138:139], v232 offset:4096
    v_add_f32 v217, v217, v173
    v_add_f32 v212, v212, v174
    v_mfma_f32_16x16x32_bf16 v[164:167], a[140:143], v[188:191], v[164:167]
    ds_read_b64_tr_b16 a[140:141], v233 offset:0
    ds_read_b64_tr_b16 a[142:143], v233 offset:4096
    v_add_f32 v217, v217, v175
    s_mov_b32 s72, 0
.p2align 6
L_loop:
    v_mfma_f32_16x16x32_bf16 v[168:171], a[80:83], a[32:35], v[200:203]
    v_exp_f32 v176, v176
    v_mfma_f32_16x16x32_bf16 v[172:175], a[96:99], a[32:35], v[200:203]
    v_exp_f32 v177, v177
    v_mfma_f32_16x16x32_bf16 v[168:171], a[84:87], a[36:39], v[168:171]
    s_and_b32 s71, s71, 262143
    v_cvt_pk_bf16_f32 v188, v176, v177
    v_add_f32 v213, v213, v176
    v_mfma_f32_16x16x32_bf16 v[172:175], a[100:103], a[36:39], v[172:175]
    v_exp_f32 v178, v178
    v_mfma_f32_16x16x32_bf16 v[168:171], a[88:91], a[40:43], v[168:171]
    v_add_f32 v218, v218, v177
    v_add_f32 v213, v213, v178
    v_mfma_f32_16x16x32_bf16 v[172:175], a[104:107], a[40:43], v[172:175]
    v_exp_f32 v179, v179
    v_mfma_f32_16x16x32_bf16 v[168:171], a[92:95], a[44:47], v[168:171]
    v_cvt_pk_bf16_f32 v189, v178, v179
    v_add_f32 v218, v218, v179
    v_mfma_f32_16x16x32_bf16 v[172:175], a[108:111], a[44:47], v[172:175]
    s_waitcnt lgkmcnt(0)
    v_exp_f32 v180, v180
    v_mfma_f32_16x16x32_bf16 v[8:11], a[112:115], v[184:187], v[8:11]
    s_mov_b32 m0, s66
    v_exp_f32 v181, v181
    v_mfma_f32_16x16x32_bf16 v[28:31], a[116:119], v[184:187], v[28:31]
    buffer_load_dwordx4 v234, s[12:15], s70 offen offset:0 nt lds
    v_mfma_f32_16x16x32_bf16 v[48:51], a[120:123], v[184:187], v[48:51]
    v_exp_f32 v182, v182
    v_mfma_f32_16x16x32_bf16 v[68:71], a[124:127], v[184:187], v[68:71]
    v_exp_f32 v183, v183
    v_mfma_f32_16x16x32_bf16 v[88:91], a[128:131], v[184:187], v[88:91]
    v_cvt_pk_bf16_f32 v190, v180, v181
    v_cvt_pk_bf16_f32 v191, v182, v183
    v_mfma_f32_16x16x32_bf16 v[108:111], a[132:135], v[184:187], v[108:111]
    v_add_f32 v213, v213, v180
    v_add_f32 v218, v218, v181
    v_mfma_f32_16x16x32_bf16 v[128:131], a[136:139], v[184:187], v[128:131]
    buffer_load_dwordx4 v235, s[12:15], s70 offen offset:1024 nt lds
    v_mfma_f32_16x16x32_bf16 v[148:151], a[140:143], v[184:187], v[148:151]
    v_add_f32 v213, v213, v182
    v_add_f32 v218, v218, v183
    v_mfma_f32_16x16x32_bf16 v[176:179], a[80:83], a[48:51], v[204:207]
    v_exp_f32 v168, v168
    v_exp_f32 v169, v169
    v_mfma_f32_16x16x32_bf16 v[180:183], a[96:99], a[48:51], v[204:207]
    v_cvt_pk_bf16_f32 v184, v168, v169
    v_add_f32 v214, v214, v168
    v_add_f32 v219, v219, v169
    v_mfma_f32_16x16x32_bf16 v[176:179], a[84:87], a[52:55], v[176:179]
    v_exp_f32 v170, v170
    v_mfma_f32_16x16x32_bf16 v[180:183], a[100:103], a[52:55], v[180:183]
    buffer_load_dwordx4 v234, s[12:15], s70 offen offset:2048 nt lds
    v_mfma_f32_16x16x32_bf16 v[176:179], a[88:91], a[56:59], v[176:179]
    v_exp_f32 v171, v171
    v_mfma_f32_16x16x32_bf16 v[180:183], a[104:107], a[56:59], v[180:183]
    v_cvt_pk_bf16_f32 v185, v170, v171
    v_add_f32 v214, v214, v170
    v_mfma_f32_16x16x32_bf16 v[176:179], a[92:95], a[60:63], v[176:179]
    v_exp_f32 v172, v172
    v_mfma_f32_16x16x32_bf16 v[180:183], a[108:111], a[60:63], v[180:183]
    v_add_f32 v219, v219, v171
    v_add_f32 v214, v214, v172
    v_mfma_f32_16x16x32_bf16 v[12:15], a[112:115], v[188:191], v[12:15]
    buffer_load_dwordx4 v235, s[12:15], s70 offen offset:3072 nt lds
    v_mfma_f32_16x16x32_bf16 v[32:35], a[116:119], v[188:191], v[32:35]
    v_exp_f32 v173, v173
    v_mfma_f32_16x16x32_bf16 v[52:55], a[120:123], v[188:191], v[52:55]
    v_exp_f32 v174, v174
    v_mfma_f32_16x16x32_bf16 v[72:75], a[124:127], v[188:191], v[72:75]
    v_exp_f32 v175, v175
    v_mfma_f32_16x16x32_bf16 v[92:95], a[128:131], v[188:191], v[92:95]
    s_mov_b32 m0, s67
    v_cvt_pk_bf16_f32 v186, v172, v173
    v_cvt_pk_bf16_f32 v187, v174, v175
    v_mfma_f32_16x16x32_bf16 v[112:115], a[132:135], v[188:191], v[112:115]
    buffer_load_dwordx4 v236, s[12:15], s70 offen offset:0 nt lds
    v_mfma_f32_16x16x32_bf16 v[132:135], a[136:139], v[188:191], v[132:135]
    v_add_f32 v219, v219, v173
    v_add_f32 v214, v214, v174
    v_mfma_f32_16x16x32_bf16 v[152:155], a[140:143], v[188:191], v[152:155]
    s_waitcnt vmcnt(21)
    v_add_f32 v219, v219, v175
    v_mfma_f32_16x16x32_bf16 v[168:171], a[80:83], a[64:67], v[208:211]
    ds_read_b128 a[80:83], v222 offset:8192
    v_exp_f32 v176, v176
    v_mfma_f32_16x16x32_bf16 v[172:175], a[96:99], a[64:67], v[208:211]
    ds_read_b128 a[96:99], v222 offset:12288
    v_exp_f32 v177, v177
    v_mfma_f32_16x16x32_bf16 v[168:171], a[84:87], a[68:71], v[168:171]
    ds_read_b128 a[84:87], v223 offset:8192
    v_cvt_pk_bf16_f32 v188, v176, v177
    v_add_f32 v215, v215, v176
    v_mfma_f32_16x16x32_bf16 v[172:175], a[100:103], a[68:71], v[172:175]
    ds_read_b128 a[100:103], v223 offset:12288
    v_exp_f32 v178, v178
    v_mfma_f32_16x16x32_bf16 v[168:171], a[88:91], a[72:75], v[168:171]
    ds_read_b128 a[88:91], v224 offset:8192
    v_add_f32 v220, v220, v177
    v_add_f32 v215, v215, v178
    v_mfma_f32_16x16x32_bf16 v[172:175], a[104:107], a[72:75], v[172:175]
    ds_read_b128 a[104:107], v224 offset:12288
    v_exp_f32 v179, v179
    v_mfma_f32_16x16x32_bf16 v[168:171], a[92:95], a[76:79], v[168:171]
    ds_read_b128 a[92:95], v225 offset:8192
    v_cvt_pk_bf16_f32 v189, v178, v179
    v_add_f32 v220, v220, v179
    v_mfma_f32_16x16x32_bf16 v[172:175], a[108:111], a[76:79], v[172:175]
    ds_read_b128 a[108:111], v225 offset:12288
    v_exp_f32 v180, v180
    v_mfma_f32_16x16x32_bf16 v[16:19], a[112:115], v[184:187], v[16:19]
    v_exp_f32 v181, v181
    v_add_f32 v215, v215, v180
    v_mfma_f32_16x16x32_bf16 v[36:39], a[116:119], v[184:187], v[36:39]
    buffer_load_dwordx4 v237, s[12:15], s70 offen offset:1024 nt lds
    v_mfma_f32_16x16x32_bf16 v[56:59], a[120:123], v[184:187], v[56:59]
    v_exp_f32 v182, v182
    v_cvt_pk_bf16_f32 v190, v180, v181
    v_mfma_f32_16x16x32_bf16 v[76:79], a[124:127], v[184:187], v[76:79]
    v_exp_f32 v183, v183
    v_mfma_f32_16x16x32_bf16 v[96:99], a[128:131], v[184:187], v[96:99]
    buffer_load_dwordx4 v236, s[12:15], s70 offen offset:2048 nt lds
    v_mfma_f32_16x16x32_bf16 v[116:119], a[132:135], v[184:187], v[116:119]
    v_cvt_pk_bf16_f32 v191, v182, v183
    v_add_f32 v220, v220, v181
    v_mfma_f32_16x16x32_bf16 v[136:139], a[136:139], v[184:187], v[136:139]
    buffer_load_dwordx4 v237, s[12:15], s70 offen offset:3072 nt lds
    v_mfma_f32_16x16x32_bf16 v[156:159], a[140:143], v[184:187], v[156:159]
    s_waitcnt lgkmcnt(0)
    v_add_f32 v215, v215, v182
    v_add_f32 v220, v220, v183
    v_mfma_f32_16x16x32_bf16 v[176:179], a[80:83], a[0:3], v[192:195]
    s_mov_b32 m0, s64
    v_exp_f32 v168, v168
    v_exp_f32 v169, v169
    v_mfma_f32_16x16x32_bf16 v[180:183], a[96:99], a[0:3], v[192:195]
    buffer_load_dwordx4 v234, s[8:11], s71 offen offset:0 nt lds
    v_mfma_f32_16x16x32_bf16 v[176:179], a[84:87], a[4:7], v[176:179]
    v_cvt_pk_bf16_f32 v184, v168, v169
    v_add_f32 v216, v216, v168
    v_add_f32 v221, v221, v169
    v_mfma_f32_16x16x32_bf16 v[180:183], a[100:103], a[4:7], v[180:183]
    v_exp_f32 v170, v170
    v_exp_f32 v171, v171
    v_mfma_f32_16x16x32_bf16 v[176:179], a[88:91], a[8:11], v[176:179]
    buffer_load_dwordx4 v235, s[8:11], s71 offen offset:1024 nt lds
    v_mfma_f32_16x16x32_bf16 v[180:183], a[104:107], a[8:11], v[180:183]
    v_cvt_pk_bf16_f32 v185, v170, v171
    v_add_f32 v216, v216, v170
    v_add_f32 v221, v221, v171
    v_mfma_f32_16x16x32_bf16 v[176:179], a[92:95], a[12:15], v[176:179]
    v_exp_f32 v172, v172
    v_exp_f32 v173, v173
    v_mfma_f32_16x16x32_bf16 v[180:183], a[108:111], a[12:15], v[180:183]
    buffer_load_dwordx4 v234, s[8:11], s71 offen offset:2048 nt lds
    v_mfma_f32_16x16x32_bf16 v[20:23], a[112:115], v[188:191], v[20:23]
    v_cvt_pk_bf16_f32 v186, v172, v173
    v_add_f32 v216, v216, v172
    v_add_f32 v221, v221, v173
    v_mfma_f32_16x16x32_bf16 v[40:43], a[116:119], v[188:191], v[40:43]
    v_exp_f32 v174, v174
    v_mfma_f32_16x16x32_bf16 v[60:63], a[120:123], v[188:191], v[60:63]
    buffer_load_dwordx4 v235, s[8:11], s71 offen offset:3072 nt lds
    v_mfma_f32_16x16x32_bf16 v[80:83], a[124:127], v[188:191], v[80:83]
    v_exp_f32 v175, v175
    v_mfma_f32_16x16x32_bf16 v[100:103], a[128:131], v[188:191], v[100:103]
    s_mov_b32 m0, s65
    v_cvt_pk_bf16_f32 v187, v174, v175
    v_add_f32 v216, v216, v174
    v_mfma_f32_16x16x32_bf16 v[120:123], a[132:135], v[188:191], v[120:123]
    buffer_load_dwordx4 v236, s[8:11], s71 offen offset:0 nt lds
    v_mfma_f32_16x16x32_bf16 v[140:143], a[136:139], v[188:191], v[140:143]
    v_add_f32 v221, v221, v175
    v_mfma_f32_16x16x32_bf16 v[160:163], a[140:143], v[188:191], v[160:163]
    v_mfma_f32_16x16x32_bf16 v[168:171], a[80:83], a[16:19], v[196:199]
    buffer_load_dwordx4 v237, s[8:11], s71 offen offset:1024 nt lds
    v_mfma_f32_16x16x32_bf16 v[172:175], a[96:99], a[16:19], v[196:199]
    v_exp_f32 v176, v176
    v_exp_f32 v177, v177
    v_mfma_f32_16x16x32_bf16 v[168:171], a[84:87], a[20:23], v[168:171]
    v_cvt_pk_bf16_f32 v188, v176, v177
    v_add_f32 v212, v212, v176
    v_add_f32 v217, v217, v177
    v_mfma_f32_16x16x32_bf16 v[172:175], a[100:103], a[20:23], v[172:175]
    buffer_load_dwordx4 v236, s[8:11], s71 offen offset:2048 nt lds
    v_mfma_f32_16x16x32_bf16 v[168:171], a[88:91], a[24:27], v[168:171]
    v_exp_f32 v178, v178
    v_mfma_f32_16x16x32_bf16 v[172:175], a[104:107], a[24:27], v[172:175]
    v_exp_f32 v179, v179
    v_mfma_f32_16x16x32_bf16 v[168:171], a[92:95], a[28:31], v[168:171]
    buffer_load_dwordx4 v237, s[8:11], s71 offen offset:3072 nt lds
    v_mfma_f32_16x16x32_bf16 v[172:175], a[108:111], a[28:31], v[172:175]
    s_waitcnt vmcnt(24)
    v_cvt_pk_bf16_f32 v189, v178, v179
    v_add_f32 v212, v212, v178
    v_mfma_f32_16x16x32_bf16 v[24:27], a[112:115], v[184:187], v[24:27]
    ds_read_b64_tr_b16 a[112:113], v226 offset:8192
    ds_read_b64_tr_b16 a[114:115], v226 offset:12288
    v_exp_f32 v180, v180
    v_mfma_f32_16x16x32_bf16 v[44:47], a[116:119], v[184:187], v[44:47]
    ds_read_b64_tr_b16 a[116:117], v227 offset:8192
    ds_read_b64_tr_b16 a[118:119], v227 offset:12288
    v_add_f32 v217, v217, v179
    v_add_f32 v212, v212, v180
    v_mfma_f32_16x16x32_bf16 v[64:67], a[120:123], v[184:187], v[64:67]
    ds_read_b64_tr_b16 a[120:121], v228 offset:8192
    ds_read_b64_tr_b16 a[122:123], v228 offset:12288
    v_exp_f32 v181, v181
    v_mfma_f32_16x16x32_bf16 v[84:87], a[124:127], v[184:187], v[84:87]
    ds_read_b64_tr_b16 a[124:125], v229 offset:8192
    ds_read_b64_tr_b16 a[126:127], v229 offset:12288
    v_exp_f32 v182, v182
    v_mfma_f32_16x16x32_bf16 v[104:107], a[128:131], v[184:187], v[104:107]
    s_mov_b32 s70, s71
    ds_read_b64_tr_b16 a[128:129], v230 offset:8192
    ds_read_b64_tr_b16 a[130:131], v230 offset:12288
    v_exp_f32 v183, v183
    v_mfma_f32_16x16x32_bf16 v[124:127], a[132:135], v[184:187], v[124:127]
    s_add_u32 s71, s71, 8192
    ds_read_b64_tr_b16 a[132:133], v231 offset:8192
    ds_read_b64_tr_b16 a[134:135], v231 offset:12288
    v_cvt_pk_bf16_f32 v190, v180, v181
    v_cvt_pk_bf16_f32 v191, v182, v183
    v_mfma_f32_16x16x32_bf16 v[144:147], a[136:139], v[184:187], v[144:147]
    ds_read_b64_tr_b16 a[136:137], v232 offset:8192
    ds_read_b64_tr_b16 a[138:139], v232 offset:12288
    v_add_f32 v217, v217, v181
    v_add_f32 v212, v212, v182
    v_mfma_f32_16x16x32_bf16 v[164:167], a[140:143], v[184:187], v[164:167]
    ds_read_b64_tr_b16 a[140:141], v233 offset:8192
    ds_read_b64_tr_b16 a[142:143], v233 offset:12288
    v_add_f32 v217, v217, v183
    v_mfma_f32_16x16x32_bf16 v[176:179], a[80:83], a[32:35], v[200:203]
    v_exp_f32 v168, v168
    v_mfma_f32_16x16x32_bf16 v[180:183], a[96:99], a[32:35], v[200:203]
    v_exp_f32 v169, v169
    v_mfma_f32_16x16x32_bf16 v[176:179], a[84:87], a[36:39], v[176:179]
    s_and_b32 s71, s71, 262143
    v_cvt_pk_bf16_f32 v184, v168, v169
    v_add_f32 v213, v213, v168
    v_mfma_f32_16x16x32_bf16 v[180:183], a[100:103], a[36:39], v[180:183]
    v_exp_f32 v170, v170
    v_mfma_f32_16x16x32_bf16 v[176:179], a[88:91], a[40:43], v[176:179]
    v_add_f32 v218, v218, v169
    v_add_f32 v213, v213, v170
    v_mfma_f32_16x16x32_bf16 v[180:183], a[104:107], a[40:43], v[180:183]
    v_exp_f32 v171, v171
    v_mfma_f32_16x16x32_bf16 v[176:179], a[92:95], a[44:47], v[176:179]
    v_cvt_pk_bf16_f32 v185, v170, v171
    v_add_f32 v218, v218, v171
    v_mfma_f32_16x16x32_bf16 v[180:183], a[108:111], a[44:47], v[180:183]
    s_waitcnt lgkmcnt(0)
    v_exp_f32 v172, v172
    v_mfma_f32_16x16x32_bf16 v[8:11], a[112:115], v[188:191], v[8:11]
    s_mov_b32 m0, s68
    v_exp_f32 v173, v173
    v_mfma_f32_16x16x32_bf16 v[28:31], a[116:119], v[188:191], v[28:31]
    buffer_load_dwordx4 v234, s[12:15], s70 offen offset:0 nt lds
    v_mfma_f32_16x16x32_bf16 v[48:51], a[120:123], v[188:191], v[48:51]
    v_exp_f32 v174, v174
    v_mfma_f32_16x16x32_bf16 v[68:71], a[124:127], v[188:191], v[68:71]
    v_exp_f32 v175, v175
    v_mfma_f32_16x16x32_bf16 v[88:91], a[128:131], v[188:191], v[88:91]
    v_cvt_pk_bf16_f32 v186, v172, v173
    v_cvt_pk_bf16_f32 v187, v174, v175
    v_mfma_f32_16x16x32_bf16 v[108:111], a[132:135], v[188:191], v[108:111]
    v_add_f32 v213, v213, v172
    v_add_f32 v218, v218, v173
    v_mfma_f32_16x16x32_bf16 v[128:131], a[136:139], v[188:191], v[128:131]
    buffer_load_dwordx4 v235, s[12:15], s70 offen offset:1024 nt lds
    v_mfma_f32_16x16x32_bf16 v[148:151], a[140:143], v[188:191], v[148:151]
    v_add_f32 v213, v213, v174
    v_add_f32 v218, v218, v175
    v_mfma_f32_16x16x32_bf16 v[168:171], a[80:83], a[48:51], v[204:207]
    v_exp_f32 v176, v176
    v_exp_f32 v177, v177
    v_mfma_f32_16x16x32_bf16 v[172:175], a[96:99], a[48:51], v[204:207]
    v_cvt_pk_bf16_f32 v188, v176, v177
    v_add_f32 v214, v214, v176
    v_add_f32 v219, v219, v177
    v_mfma_f32_16x16x32_bf16 v[168:171], a[84:87], a[52:55], v[168:171]
    v_exp_f32 v178, v178
    v_mfma_f32_16x16x32_bf16 v[172:175], a[100:103], a[52:55], v[172:175]
    buffer_load_dwordx4 v234, s[12:15], s70 offen offset:2048 nt lds
    v_mfma_f32_16x16x32_bf16 v[168:171], a[88:91], a[56:59], v[168:171]
    v_exp_f32 v179, v179
    v_mfma_f32_16x16x32_bf16 v[172:175], a[104:107], a[56:59], v[172:175]
    v_cvt_pk_bf16_f32 v189, v178, v179
    v_add_f32 v214, v214, v178
    v_mfma_f32_16x16x32_bf16 v[168:171], a[92:95], a[60:63], v[168:171]
    v_exp_f32 v180, v180
    v_mfma_f32_16x16x32_bf16 v[172:175], a[108:111], a[60:63], v[172:175]
    v_add_f32 v219, v219, v179
    v_add_f32 v214, v214, v180
    v_mfma_f32_16x16x32_bf16 v[12:15], a[112:115], v[184:187], v[12:15]
    buffer_load_dwordx4 v235, s[12:15], s70 offen offset:3072 nt lds
    v_mfma_f32_16x16x32_bf16 v[32:35], a[116:119], v[184:187], v[32:35]
    v_exp_f32 v181, v181
    v_mfma_f32_16x16x32_bf16 v[52:55], a[120:123], v[184:187], v[52:55]
    v_exp_f32 v182, v182
    v_mfma_f32_16x16x32_bf16 v[72:75], a[124:127], v[184:187], v[72:75]
    v_exp_f32 v183, v183
    v_mfma_f32_16x16x32_bf16 v[92:95], a[128:131], v[184:187], v[92:95]
    s_mov_b32 m0, s69
    v_cvt_pk_bf16_f32 v190, v180, v181
    v_cvt_pk_bf16_f32 v191, v182, v183
    v_mfma_f32_16x16x32_bf16 v[112:115], a[132:135], v[184:187], v[112:115]
    buffer_load_dwordx4 v236, s[12:15], s70 offen offset:0 nt lds
    v_mfma_f32_16x16x32_bf16 v[132:135], a[136:139], v[184:187], v[132:135]
    v_add_f32 v219, v219, v181
    v_add_f32 v214, v214, v182
    v_mfma_f32_16x16x32_bf16 v[152:155], a[140:143], v[184:187], v[152:155]
    s_waitcnt vmcnt(21)
    v_add_f32 v219, v219, v183
    v_mfma_f32_16x16x32_bf16 v[176:179], a[80:83], a[64:67], v[208:211]
    ds_read_b128 a[80:83], v222 offset:0
    v_exp_f32 v168, v168
    v_mfma_f32_16x16x32_bf16 v[180:183], a[96:99], a[64:67], v[208:211]
    ds_read_b128 a[96:99], v222 offset:4096
    v_exp_f32 v169, v169
    v_mfma_f32_16x16x32_bf16 v[176:179], a[84:87], a[68:71], v[176:179]
    ds_read_b128 a[84:87], v223 offset:0
    v_cvt_pk_bf16_f32 v184, v168, v169
    v_add_f32 v215, v215, v168
    v_mfma_f32_16x16x32_bf16 v[180:183], a[100:103], a[68:71], v[180:183]
    ds_read_b128 a[100:103], v223 offset:4096
    v_exp_f32 v170, v170
    v_mfma_f32_16x16x32_bf16 v[176:179], a[88:91], a[72:75], v[176:179]
    ds_read_b128 a[88:91], v224 offset:0
    v_add_f32 v220, v220, v169
    v_add_f32 v215, v215, v170
    v_mfma_f32_16x16x32_bf16 v[180:183], a[104:107], a[72:75], v[180:183]
    ds_read_b128 a[104:107], v224 offset:4096
    v_exp_f32 v171, v171
    v_mfma_f32_16x16x32_bf16 v[176:179], a[92:95], a[76:79], v[176:179]
    ds_read_b128 a[92:95], v225 offset:0
    v_cvt_pk_bf16_f32 v185, v170, v171
    v_add_f32 v220, v220, v171
    v_mfma_f32_16x16x32_bf16 v[180:183], a[108:111], a[76:79], v[180:183]
    ds_read_b128 a[108:111], v225 offset:4096
    v_exp_f32 v172, v172
    v_mfma_f32_16x16x32_bf16 v[16:19], a[112:115], v[188:191], v[16:19]
    v_exp_f32 v173, v173
    v_add_f32 v215, v215, v172
    v_mfma_f32_16x16x32_bf16 v[36:39], a[116:119], v[188:191], v[36:39]
    buffer_load_dwordx4 v237, s[12:15], s70 offen offset:1024 nt lds
    v_mfma_f32_16x16x32_bf16 v[56:59], a[120:123], v[188:191], v[56:59]
    v_exp_f32 v174, v174
    v_cvt_pk_bf16_f32 v186, v172, v173
    v_mfma_f32_16x16x32_bf16 v[76:79], a[124:127], v[188:191], v[76:79]
    v_exp_f32 v175, v175
    v_mfma_f32_16x16x32_bf16 v[96:99], a[128:131], v[188:191], v[96:99]
    buffer_load_dwordx4 v236, s[12:15], s70 offen offset:2048 nt lds
    v_mfma_f32_16x16x32_bf16 v[116:119], a[132:135], v[188:191], v[116:119]
    v_cvt_pk_bf16_f32 v187, v174, v175
    v_add_f32 v220, v220, v173
    v_mfma_f32_16x16x32_bf16 v[136:139], a[136:139], v[188:191], v[136:139]
    buffer_load_dwordx4 v237, s[12:15], s70 offen offset:3072 nt lds
    v_mfma_f32_16x16x32_bf16 v[156:159], a[140:143], v[188:191], v[156:159]
    s_waitcnt lgkmcnt(0)
    v_add_f32 v215, v215, v174
    v_add_f32 v220, v220, v175
    v_mfma_f32_16x16x32_bf16 v[168:171], a[80:83], a[0:3], v[192:195]
    s_mov_b32 m0, s62
    v_exp_f32 v176, v176
    v_exp_f32 v177, v177
    v_mfma_f32_16x16x32_bf16 v[172:175], a[96:99], a[0:3], v[192:195]
    buffer_load_dwordx4 v234, s[8:11], s71 offen offset:0 nt lds
    v_mfma_f32_16x16x32_bf16 v[168:171], a[84:87], a[4:7], v[168:171]
    v_cvt_pk_bf16_f32 v188, v176, v177
    v_add_f32 v216, v216, v176
    v_add_f32 v221, v221, v177
    v_mfma_f32_16x16x32_bf16 v[172:175], a[100:103], a[4:7], v[172:175]
    v_exp_f32 v178, v178
    v_exp_f32 v179, v179
    v_mfma_f32_16x16x32_bf16 v[168:171], a[88:91], a[8:11], v[168:171]
    buffer_load_dwordx4 v235, s[8:11], s71 offen offset:1024 nt lds
    v_mfma_f32_16x16x32_bf16 v[172:175], a[104:107], a[8:11], v[172:175]
    v_cvt_pk_bf16_f32 v189, v178, v179
    v_add_f32 v216, v216, v178
    v_add_f32 v221, v221, v179
    v_mfma_f32_16x16x32_bf16 v[168:171], a[92:95], a[12:15], v[168:171]
    v_exp_f32 v180, v180
    v_exp_f32 v181, v181
    v_mfma_f32_16x16x32_bf16 v[172:175], a[108:111], a[12:15], v[172:175]
    buffer_load_dwordx4 v234, s[8:11], s71 offen offset:2048 nt lds
    v_mfma_f32_16x16x32_bf16 v[20:23], a[112:115], v[184:187], v[20:23]
    v_cvt_pk_bf16_f32 v190, v180, v181
    v_add_f32 v216, v216, v180
    v_add_f32 v221, v221, v181
    v_mfma_f32_16x16x32_bf16 v[40:43], a[116:119], v[184:187], v[40:43]
    v_exp_f32 v182, v182
    v_mfma_f32_16x16x32_bf16 v[60:63], a[120:123], v[184:187], v[60:63]
    buffer_load_dwordx4 v235, s[8:11], s71 offen offset:3072 nt lds
    v_mfma_f32_16x16x32_bf16 v[80:83], a[124:127], v[184:187], v[80:83]
    v_exp_f32 v183, v183
    v_mfma_f32_16x16x32_bf16 v[100:103], a[128:131], v[184:187], v[100:103]
    s_mov_b32 m0, s63
    v_cvt_pk_bf16_f32 v191, v182, v183
    v_add_f32 v216, v216, v182
    v_mfma_f32_16x16x32_bf16 v[120:123], a[132:135], v[184:187], v[120:123]
    buffer_load_dwordx4 v236, s[8:11], s71 offen offset:0 nt lds
    v_mfma_f32_16x16x32_bf16 v[140:143], a[136:139], v[184:187], v[140:143]
    v_add_f32 v221, v221, v183
    v_mfma_f32_16x16x32_bf16 v[160:163], a[140:143], v[184:187], v[160:163]
    v_mfma_f32_16x16x32_bf16 v[176:179], a[80:83], a[16:19], v[196:199]
    buffer_load_dwordx4 v237, s[8:11], s71 offen offset:1024 nt lds
    v_mfma_f32_16x16x32_bf16 v[180:183], a[96:99], a[16:19], v[196:199]
    v_exp_f32 v168, v168
    v_exp_f32 v169, v169
    v_mfma_f32_16x16x32_bf16 v[176:179], a[84:87], a[20:23], v[176:179]
    v_cvt_pk_bf16_f32 v184, v168, v169
    v_add_f32 v212, v212, v168
    v_add_f32 v217, v217, v169
    v_mfma_f32_16x16x32_bf16 v[180:183], a[100:103], a[20:23], v[180:183]
    buffer_load_dwordx4 v236, s[8:11], s71 offen offset:2048 nt lds
    v_mfma_f32_16x16x32_bf16 v[176:179], a[88:91], a[24:27], v[176:179]
    v_exp_f32 v170, v170
    v_mfma_f32_16x16x32_bf16 v[180:183], a[104:107], a[24:27], v[180:183]
    v_exp_f32 v171, v171
    v_mfma_f32_16x16x32_bf16 v[176:179], a[92:95], a[28:31], v[176:179]
    buffer_load_dwordx4 v237, s[8:11], s71 offen offset:3072 nt lds
    v_mfma_f32_16x16x32_bf16 v[180:183], a[108:111], a[28:31], v[180:183]
    s_waitcnt vmcnt(24)
    v_cvt_pk_bf16_f32 v185, v170, v171
    v_add_f32 v212, v212, v170
    v_mfma_f32_16x16x32_bf16 v[24:27], a[112:115], v[188:191], v[24:27]
    s_cmp_lg_u32 s73, 0
    ds_read_b64_tr_b16 a[112:113], v226 offset:0
    ds_read_b64_tr_b16 a[114:115], v226 offset:4096
    v_exp_f32 v172, v172
    v_mfma_f32_16x16x32_bf16 v[44:47], a[116:119], v[188:191], v[44:47]
    s_cbranch_scc1 L_nobar2
    s_barrier
L_nobar2:
    ds_read_b64_tr_b16 a[116:117], v227 offset:0
    ds_read_b64_tr_b16 a[118:119], v227 offset:4096
    v_add_f32 v217, v217, v171
    v_add_f32 v212, v212, v172
    v_mfma_f32_16x16x32_bf16 v[64:67], a[120:123], v[188:191], v[64:67]
    ds_read_b64_tr_b16 a[120:121], v228 offset:0
    ds_read_b64_tr_b16 a[122:123], v228 offset:4096
    v_exp_f32 v173, v173
    v_mfma_f32_16x16x32_bf16 v[84:87], a[124:127], v[188:191], v[84:87]
    ds_read_b64_tr_b16 a[124:125], v229 offset:0
    ds_read_b64_tr_b16 a[126:127], v229 offset:4096
    v_exp_f32 v174, v174
    v_mfma_f32_16x16x32_bf16 v[104:107], a[128:131], v[188:191], v[104:107]
    s_mov_b32 s70, s71
    ds_read_b64_tr_b16 a[128:129], v230 offset:0
    ds_read_b64_tr_b16 a[130:131], v230 offset:4096
    v_exp_f32 v175, v175
    v_mfma_f32_16x16x32_bf16 v[124:127], a[132:135], v[188:191], v[124:127]
    s_add_u32 s71, s71, 8192
    ds_read_b64_tr_b16 a[132:133], v231 offset:0
    ds_read_b64_tr_b16 a[134:135], v231 offset:4096
    v_cvt_pk_bf16_f32 v186, v172, v173
    v_cvt_pk_bf16_f32 v187, v174, v175
    v_mfma_f32_16x16x32_bf16 v[144:147], a[136:139], v[188:191], v[144:147]
    s_add_u32 s72, s72, 1
    ds_read_b64_tr_b16 a[136:137], v232 offset:0
    ds_read_b64_tr_b16 a[138:139], v232 offset:4096
    v_add_f32 v217, v217, v173
    v_add_f32 v212, v212, v174
    v_mfma_f32_16x16x32_bf16 v[164:167], a[140:143], v[188:191], v[164:167]
    s_cmp_lt_u32 s72, 13
    ds_read_b64_tr_b16 a[140:141], v233 offset:0
    ds_read_b64_tr_b16 a[142:143], v233 offset:4096
    v_add_f32 v217, v217, v175
    s_cbranch_scc1 L_loop
L_tail_b:
    v_mfma_f32_16x16x32_bf16 v[168:171], a[80:83], a[32:35], v[200:203]
    v_exp_f32 v176, v176
    v_exp_f32 v177, v177
    v_mfma_f32_16x16x32_bf16 v[172:175], a[96:99], a[32:35], v[200:203]
    v_cvt_pk_bf16_f32 v188, v176, v177
    v_add_f32 v213, v213, v176
    v_add_f32 v218, v218, v177
    v_mfma_f32_16x16x32_bf16 v[168:171], a[84:87], a[36:39], v[168:171]
    s_and_b32 s71, s71, 262143
    s_lshl_b32 s75, s78, 15
    v_exp_f32 v178, v178
    v_mfma_f32_16x16x32_bf16 v[172:175], a[100:103], a[36:39], v[172:175]
    v_add_u32 v244, 0, v238
    v_exp_f32 v179, v179
    v_mfma_f32_16x16x32_bf16 v[168:171], a[88:91], a[40:43], v[168:171]
    buffer_load_dword v255, v239, s[20:23], s75 offen
    v_mfma_f32_16x16x32_bf16 v[172:175], a[104:107], a[40:43], v[172:175]
    v_cvt_pk_bf16_f32 v189, v178, v179
    v_add_f32 v213, v213, v178
    v_mfma_f32_16x16x32_bf16 v[168:171], a[92:95], a[44:47], v[168:171]
    v_xor_b32 v245, 0x80, v238
    v_exp_f32 v180, v180
    v_mfma_f32_16x16x32_bf16 v[172:175], a[108:111], a[44:47], v[172:175]
    s_waitcnt lgkmcnt(0)
    v_add_f32 v218, v218, v179
    v_add_f32 v213, v213, v180
    v_mfma_f32_16x16x32_bf16 v[8:11], a[112:115], v[184:187], v[8:11]
    s_mov_b32 m0, s66
    v_exp_f32 v181, v181
    v_mfma_f32_16x16x32_bf16 v[28:31], a[116:119], v[184:187], v[28:31]
    buffer_load_dwordx4 v234, s[12:15], s70 offen offset:0 nt lds
    v_add_u32 v245, 3072, v245
    v_mfma_f32_16x16x32_bf16 v[48:51], a[120:123], v[184:187], v[48:51]
    v_exp_f32 v182, v182
    v_mfma_f32_16x16x32_bf16 v[68:71], a[124:127], v[184:187], v[68:71]
    v_exp_f32 v183, v183
    v_mfma_f32_16x16x32_bf16 v[88:91], a[128:131], v[184:187], v[88:91]
    v_add_u32 v246, 6144, v238
    v_cvt_pk_bf16_f32 v190, v180, v181
    v_cvt_pk_bf16_f32 v191, v182, v183
    v_mfma_f32_16x16x32_bf16 v[108:111], a[132:135], v[184:187], v[108:111]
    v_add_f32 v218, v218, v181
    v_add_f32 v213, v213, v182
    v_mfma_f32_16x16x32_bf16 v[128:131], a[136:139], v[184:187], v[128:131]
    buffer_load_dwordx4 v235, s[12:15], s70 offen offset:1024 nt lds
    v_mfma_f32_16x16x32_bf16 v[148:151], a[140:143], v[184:187], v[148:151]
    v_xor_b32 v247, 0x80, v238
    v_add_f32 v218, v218, v183
    v_mfma_f32_16x16x32_bf16 v[176:179], a[80:83], a[48:51], v[204:207]
    v_exp_f32 v168, v168
    v_exp_f32 v169, v169
    v_mfma_f32_16x16x32_bf16 v[180:183], a[96:99], a[48:51], v[204:207]
    v_cvt_pk_bf16_f32 v184, v168, v169
    v_add_f32 v214, v214, v168
    v_add_f32 v219, v219, v169
    v_mfma_f32_16x16x32_bf16 v[176:179], a[84:87], a[52:55], v[176:179]
    v_add_u32 v247, 9216, v247
    v_exp_f32 v170, v170
    v_mfma_f32_16x16x32_bf16 v[180:183], a[100:103], a[52:55], v[180:183]
    buffer_load_dwordx4 v234, s[12:15], s70 offen offset:2048 nt lds
    v_mfma_f32_16x16x32_bf16 v[176:179], a[88:91], a[56:59], v[176:179]
    v_exp_f32 v171, v171
    v_mfma_f32_16x16x32_bf16 v[180:183], a[104:107], a[56:59], v[180:183]
    v_add_u32 v248, 16384, v238
    v_cvt_pk_bf16_f32 v185, v170, v171
    v_add_f32 v214, v214, v170
    v_mfma_f32_16x16x32_bf16 v[176:179], a[92:95], a[60:63], v[176:179]
    v_exp_f32 v172, v172
    v_mfma_f32_16x16x32_bf16 v[180:183], a[108:111], a[60:63], v[180:183]
    v_add_f32 v219, v219, v171
    v_add_f32 v214, v214, v172
    v_mfma_f32_16x16x32_bf16 v[12:15], a[112:115], v[188:191], v[12:15]
    buffer_load_dwordx4 v235, s[12:15], s70 offen offset:3072 nt lds
    v_xor_b32 v249, 0x80, v238
    v_mfma_f32_16x16x32_bf16 v[32:35], a[116:119], v[188:191], v[32:35]
    v_exp_f32 v173, v173
    v_mfma_f32_16x16x32_bf16 v[52:55], a[120:123], v[188:191], v[52:55]
    v_exp_f32 v174, v174
    v_mfma_f32_16x16x32_bf16 v[72:75], a[124:127], v[188:191], v[72:75]
    v_add_u32 v249, 19456, v249
    v_exp_f32 v175, v175
    v_mfma_f32_16x16x32_bf16 v[92:95], a[128:131], v[188:191], v[92:95]
    s_mov_b32 m0, s67
    v_cvt_pk_bf16_f32 v186, v172, v173
    v_cvt_pk_bf16_f32 v187, v174, v175
    v_mfma_f32_16x16x32_bf16 v[112:115], a[132:135], v[188:191], v[112:115]
    buffer_load_dwordx4 v236, s[12:15], s70 offen offset:0 nt lds
    v_mfma_f32_16x16x32_bf16 v[132:135], a[136:139], v[188:191], v[132:135]
    v_add_u32 v250, 22528, v238
    v_add_f32 v219, v219, v173
    v_add_f32 v214, v214, v174
    v_mfma_f32_16x16x32_bf16 v[152:155], a[140:143], v[188:191], v[152:155]
    s_waitcnt vmcnt(22)
    v_add_f32 v219, v219, v175
    v_mfma_f32_16x16x32_bf16 v[168:171], a[80:83], a[64:67], v[208:211]
    ds_read_b128 a[80:83], v222 offset:8192
    v_exp_f32 v176, v176
    v_mfma_f32_16x16x32_bf16 v[172:175], a[96:99], a[64:67], v[208:211]
    ds_read_b128 a[96:99], v222 offset:12288
    v_xor_b32 v251, 0x80, v238
    v_add_f32 v215, v215, v176
    v_mfma_f32_16x16x32_bf16 v[168:171], a[84:87], a[68:71], v[168:171]
    ds_read_b128 a[84:87], v223 offset:8192
    v_exp_f32 v177, v177
    v_mfma_f32_16x16x32_bf16 v[172:175], a[100:103], a[68:71], v[172:175]
    ds_read_b128 a[100:103], v223 offset:12288
    v_cvt_pk_bf16_f32 v188, v176, v177
    v_add_f32 v220, v220, v177
    v_mfma_f32_16x16x32_bf16 v[168:171], a[88:91], a[72:75], v[168:171]
    ds_read_b128 a[88:91], v224 offset:8192
    v_add_u32 v251, 25600, v251
    v_exp_f32 v178, v178
    v_mfma_f32_16x16x32_bf16 v[172:175], a[104:107], a[72:75], v[172:175]
    ds_read_b128 a[104:107], v224 offset:12288
    v_exp_f32 v179, v179
    v_mfma_f32_16x16x32_bf16 v[168:171], a[92:95], a[76:79], v[168:171]
    ds_read_b128 a[92:95], v225 offset:8192
    v_cvt_pk_bf16_f32 v189, v178, v179
    v_add_f32 v215, v215, v178
    v_mfma_f32_16x16x32_bf16 v[172:175], a[108:111], a[76:79], v[172:175]
    ds_read_b128 a[108:111], v225 offset:12288
    v_exp_f32 v180, v180
    v_mfma_f32_16x16x32_bf16 v[16:19], a[112:115], v[184:187], v[16:19]
    v_add_f32 v220, v220, v179
    v_exp_f32 v181, v181
    v_mfma_f32_16x16x32_bf16 v[36:39], a[116:119], v[184:187], v[36:39]
    buffer_load_dwordx4 v237, s[12:15], s70 offen offset:1024 nt lds
    v_mfma_f32_16x16x32_bf16 v[56:59], a[120:123], v[184:187], v[56:59]
    v_exp_f32 v182, v182
    v_cvt_pk_bf16_f32 v190, v180, v181
    v_mfma_f32_16x16x32_bf16 v[76:79], a[124:127], v[184:187], v[76:79]
    v_exp_f32 v183, v183
    v_add_f32 v215, v215, v180
    v_mfma_f32_16x16x32_bf16 v[96:99], a[128:131], v[184:187], v[96:99]
    buffer_load_dwordx4 v236, s[12:15], s70 offen offset:2048 nt lds
    v_mfma_f32_16x16x32_bf16 v[116:119], a[132:135], v[184:187], v[116:119]
    v_cvt_pk_bf16_f32 v191, v182, v183
    v_add_f32 v220, v220, v181
    v_add_f32 v215, v215, v182
    v_mfma_f32_16x16x32_bf16 v[136:139], a[136:139], v[184:187], v[136:139]
    buffer_load_dwordx4 v237, s[12:15], s70 offen offset:3072 nt lds
    v_mfma_f32_16x16x32_bf16 v[156:159], a[140:143], v[184:187], v[156:159]
    s_waitcnt lgkmcnt(0)
    v_add_f32 v220, v220, v183
    v_mfma_f32_16x16x32_bf16 v[176:179], a[80:83], a[0:3], v[192:195]
    s_mov_b32 m0, s64
    v_exp_f32 v168, v168
    v_exp_f32 v169, v169
    v_mfma_f32_16x16x32_bf16 v[180:183], a[96:99], a[0:3], v[192:195]
    buffer_load_dwordx4 v234, s[8:11], s71 offen offset:0 nt lds
    v_mfma_f32_16x16x32_bf16 v[176:179], a[84:87], a[4:7], v[176:179]
    v_cvt_pk_bf16_f32 v184, v168, v169
    v_add_f32 v216, v216, v168
    v_add_f32 v221, v221, v169
    v_mfma_f32_16x16x32_bf16 v[180:183], a[100:103], a[4:7], v[180:183]
    v_exp_f32 v170, v170
    v_exp_f32 v171, v171
    v_mfma_f32_16x16x32_bf16 v[176:179], a[88:91], a[8:11], v[176:179]
    buffer_load_dwordx4 v235, s[8:11], s71 offen offset:1024 nt lds
    v_mfma_f32_16x16x32_bf16 v[180:183], a[104:107], a[8:11], v[180:183]
    v_cvt_pk_bf16_f32 v185, v170, v171
    v_add_f32 v216, v216, v170
    v_add_f32 v221, v221, v171
    v_mfma_f32_16x16x32_bf16 v[176:179], a[92:95], a[12:15], v[176:179]
    v_exp_f32 v172, v172
    v_exp_f32 v173, v173
    v_mfma_f32_16x16x32_bf16 v[180:183], a[108:111], a[12:15], v[180:183]
    buffer_load_dwordx4 v234, s[8:11], s71 offen offset:2048 nt lds
    v_mfma_f32_16x16x32_bf16 v[20:23], a[112:115], v[188:191], v[20:23]
    v_cvt_pk_bf16_f32 v186, v172, v173
    v_add_f32 v216, v216, v172
    v_add_f32 v221, v221, v173
    v_mfma_f32_16x16x32_bf16 v[40:43], a[116:119], v[188:191], v[40:43]
    v_exp_f32 v174, v174
    v_mfma_f32_16x16x32_bf16 v[60:63], a[120:123], v[188:191], v[60:63]
    buffer_load_dwordx4 v235, s[8:11], s71 offen offset:3072 nt lds
    v_mfma_f32_16x16x32_bf16 v[80:83], a[124:127], v[188:191], v[80:83]
    v_exp_f32 v175, v175
    v_mfma_f32_16x16x32_bf16 v[100:103], a[128:131], v[188:191], v[100:103]
    s_mov_b32 m0, s65
    v_cvt_pk_bf16_f32 v187, v174, v175
    v_add_f32 v216, v216, v174
    v_mfma_f32_16x16x32_bf16 v[120:123], a[132:135], v[188:191], v[120:123]
    buffer_load_dwordx4 v236, s[8:11], s71 offen offset:0 nt lds
    v_mfma_f32_16x16x32_bf16 v[140:143], a[136:139], v[188:191], v[140:143]
    v_add_f32 v221, v221, v175
    v_mfma_f32_16x16x32_bf16 v[160:163], a[140:143], v[188:191], v[160:163]
    v_mfma_f32_16x16x32_bf16 v[168:171], a[80:83], a[16:19], v[196:199]
    buffer_load_dwordx4 v237, s[8:11], s71 offen offset:1024 nt lds
    v_mfma_f32_16x16x32_bf16 v[172:175], a[96:99], a[16:19], v[196:199]
    v_exp_f32 v176, v176
    v_exp_f32 v177, v177
    v_mfma_f32_16x16x32_bf16 v[168:171], a[84:87], a[20:23], v[168:171]
    v_cvt_pk_bf16_f32 v188, v176, v177
    v_add_f32 v212, v212, v176
    v_add_f32 v217, v217, v177
    v_mfma_f32_16x16x32_bf16 v[172:175], a[100:103], a[20:23], v[172:175]
    buffer_load_dwordx4 v236, s[8:11], s71 offen offset:2048 nt lds
    v_mfma_f32_16x16x32_bf16 v[168:171], a[88:91], a[24:27], v[168:171]
    v_exp_f32 v178, v178
    v_mfma_f32_16x16x32_bf16 v[172:175], a[104:107], a[24:27], v[172:175]
    v_exp_f32 v179, v179
    v_mfma_f32_16x16x32_bf16 v[168:171], a[92:95], a[28:31], v[168:171]
    buffer_load_dwordx4 v237, s[8:11], s71 offen offset:3072 nt lds
    v_mfma_f32_16x16x32_bf16 v[172:175], a[108:111], a[28:31], v[172:175]
    s_waitcnt vmcnt(25)
    v_cvt_pk_bf16_f32 v189, v178, v179
    v_add_f32 v212, v212, v178
    v_mfma_f32_16x16x32_bf16 v[24:27], a[112:115], v[184:187], v[24:27]
    ds_read_b64_tr_b16 a[112:113], v226 offset:8192
    ds_read_b64_tr_b16 a[114:115], v226 offset:12288
    v_exp_f32 v180, v180
    v_mfma_f32_16x16x32_bf16 v[44:47], a[116:119], v[184:187], v[44:47]
    ds_read_b64_tr_b16 a[116:117], v227 offset:8192
    ds_read_b64_tr_b16 a[118:119], v227 offset:12288
    v_add_f32 v217, v217, v179
    v_add_f32 v212, v212, v180
    v_mfma_f32_16x16x32_bf16 v[64:67], a[120:123], v[184:187], v[64:67]
    ds_read_b64_tr_b16 a[120:121], v228 offset:8192
    ds_read_b64_tr_b16 a[122:123], v228 offset:12288
    v_exp_f32 v181, v181
    v_mfma_f32_16x16x32_bf16 v[84:87], a[124:127], v[184:187], v[84:87]
    ds_read_b64_tr_b16 a[124:125], v229 offset:8192
    ds_read_b64_tr_b16 a[126:127], v229 offset:12288
    v_exp_f32 v182, v182
    v_mfma_f32_16x16x32_bf16 v[104:107], a[128:131], v[184:187], v[104:107]
    s_mov_b32 s70, s71
    ds_read_b64_tr_b16 a[128:129], v230 offset:8192
    ds_read_b64_tr_b16 a[130:131], v230 offset:12288
    v_exp_f32 v183, v183
    v_mfma_f32_16x16x32_bf16 v[124:127], a[132:135], v[184:187], v[124:127]
    s_add_u32 s71, s71, 8192
    ds_read_b64_tr_b16 a[132:133], v231 offset:8192
    ds_read_b64_tr_b16 a[134:135], v231 offset:12288
    v_cvt_pk_bf16_f32 v190, v180, v181
    v_cvt_pk_bf16_f32 v191, v182, v183
    v_mfma_f32_16x16x32_bf16 v[144:147], a[136:139], v[184:187], v[144:147]
    ds_read_b64_tr_b16 a[136:137], v232 offset:8192
    ds_read_b64_tr_b16 a[138:139], v232 offset:12288
    v_add_f32 v217, v217, v181
    v_add_f32 v212, v212, v182
    v_mfma_f32_16x16x32_bf16 v[164:167], a[140:143], v[184:187], v[164:167]
    ds_read_b64_tr_b16 a[140:141], v233 offset:8192
    ds_read_b64_tr_b16 a[142:143], v233 offset:12288
    v_add_f32 v217, v217, v183
    v_mfma_f32_16x16x32_bf16 v[176:179], a[80:83], a[32:35], v[200:203]
    v_exp_f32 v168, v168
    v_mfma_f32_16x16x32_bf16 v[180:183], a[96:99], a[32:35], v[200:203]
    v_exp_f32 v169, v169
    v_mfma_f32_16x16x32_bf16 v[176:179], a[84:87], a[36:39], v[176:179]
    s_and_b32 s71, s71, 262143
    v_cvt_pk_bf16_f32 v184, v168, v169
    v_add_f32 v213, v213, v168
    v_mfma_f32_16x16x32_bf16 v[180:183], a[100:103], a[36:39], v[180:183]
    v_exp_f32 v170, v170
    v_mfma_f32_16x16x32_bf16 v[176:179], a[88:91], a[40:43], v[176:179]
    v_add_f32 v218, v218, v169
    v_add_f32 v213, v213, v170
    v_mfma_f32_16x16x32_bf16 v[180:183], a[104:107], a[40:43], v[180:183]
    v_exp_f32 v171, v171
    v_mfma_f32_16x16x32_bf16 v[176:179], a[92:95], a[44:47], v[176:179]
    v_cvt_pk_bf16_f32 v185, v170, v171
    v_add_f32 v218, v218, v171
    v_mfma_f32_16x16x32_bf16 v[180:183], a[108:111], a[44:47], v[180:183]
    s_waitcnt lgkmcnt(0)
    v_exp_f32 v172, v172
    v_mfma_f32_16x16x32_bf16 v[8:11], a[112:115], v[188:191], v[8:11]
    s_mov_b32 m0, s68
    v_exp_f32 v173, v173
    v_mfma_f32_16x16x32_bf16 v[28:31], a[116:119], v[188:191], v[28:31]
    buffer_load_dwordx4 v234, s[12:15], s70 offen offset:0 nt lds
    v_mfma_f32_16x16x32_bf16 v[48:51], a[120:123], v[188:191], v[48:51]
    v_exp_f32 v174, v174
    v_mfma_f32_16x16x32_bf16 v[68:71], a[124:127], v[188:191], v[68:71]
    v_exp_f32 v175, v175
    v_mfma_f32_16x16x32_bf16 v[88:91], a[128:131], v[188:191], v[88:91]
    v_cvt_pk_bf16_f32 v186, v172, v173
    v_cvt_pk_bf16_f32 v187, v174, v175
    v_mfma_f32_16x16x32_bf16 v[108:111], a[132:135], v[188:191], v[108:111]
    v_add_f32 v213, v213, v172
    v_add_f32 v218, v218, v173
    v_mfma_f32_16x16x32_bf16 v[128:131], a[136:139], v[188:191], v[128:131]
    buffer_load_dwordx4 v235, s[12:15], s70 offen offset:1024 nt lds
    v_mfma_f32_16x16x32_bf16 v[148:151], a[140:143], v[188:191], v[148:151]
    v_add_f32 v213, v213, v174
    v_add_f32 v218, v218, v175
    v_mfma_f32_16x16x32_bf16 v[168:171], a[80:83], a[48:51], v[204:207]
    v_exp_f32 v176, v176
    v_exp_f32 v177, v177
    v_mfma_f32_16x16x32_bf16 v[172:175], a[96:99], a[48:51], v[204:207]
    v_cvt_pk_bf16_f32 v188, v176, v177
    v_add_f32 v214, v214, v176
    v_add_f32 v219, v219, v177
    v_mfma_f32_16x16x32_bf16 v[168:171], a[84:87], a[52:55], v[168:171]
    v_exp_f32 v178, v178
    v_mfma_f32_16x16x32_bf16 v[172:175], a[100:103], a[52:55], v[172:175]
    buffer_load_dwordx4 v234, s[12:15], s70 offen offset:2048 nt lds
    v_mfma_f32_16x16x32_bf16 v[168:171], a[88:91], a[56:59], v[168:171]
    v_exp_f32 v179, v179
    v_mfma_f32_16x16x32_bf16 v[172:175], a[104:107], a[56:59], v[172:175]
    v_cvt_pk_bf16_f32 v189, v178, v179
    v_add_f32 v214, v214, v178
    v_mfma_f32_16x16x32_bf16 v[168:171], a[92:95], a[60:63], v[168:171]
    v_exp_f32 v180, v180
    v_mfma_f32_16x16x32_bf16 v[172:175], a[108:111], a[60:63], v[172:175]
    v_add_f32 v219, v219, v179
    v_add_f32 v214, v214, v180
    v_mfma_f32_16x16x32_bf16 v[12:15], a[112:115], v[184:187], v[12:15]
    buffer_load_dwordx4 v235, s[12:15], s70 offen offset:3072 nt lds
    v_mfma_f32_16x16x32_bf16 v[32:35], a[116:119], v[184:187], v[32:35]
    v_exp_f32 v181, v181
    v_mfma_f32_16x16x32_bf16 v[52:55], a[120:123], v[184:187], v[52:55]
    v_exp_f32 v182, v182
    v_mfma_f32_16x16x32_bf16 v[72:75], a[124:127], v[184:187], v[72:75]
    v_exp_f32 v183, v183
    v_mfma_f32_16x16x32_bf16 v[92:95], a[128:131], v[184:187], v[92:95]
    s_mov_b32 m0, s69
    v_cvt_pk_bf16_f32 v190, v180, v181
    v_cvt_pk_bf16_f32 v191, v182, v183
    v_mfma_f32_16x16x32_bf16 v[112:115], a[132:135], v[184:187], v[112:115]
    buffer_load_dwordx4 v236, s[12:15], s70 offen offset:0 nt lds
    v_mfma_f32_16x16x32_bf16 v[132:135], a[136:139], v[184:187], v[132:135]
    v_add_f32 v219, v219, v181
    v_add_f32 v214, v214, v182
    v_mfma_f32_16x16x32_bf16 v[152:155], a[140:143], v[184:187], v[152:155]
    s_waitcnt vmcnt(22)
    v_add_f32 v219, v219, v183
    v_mfma_f32_16x16x32_bf16 v[176:179], a[80:83], a[64:67], v[208:211]
    ds_read_b128 a[80:83], v222 offset:0
    v_exp_f32 v168, v168
    v_mfma_f32_16x16x32_bf16 v[180:183], a[96:99], a[64:67], v[208:211]
    ds_read_b128 a[96:99], v222 offset:4096
    v_exp_f32 v169, v169
    v_mfma_f32_16x16x32_bf16 v[176:179], a[84:87], a[68:71], v[176:179]
    ds_read_b128 a[84:87], v223 offset:0
    v_cvt_pk_bf16_f32 v184, v168, v169
    v_add_f32 v215, v215, v168
    v_mfma_f32_16x16x32_bf16 v[180:183], a[100:103], a[68:71], v[180:183]
    ds_read_b128 a[100:103], v223 offset:4096
    v_exp_f32 v170, v170
    v_mfma_f32_16x16x32_bf16 v[176:179], a[88:91], a[72:75], v[176:179]
    ds_read_b128 a[88:91], v224 offset:0
    v_add_f32 v220, v220, v169
    v_add_f32 v215, v215, v170
    v_mfma_f32_16x16x32_bf16 v[180:183], a[104:107], a[72:75], v[180:183]
    ds_read_b128 a[104:107], v224 offset:4096
    v_exp_f32 v171, v171
    v_mfma_f32_16x16x32_bf16 v[176:179], a[92:95], a[76:79], v[176:179]
    ds_read_b128 a[92:95], v225 offset:0
    v_cvt_pk_bf16_f32 v185, v170, v171
    v_add_f32 v220, v220, v171
    v_mfma_f32_16x16x32_bf16 v[180:183], a[108:111], a[76:79], v[180:183]
    ds_read_b128 a[108:111], v225 offset:4096
    v_exp_f32 v172, v172
    v_mfma_f32_16x16x32_bf16 v[16:19], a[112:115], v[188:191], v[16:19]
    v_exp_f32 v173, v173
    v_add_f32 v215, v215, v172
    v_mfma_f32_16x16x32_bf16 v[36:39], a[116:119], v[188:191], v[36:39]
    buffer_load_dwordx4 v237, s[12:15], s70 offen offset:1024 nt lds
    v_mfma_f32_16x16x32_bf16 v[56:59], a[120:123], v[188:191], v[56:59]
    v_exp_f32 v174, v174
    v_cvt_pk_bf16_f32 v186, v172, v173
    v_mfma_f32_16x16x32_bf16 v[76:79], a[124:127], v[188:191], v[76:79]
    v_exp_f32 v175, v175
    v_mfma_f32_16x16x32_bf16 v[96:99], a[128:131], v[188:191], v[96:99]
    buffer_load_dwordx4 v236, s[12:15], s70 offen offset:2048 nt lds
    v_mfma_f32_16x16x32_bf16 v[116:119], a[132:135], v[188:191], v[116:119]
    v_cvt_pk_bf16_f32 v187, v174, v175
    v_add_f32 v220, v220, v173
    v_mfma_f32_16x16x32_bf16 v[136:139], a[136:139], v[188:191], v[136:139]
    buffer_load_dwordx4 v237, s[12:15], s70 offen offset:3072 nt lds
    v_mfma_f32_16x16x32_bf16 v[156:159], a[140:143], v[188:191], v[156:159]
    s_waitcnt lgkmcnt(0)
    v_add_f32 v215, v215, v174
    v_add_f32 v220, v220, v175
    v_mfma_f32_16x16x32_bf16 v[168:171], a[80:83], a[0:3], v[192:195]
    s_mov_b32 m0, s62
    v_exp_f32 v176, v176
    v_exp_f32 v177, v177
    v_mfma_f32_16x16x32_bf16 v[172:175], a[96:99], a[0:3], v[192:195]
    buffer_load_dwordx4 v244, s[20:23], s79 offen offset:0 lds
    v_mfma_f32_16x16x32_bf16 v[168:171], a[84:87], a[4:7], v[168:171]
    v_cvt_pk_bf16_f32 v188, v176, v177
    v_add_f32 v216, v216, v176
    v_add_f32 v221, v221, v177
    v_mfma_f32_16x16x32_bf16 v[172:175], a[100:103], a[4:7], v[172:175]
    v_exp_f32 v178, v178
    v_exp_f32 v179, v179
    v_mfma_f32_16x16x32_bf16 v[168:171], a[88:91], a[8:11], v[168:171]
    buffer_load_dwordx4 v245, s[20:23], s79 offen offset:1024 lds
    v_mfma_f32_16x16x32_bf16 v[172:175], a[104:107], a[8:11], v[172:175]
    v_cvt_pk_bf16_f32 v189, v178, v179
    v_add_f32 v216, v216, v178
    v_add_f32 v221, v221, v179
    v_mfma_f32_16x16x32_bf16 v[168:171], a[92:95], a[12:15], v[168:171]
    v_exp_f32 v180, v180
    v_exp_f32 v181, v181
    v_mfma_f32_16x16x32_bf16 v[172:175], a[108:111], a[12:15], v[172:175]
    buffer_load_dwordx4 v246, s[20:23], s79 offen offset:2048 lds
    v_mfma_f32_16x16x32_bf16 v[20:23], a[112:115], v[184:187], v[20:23]
    v_cvt_pk_bf16_f32 v190, v180, v181
    v_add_f32 v216, v216, v180
    v_add_f32 v221, v221, v181
    v_mfma_f32_16x16x32_bf16 v[40:43], a[116:119], v[184:187], v[40:43]
    v_exp_f32 v182, v182
    v_mfma_f32_16x16x32_bf16 v[60:63], a[120:123], v[184:187], v[60:63]
    buffer_load_dwordx4 v247, s[20:23], s79 offen offset:3072 lds
    v_mfma_f32_16x16x32_bf16 v[80:83], a[124:127], v[184:187], v[80:83]
    v_exp_f32 v183, v183
    v_mfma_f32_16x16x32_bf16 v[100:103], a[128:131], v[184:187], v[100:103]
    s_mov_b32 m0, s63
    v_cvt_pk_bf16_f32 v191, v182, v183
    v_add_f32 v216, v216, v182
    v_mfma_f32_16x16x32_bf16 v[120:123], a[132:135], v[184:187], v[120:123]
    buffer_load_dwordx4 v248, s[20:23], s79 offen offset:0 lds
    v_mfma_f32_16x16x32_bf16 v[140:143], a[136:139], v[184:187], v[140:143]
    v_add_f32 v221, v221, v183
    v_mfma_f32_16x16x32_bf16 v[160:163], a[140:143], v[184:187], v[160:163]
    v_mfma_f32_16x16x32_bf16 v[176:179], a[80:83], a[16:19], v[196:199]
    buffer_load_dwordx4 v249, s[20:23], s79 offen offset:1024 lds
    v_mfma_f32_16x16x32_bf16 v[180:183], a[96:99], a[16:19], v[196:199]
    v_exp_f32 v168, v168
    v_exp_f32 v169, v169
    v_mfma_f32_16x16x32_bf16 v[176:179], a[84:87], a[20:23], v[176:179]
    v_cvt_pk_bf16_f32 v184, v168, v169
    v_add_f32 v212, v212, v168
    v_add_f32 v217, v217, v169
    v_mfma_f32_16x16x32_bf16 v[180:183], a[100:103], a[20:23], v[180:183]
    buffer_load_dwordx4 v250, s[20:23], s79 offen offset:2048 lds
    v_mfma_f32_16x16x32_bf16 v[176:179], a[88:91], a[24:27], v[176:179]
    v_exp_f32 v170, v170
    v_mfma_f32_16x16x32_bf16 v[180:183], a[104:107], a[24:27], v[180:183]
    v_exp_f32 v171, v171
    v_mfma_f32_16x16x32_bf16 v[176:179], a[92:95], a[28:31], v[176:179]
    buffer_load_dwordx4 v251, s[20:23], s79 offen offset:3072 lds
    v_mfma_f32_16x16x32_bf16 v[180:183], a[108:111], a[28:31], v[180:183]
    s_waitcnt vmcnt(24)
    s_add_u32 s79, s79, 32768
    v_cvt_pk_bf16_f32 v185, v170, v171
    v_add_f32 v212, v212, v170
    v_mfma_f32_16x16x32_bf16 v[24:27], a[112:115], v[188:191], v[24:27]
    s_cmp_lg_u32 s73, 0
    s_and_b32 s79, s79, 524287
    ds_read_b64_tr_b16 a[112:113], v226 offset:0
    ds_read_b64_tr_b16 a[114:115], v226 offset:4096
    v_exp_f32 v172, v172
    v_mfma_f32_16x16x32_bf16 v[44:47], a[116:119], v[188:191], v[44:47]
    s_cbranch_scc1 L_nobar3
    s_barrier
L_nobar3:
    ds_read_b64_tr_b16 a[116:117], v227 offset:0
    ds_read_b64_tr_b16 a[118:119], v227 offset:4096
    v_add_f32 v217, v217, v171
    v_add_f32 v212, v212, v172
    v_mfma_f32_16x16x32_bf16 v[64:67], a[120:123], v[188:191], v[64:67]
    ds_read_b64_tr_b16 a[120:121], v228 offset:0
    ds_read_b64_tr_b16 a[122:123], v228 offset:4096
    v_exp_f32 v173, v173
    v_mfma_f32_16x16x32_bf16 v[84:87], a[124:127], v[188:191], v[84:87]
    ds_read_b64_tr_b16 a[124:125], v229 offset:0
    ds_read_b64_tr_b16 a[126:127], v229 offset:4096
    v_exp_f32 v174, v174
    v_mfma_f32_16x16x32_bf16 v[104:107], a[128:131], v[188:191], v[104:107]
    s_mov_b32 s70, s71
    ds_read_b64_tr_b16 a[128:129], v230 offset:0
    ds_read_b64_tr_b16 a[130:131], v230 offset:4096
    v_exp_f32 v175, v175
    v_mfma_f32_16x16x32_bf16 v[124:127], a[132:135], v[188:191], v[124:127]
    s_add_u32 s71, s71, 8192
    ds_read_b64_tr_b16 a[132:133], v231 offset:0
    ds_read_b64_tr_b16 a[134:135], v231 offset:4096
    v_cvt_pk_bf16_f32 v186, v172, v173
    v_cvt_pk_bf16_f32 v187, v174, v175
    v_mfma_f32_16x16x32_bf16 v[144:147], a[136:139], v[188:191], v[144:147]
    ds_read_b64_tr_b16 a[136:137], v232 offset:0
    ds_read_b64_tr_b16 a[138:139], v232 offset:4096
    v_add_f32 v217, v217, v173
    v_add_f32 v212, v212, v174
    v_mfma_f32_16x16x32_bf16 v[164:167], a[140:143], v[188:191], v[164:167]
    ds_read_b64_tr_b16 a[140:141], v233 offset:0
    ds_read_b64_tr_b16 a[142:143], v233 offset:4096
    v_add_f32 v217, v217, v175
    v_mfma_f32_16x16x32_bf16 v[168:171], a[80:83], a[32:35], v[200:203]
    v_exp_f32 v176, v176
    v_mfma_f32_16x16x32_bf16 v[172:175], a[96:99], a[32:35], v[200:203]
    v_exp_f32 v177, v177
    v_mfma_f32_16x16x32_bf16 v[168:171], a[84:87], a[36:39], v[168:171]
    v_cvt_pk_bf16_f32 v188, v176, v177
    v_add_f32 v213, v213, v176
    v_mfma_f32_16x16x32_bf16 v[172:175], a[100:103], a[36:39], v[172:175]
    v_exp_f32 v178, v178
    v_mfma_f32_16x16x32_bf16 v[168:171], a[88:91], a[40:43], v[168:171]
    v_add_f32 v218, v218, v177
    v_add_f32 v213, v213, v178
    v_mfma_f32_16x16x32_bf16 v[172:175], a[104:107], a[40:43], v[172:175]
    v_exp_f32 v179, v179
    v_mfma_f32_16x16x32_bf16 v[168:171], a[92:95], a[44:47], v[168:171]
    v_cvt_pk_bf16_f32 v189, v178, v179
    v_add_f32 v218, v218, v179
    v_mfma_f32_16x16x32_bf16 v[172:175], a[108:111], a[44:47], v[172:175]
    s_waitcnt lgkmcnt(0)
    v_exp_f32 v180, v180
    v_mfma_f32_16x16x32_bf16 v[8:11], a[112:115], v[184:187], v[8:11]
    v_exp_f32 v181, v181
    v_mfma_f32_16x16x32_bf16 v[28:31], a[116:119], v[184:187], v[28:31]
    v_cvt_pk_bf16_f32 v190, v180, v181
    v_add_f32 v213, v213, v180
    v_mfma_f32_16x16x32_bf16 v[48:51], a[120:123], v[184:187], v[48:51]
    v_exp_f32 v182, v182
    v_mfma_f32_16x16x32_bf16 v[68:71], a[124:127], v[184:187], v[68:71]
    v_add_f32 v218, v218, v181
    v_add_f32 v213, v213, v182
    v_mfma_f32_16x16x32_bf16 v[88:91], a[128:131], v[184:187], v[88:91]
    v_exp_f32 v183, v183
    v_mfma_f32_16x16x32_bf16 v[108:111], a[132:135], v[184:187], v[108:111]
    v_cvt_pk_bf16_f32 v191, v182, v183
    v_add_f32 v218, v218, v183
    v_mfma_f32_16x16x32_bf16 v[128:131], a[136:139], v[184:187], v[128:131]
    v_mfma_f32_16x16x32_bf16 v[148:151], a[140:143], v[184:187], v[148:151]
    v_mfma_f32_16x16x32_bf16 v[176:179], a[80:83], a[48:51], v[204:207]
    v_exp_f32 v168, v168
    v_mfma_f32_16x16x32_bf16 v[180:183], a[96:99], a[48:51], v[204:207]
    v_exp_f32 v169, v169
    v_mfma_f32_16x16x32_bf16 v[176:179], a[84:87], a[52:55], v[176:179]
    v_cvt_pk_bf16_f32 v184, v168, v169
    v_add_f32 v214, v214, v168
    v_mfma_f32_16x16x32_bf16 v[180:183], a[100:103], a[52:55], v[180:183]
    v_exp_f32 v170, v170
    v_mfma_f32_16x16x32_bf16 v[176:179], a[88:91], a[56:59], v[176:179]
    v_add_f32 v219, v219, v169
    v_add_f32 v214, v214, v170
    v_mfma_f32_16x16x32_bf16 v[180:183], a[104:107], a[56:59], v[180:183]
    v_exp_f32 v171, v171
    v_mfma_f32_16x16x32_bf16 v[176:179], a[92:95], a[60:63], v[176:179]
    v_cvt_pk_bf16_f32 v185, v170, v171
    v_add_f32 v219, v219, v171
    v_mfma_f32_16x16x32_bf16 v[180:183], a[108:111], a[60:63], v[180:183]
    v_exp_f32 v172, v172
    v_mfma_f32_16x16x32_bf16 v[12:15], a[112:115], v[188:191], v[12:15]
    v_exp_f32 v173, v173
    v_mfma_f32_16x16x32_bf16 v[32:35], a[116:119], v[188:191], v[32:35]
    v_cvt_pk_bf16_f32 v186, v172, v173
    v_add_f32 v214, v214, v172
    v_mfma_f32_16x16x32_bf16 v[52:55], a[120:123], v[188:191], v[52:55]
    v_exp_f32 v174, v174
    v_mfma_f32_16x16x32_bf16 v[72:75], a[124:127], v[188:191], v[72:75]
    v_add_f32 v219, v219, v173
    v_add_f32 v214, v214, v174
    v_mfma_f32_16x16x32_bf16 v[92:95], a[128:131], v[188:191], v[92:95]
    v_exp_f32 v175, v175
    v_mfma_f32_16x16x32_bf16 v[112:115], a[132:135], v[188:191], v[112:115]
    v_cvt_pk_bf16_f32 v187, v174, v175
    v_add_f32 v219, v219, v175
    v_mfma_f32_16x16x32_bf16 v[132:135], a[136:139], v[188:191], v[132:135]
    v_mfma_f32_16x16x32_bf16 v[152:155], a[140:143], v[188:191], v[152:155]
    s_waitcnt vmcnt(16)
    v_mfma_f32_16x16x32_bf16 v[168:171], a[80:83], a[64:67], v[208:211]
    ds_read_b128 a[80:83], v222 offset:8192
    v_exp_f32 v176, v176
    v_mfma_f32_16x16x32_bf16 v[172:175], a[96:99], a[64:67], v[208:211]
    ds_read_b128 a[96:99], v222 offset:12288
    v_exp_f32 v177, v177
    v_mfma_f32_16x16x32_bf16 v[168:171], a[84:87], a[68:71], v[168:171]
    ds_read_b128 a[84:87], v223 offset:8192
    v_cvt_pk_bf16_f32 v188, v176, v177
    v_add_f32 v215, v215, v176
    v_mfma_f32_16x16x32_bf16 v[172:175], a[100:103], a[68:71], v[172:175]
    ds_read_b128 a[100:103], v223 offset:12288
    v_exp_f32 v178, v178
    v_mfma_f32_16x16x32_bf16 v[168:171], a[88:91], a[72:75], v[168:171]
    ds_read_b128 a[88:91], v224 offset:8192
    v_add_f32 v220, v220, v177
    v_mfma_f32_16x16x32_bf16 v[172:175], a[104:107], a[72:75], v[172:175]
    ds_read_b128 a[104:107], v224 offset:12288
    v_add_f32 v215, v215, v178
    v_mfma_f32_16x16x32_bf16 v[168:171], a[92:95], a[76:79], v[168:171]
    ds_read_b128 a[92:95], v225 offset:8192
    v_exp_f32 v179, v179
    v_mfma_f32_16x16x32_bf16 v[172:175], a[108:111], a[76:79], v[172:175]
    ds_read_b128 a[108:111], v225 offset:12288
    v_cvt_pk_bf16_f32 v189, v178, v179
    v_mfma_f32_16x16x32_bf16 v[16:19], a[112:115], v[184:187], v[16:19]
    v_exp_f32 v180, v180
    v_mfma_f32_16x16x32_bf16 v[36:39], a[116:119], v[184:187], v[36:39]
    v_add_f32 v220, v220, v179
    v_add_f32 v215, v215, v180
    v_mfma_f32_16x16x32_bf16 v[56:59], a[120:123], v[184:187], v[56:59]
    v_exp_f32 v181, v181
    v_mfma_f32_16x16x32_bf16 v[76:79], a[124:127], v[184:187], v[76:79]
    v_exp_f32 v182, v182
    v_mfma_f32_16x16x32_bf16 v[96:99], a[128:131], v[184:187], v[96:99]
    v_exp_f32 v183, v183
    v_mfma_f32_16x16x32_bf16 v[116:119], a[132:135], v[184:187], v[116:119]
    v_cvt_pk_bf16_f32 v190, v180, v181
    v_cvt_pk_bf16_f32 v191, v182, v183
    v_mfma_f32_16x16x32_bf16 v[136:139], a[136:139], v[184:187], v[136:139]
    v_add_f32 v220, v220, v181
    v_add_f32 v215, v215, v182
    v_mfma_f32_16x16x32_bf16 v[156:159], a[140:143], v[184:187], v[156:159]
    s_waitcnt lgkmcnt(0)
    v_add_f32 v220, v220, v183
    v_mfma_f32_16x16x32_bf16 v[176:179], a[80:83], a[0:3], v[192:195]
    s_mov_b32 m0, s64
    v_exp_f32 v168, v168
    v_exp_f32 v169, v169
    v_mfma_f32_16x16x32_bf16 v[180:183], a[96:99], a[0:3], v[192:195]
    buffer_load_dwordx4 v244, s[20:23], s79 offen offset:0 lds
    v_mfma_f32_16x16x32_bf16 v[176:179], a[84:87], a[4:7], v[176:179]
    v_cvt_pk_bf16_f32 v184, v168, v169
    v_add_f32 v216, v216, v168
    v_add_f32 v221, v221, v169
    v_mfma_f32_16x16x32_bf16 v[180:183], a[100:103], a[4:7], v[180:183]
    v_exp_f32 v170, v170
    v_exp_f32 v171, v171
    v_mfma_f32_16x16x32_bf16 v[176:179], a[88:91], a[8:11], v[176:179]
    buffer_load_dwordx4 v245, s[20:23], s79 offen offset:1024 lds
    v_mfma_f32_16x16x32_bf16 v[180:183], a[104:107], a[8:11], v[180:183]
    v_cvt_pk_bf16_f32 v185, v170, v171
    v_add_f32 v216, v216, v170
    v_add_f32 v221, v221, v171
    v_mfma_f32_16x16x32_bf16 v[176:179], a[92:95], a[12:15], v[176:179]
    v_exp_f32 v172, v172
    v_exp_f32 v173, v173
    v_mfma_f32_16x16x32_bf16 v[180:183], a[108:111], a[12:15], v[180:183]
    buffer_load_dwordx4 v246, s[20:23], s79 offen offset:2048 lds
    v_mfma_f32_16x16x32_bf16 v[20:23], a[112:115], v[188:191], v[20:23]
    v_cvt_pk_bf16_f32 v186, v172, v173
    v_add_f32 v216, v216, v172
    v_add_f32 v221, v221, v173
    v_mfma_f32_16x16x32_bf16 v[40:43], a[116:119], v[188:191], v[40:43]
    v_exp_f32 v174, v174
    v_mfma_f32_16x16x32_bf16 v[60:63], a[120:123], v[188:191], v[60:63]
    buffer_load_dwordx4 v247, s[20:23], s79 offen offset:3072 lds
    v_mfma_f32_16x16x32_bf16 v[80:83], a[124:127], v[188:191], v[80:83]
    v_exp_f32 v175, v175
    v_mfma_f32_16x16x32_bf16 v[100:103], a[128:131], v[188:191], v[100:103]
    s_mov_b32 m0, s65
    v_cvt_pk_bf16_f32 v187, v174, v175
    v_add_f32 v216, v216, v174
    v_mfma_f32_16x16x32_bf16 v[120:123], a[132:135], v[188:191], v[120:123]
    buffer_load_dwordx4 v248, s[20:23], s79 offen offset:0 lds
    v_mfma_f32_16x16x32_bf16 v[140:143], a[136:139], v[188:191], v[140:143]
    v_add_f32 v221, v221, v175
    v_mfma_f32_16x16x32_bf16 v[160:163], a[140:143], v[188:191], v[160:163]
    v_mfma_f32_16x16x32_bf16 v[168:171], a[80:83], a[16:19], v[196:199]
    buffer_load_dwordx4 v249, s[20:23], s79 offen offset:1024 lds
    v_mfma_f32_16x16x32_bf16 v[172:175], a[96:99], a[16:19], v[196:199]
    v_exp_f32 v176, v176
    v_exp_f32 v177, v177
    v_mfma_f32_16x16x32_bf16 v[168:171], a[84:87], a[20:23], v[168:171]
    v_cvt_pk_bf16_f32 v192, v176, v177
    v_add_f32 v212, v212, v176
    v_add_f32 v217, v217, v177
    v_mfma_f32_16x16x32_bf16 v[172:175], a[100:103], a[20:23], v[172:175]
    buffer_load_dwordx4 v250, s[20:23], s79 offen offset:2048 lds
    v_mfma_f32_16x16x32_bf16 v[168:171], a[88:91], a[24:27], v[168:171]
    v_exp_f32 v178, v178
    v_mfma_f32_16x16x32_bf16 v[172:175], a[104:107], a[24:27], v[172:175]
    v_exp_f32 v179, v179
    v_mfma_f32_16x16x32_bf16 v[168:171], a[92:95], a[28:31], v[168:171]
    buffer_load_dwordx4 v251, s[20:23], s79 offen offset:3072 lds
    v_mfma_f32_16x16x32_bf16 v[172:175], a[108:111], a[28:31], v[172:175]
    s_add_u32 s79, s79, 32768
    v_cvt_pk_bf16_f32 v193, v178, v179
    v_add_f32 v212, v212, v178
    v_mfma_f32_16x16x32_bf16 v[24:27], a[112:115], v[184:187], v[24:27]
    s_and_b32 s79, s79, 524287
    v_exp_f32 v180, v180
    v_mfma_f32_16x16x32_bf16 v[44:47], a[116:119], v[184:187], v[44:47]
    v_add_f32 v217, v217, v179
    v_add_f32 v212, v212, v180
    v_mfma_f32_16x16x32_bf16 v[64:67], a[120:123], v[184:187], v[64:67]
    v_exp_f32 v181, v181
    v_mfma_f32_16x16x32_bf16 v[84:87], a[124:127], v[184:187], v[84:87]
    v_exp_f32 v182, v182
    v_mfma_f32_16x16x32_bf16 v[104:107], a[128:131], v[184:187], v[104:107]
    v_exp_f32 v183, v183
    v_mfma_f32_16x16x32_bf16 v[124:127], a[132:135], v[184:187], v[124:127]
    v_cvt_pk_bf16_f32 v194, v180, v181
    v_cvt_pk_bf16_f32 v195, v182, v183
    v_mfma_f32_16x16x32_bf16 v[144:147], a[136:139], v[184:187], v[144:147]
    v_add_f32 v217, v217, v181
    v_add_f32 v212, v212, v182
    v_mfma_f32_16x16x32_bf16 v[164:167], a[140:143], v[184:187], v[164:167]
    v_add_f32 v217, v217, v183
    v_mfma_f32_16x16x32_bf16 v[176:179], a[80:83], a[32:35], v[200:203]
    v_exp_f32 v168, v168
    v_exp_f32 v169, v169
    v_mfma_f32_16x16x32_bf16 v[180:183], a[96:99], a[32:35], v[200:203]
    v_cvt_pk_bf16_f32 v196, v168, v169
    v_add_f32 v213, v213, v168
    v_exp_f32 v170, v170
    v_mfma_f32_16x16x32_bf16 v[176:179], a[84:87], a[36:39], v[176:179]
    v_add_f32 v218, v218, v169
    v_exp_f32 v171, v171
    v_add_f32 v213, v213, v170
    v_mfma_f32_16x16x32_bf16 v[180:183], a[100:103], a[36:39], v[180:183]
    v_exp_f32 v172, v172
    v_cvt_pk_bf16_f32 v197, v170, v171
    v_add_f32 v218, v218, v171
    v_mfma_f32_16x16x32_bf16 v[176:179], a[88:91], a[40:43], v[176:179]
    v_exp_f32 v173, v173
    v_add_f32 v213, v213, v172
    v_mfma_f32_16x16x32_bf16 v[180:183], a[104:107], a[40:43], v[180:183]
    v_exp_f32 v174, v174
    v_cvt_pk_bf16_f32 v198, v172, v173
    v_mfma_f32_16x16x32_bf16 v[176:179], a[92:95], a[44:47], v[176:179]
    v_exp_f32 v175, v175
    v_add_f32 v218, v218, v173
    v_mfma_f32_16x16x32_bf16 v[180:183], a[108:111], a[44:47], v[180:183]
    v_cvt_pk_bf16_f32 v199, v174, v175
    v_add_f32 v213, v213, v174
    v_add_f32 v218, v218, v175
    v_mfma_f32_16x16x32_bf16 v[168:171], a[80:83], a[48:51], v[204:207]
    v_mfma_f32_16x16x32_bf16 v[172:175], a[96:99], a[48:51], v[204:207]
    v_mfma_f32_16x16x32_bf16 v[168:171], a[84:87], a[52:55], v[168:171]
    v_mfma_f32_16x16x32_bf16 v[172:175], a[100:103], a[52:55], v[172:175]
    v_exp_f32 v176, v176
    v_exp_f32 v177, v177
    v_exp_f32 v178, v178
    v_mfma_f32_16x16x32_bf16 v[168:171], a[88:91], a[56:59], v[168:171]
    v_cvt_pk_bf16_f32 v200, v176, v177
    v_add_f32 v214, v214, v176
    v_add_f32 v219, v219, v177
    v_exp_f32 v179, v179
    v_add_f32 v214, v214, v178
    v_mfma_f32_16x16x32_bf16 v[172:175], a[104:107], a[56:59], v[172:175]
    v_exp_f32 v180, v180
    v_exp_f32 v181, v181
    v_cvt_pk_bf16_f32 v201, v178, v179
    v_add_f32 v219, v219, v179
    v_mfma_f32_16x16x32_bf16 v[168:171], a[92:95], a[60:63], v[168:171]
    v_exp_f32 v182, v182
    v_exp_f32 v183, v183
    v_cvt_pk_bf16_f32 v202, v180, v181
    v_mfma_f32_16x16x32_bf16 v[172:175], a[108:111], a[60:63], v[172:175]
    v_cvt_pk_bf16_f32 v203, v182, v183
    v_add_f32 v214, v214, v180
    v_add_f32 v219, v219, v181
    v_add_f32 v214, v214, v182
    v_add_f32 v219, v219, v183
    v_mfma_f32_16x16x32_bf16 v[176:179], a[80:83], a[64:67], v[208:211]
    v_mfma_f32_16x16x32_bf16 v[180:183], a[96:99], a[64:67], v[208:211]
    v_mfma_f32_16x16x32_bf16 v[176:179], a[84:87], a[68:71], v[176:179]
    v_mfma_f32_16x16x32_bf16 v[180:183], a[100:103], a[68:71], v[180:183]
    v_mfma_f32_16x16x32_bf16 v[176:179], a[88:91], a[72:75], v[176:179]
    v_mfma_f32_16x16x32_bf16 v[180:183], a[104:107], a[72:75], v[180:183]
    v_mfma_f32_16x16x32_bf16 v[176:179], a[92:95], a[76:79], v[176:179]
    v_mfma_f32_16x16x32_bf16 v[180:183], a[108:111], a[76:79], v[180:183]
    v_exp_f32 v168, v168
    v_exp_f32 v169, v169
    v_exp_f32 v170, v170
    v_exp_f32 v171, v171
    v_exp_f32 v172, v172
    v_exp_f32 v173, v173
    v_exp_f32 v174, v174
    v_exp_f32 v175, v175
    v_cvt_pk_bf16_f32 v204, v168, v169
    v_cvt_pk_bf16_f32 v205, v170, v171
    v_cvt_pk_bf16_f32 v206, v172, v173
    v_cvt_pk_bf16_f32 v207, v174, v175
    v_add_f32 v215, v215, v168
    v_add_f32 v220, v220, v169
    v_add_f32 v215, v215, v170
    v_add_f32 v220, v220, v171
    v_add_f32 v215, v215, v172
    v_add_f32 v220, v220, v173
    v_add_f32 v215, v215, v174
    v_add_f32 v220, v220, v175
    v_exp_f32 v176, v176
    v_exp_f32 v177, v177
    v_exp_f32 v178, v178
    v_exp_f32 v179, v179
    v_exp_f32 v180, v180
    v_exp_f32 v181, v181
    v_exp_f32 v182, v182
    v_exp_f32 v183, v183
    v_cvt_pk_bf16_f32 v208, v176, v177
    v_cvt_pk_bf16_f32 v209, v178, v179
    v_cvt_pk_bf16_f32 v210, v180, v181
    v_cvt_pk_bf16_f32 v211, v182, v183
    v_add_f32 v216, v216, v176
    v_add_f32 v221, v221, v177
    v_add_f32 v216, v216, v178
    v_add_f32 v221, v221, v179
    v_add_f32 v216, v216, v180
    v_add_f32 v221, v221, v181
    v_add_f32 v216, v216, v182
    v_add_f32 v221, v221, v183
    s_waitcnt vmcnt(16)
    ds_read_b64_tr_b16 a[112:113], v226 offset:8192
    ds_read_b64_tr_b16 a[114:115], v226 offset:12288
    ds_read_b64_tr_b16 a[116:117], v227 offset:8192
    ds_read_b64_tr_b16 a[118:119], v227 offset:12288
    ds_read_b64_tr_b16 a[120:121], v228 offset:8192
    ds_read_b64_tr_b16 a[122:123], v228 offset:12288
    ds_read_b64_tr_b16 a[124:125], v229 offset:8192
    ds_read_b64_tr_b16 a[126:127], v229 offset:12288
    ds_read_b64_tr_b16 a[128:129], v230 offset:8192
    ds_read_b64_tr_b16 a[130:131], v230 offset:12288
    ds_read_b64_tr_b16 a[132:133], v231 offset:8192
    ds_read_b64_tr_b16 a[134:135], v231 offset:12288
    ds_read_b64_tr_b16 a[136:137], v232 offset:8192
    ds_read_b64_tr_b16 a[138:139], v232 offset:12288
    ds_read_b64_tr_b16 a[140:141], v233 offset:8192
    ds_read_b64_tr_b16 a[142:143], v233 offset:12288
    s_mov_b32 s100, s3
    s_lshl_b32 s74, s3, 14
    s_lshl_b32 s75, s3, 12
    v_add_f32 v212, v212, v217
    v_add_f32 v213, v213, v218
    v_add_f32 v214, v214, v219
    v_add_f32 v215, v215, v220
    v_add_f32 v216, v216, v221
    v_mov_b32 v217, v212
    v_mov_b32 v218, v213
    v_mov_b32 v219, v214
    v_mov_b32 v220, v215
    v_mov_b32 v221, v216
    v_permlane32_swap_b32 v217, v212
    v_permlane32_swap_b32 v218, v213
    v_permlane32_swap_b32 v219, v214
    v_permlane32_swap_b32 v220, v215
    v_permlane32_swap_b32 v221, v216
    v_add_f32 v212, v212, v217
    v_add_f32 v213, v213, v218
    v_add_f32 v214, v214, v219
    v_add_f32 v215, v215, v220
    v_add_f32 v216, v216, v221
    v_mov_b32 v217, v212
    v_mov_b32 v218, v213
    v_mov_b32 v219, v214
    v_mov_b32 v220, v215
    v_mov_b32 v221, v216
    v_permlane16_swap_b32 v217, v212
    v_permlane16_swap_b32 v218, v213
    v_permlane16_swap_b32 v219, v214
    v_permlane16_swap_b32 v220, v215
    v_permlane16_swap_b32 v221, v216
    v_add_f32 v212, v212, v217
    v_add_f32 v213, v213, v218
    v_add_f32 v214, v214, v219
    v_add_f32 v215, v215, v220
    v_add_f32 v216, v216, v221
    v_rcp_f32 v217, v212
    v_rcp_f32 v218, v213
    v_rcp_f32 v219, v214
    v_rcp_f32 v220, v215
    v_rcp_f32 v221, v216
    v_add_u32 v176, s74, v240
    v_add_u32 v177, s75, v241
    s_waitcnt lgkmcnt(0)
    v_mfma_f32_16x16x32_bf16 v[8:11], a[112:115], v[192:195], v[8:11]
    v_mfma_f32_16x16x32_bf16 v[28:31], a[116:119], v[192:195], v[28:31]
    v_mfma_f32_16x16x32_bf16 v[48:51], a[120:123], v[192:195], v[48:51]
    v_mfma_f32_16x16x32_bf16 v[68:71], a[124:127], v[192:195], v[68:71]
    v_mfma_f32_16x16x32_bf16 v[88:91], a[128:131], v[192:195], v[88:91]
    v_mfma_f32_16x16x32_bf16 v[108:111], a[132:135], v[192:195], v[108:111]
    v_mfma_f32_16x16x32_bf16 v[128:131], a[136:139], v[192:195], v[128:131]
    v_mfma_f32_16x16x32_bf16 v[148:151], a[140:143], v[192:195], v[148:151]
    v_mfma_f32_16x16x32_bf16 v[12:15], a[112:115], v[196:199], v[12:15]
    v_mfma_f32_16x16x32_bf16 v[32:35], a[116:119], v[196:199], v[32:35]
    v_mfma_f32_16x16x32_bf16 v[52:55], a[120:123], v[196:199], v[52:55]
    v_pk_mul_f32 v[8:9], v[8:9], v[216:217] op_sel:[0,1] op_sel_hi:[1,1]
    v_pk_mul_f32 v[10:11], v[10:11], v[216:217] op_sel:[0,1] op_sel_hi:[1,1]
    v_pk_mul_f32 v[28:29], v[28:29], v[216:217] op_sel:[0,1] op_sel_hi:[1,1]
    v_pk_mul_f32 v[30:31], v[30:31], v[216:217] op_sel:[0,1] op_sel_hi:[1,1]
    v_pk_mul_f32 v[48:49], v[48:49], v[216:217] op_sel:[0,1] op_sel_hi:[1,1]
    v_pk_mul_f32 v[50:51], v[50:51], v[216:217] op_sel:[0,1] op_sel_hi:[1,1]
    v_pk_mul_f32 v[68:69], v[68:69], v[216:217] op_sel:[0,1] op_sel_hi:[1,1]
    v_pk_mul_f32 v[70:71], v[70:71], v[216:217] op_sel:[0,1] op_sel_hi:[1,1]
    v_pk_mul_f32 v[88:89], v[88:89], v[216:217] op_sel:[0,1] op_sel_hi:[1,1]
    v_pk_mul_f32 v[90:91], v[90:91], v[216:217] op_sel:[0,1] op_sel_hi:[1,1]
    v_pk_mul_f32 v[108:109], v[108:109], v[216:217] op_sel:[0,1] op_sel_hi:[1,1]
    v_pk_mul_f32 v[110:111], v[110:111], v[216:217] op_sel:[0,1] op_sel_hi:[1,1]
    v_pk_mul_f32 v[128:129], v[128:129], v[216:217] op_sel:[0,1] op_sel_hi:[1,1]
    v_pk_mul_f32 v[130:131], v[130:131], v[216:217] op_sel:[0,1] op_sel_hi:[1,1]
    v_pk_mul_f32 v[148:149], v[148:149], v[216:217] op_sel:[0,1] op_sel_hi:[1,1]
    v_pk_mul_f32 v[150:151], v[150:151], v[216:217] op_sel:[0,1] op_sel_hi:[1,1]
    v_mfma_f32_16x16x32_bf16 v[72:75], a[124:127], v[196:199], v[72:75]
    v_cvt_pk_bf16_f32 v8, v8, v9
    v_cvt_pk_bf16_f32 v9, v10, v11
    v_cvt_pk_bf16_f32 v10, v28, v29
    v_cvt_pk_bf16_f32 v11, v30, v31
    v_mfma_f32_16x16x32_bf16 v[92:95], a[128:131], v[196:199], v[92:95]
    ds_write_b128 v176, v[8:11] offset:0
    v_cvt_pk_bf16_f32 v48, v48, v49
    v_cvt_pk_bf16_f32 v49, v50, v51
    v_cvt_pk_bf16_f32 v50, v68, v69
    v_cvt_pk_bf16_f32 v51, v70, v71
    v_mfma_f32_16x16x32_bf16 v[112:115], a[132:135], v[196:199], v[112:115]
    ds_write_b128 v176, v[48:51] offset:5120
    v_cvt_pk_bf16_f32 v88, v88, v89
    v_cvt_pk_bf16_f32 v89, v90, v91
    v_cvt_pk_bf16_f32 v90, v108, v109
    v_cvt_pk_bf16_f32 v91, v110, v111
    v_mfma_f32_16x16x32_bf16 v[132:135], a[136:139], v[196:199], v[132:135]
    ds_write_b128 v176, v[88:91] offset:10240
    v_cvt_pk_bf16_f32 v128, v128, v129
    v_cvt_pk_bf16_f32 v129, v130, v131
    v_cvt_pk_bf16_f32 v130, v148, v149
    v_cvt_pk_bf16_f32 v131, v150, v151
    v_mfma_f32_16x16x32_bf16 v[152:155], a[140:143], v[196:199], v[152:155]
    ds_write_b128 v176, v[128:131] offset:15360
    v_mfma_f32_16x16x32_bf16 v[16:19], a[112:115], v[200:203], v[16:19]
    v_mfma_f32_16x16x32_bf16 v[36:39], a[116:119], v[200:203], v[36:39]
    v_mfma_f32_16x16x32_bf16 v[56:59], a[120:123], v[200:203], v[56:59]
    v_pk_mul_f32 v[12:13], v[12:13], v[218:219] op_sel_hi:[1,0]
    v_pk_mul_f32 v[14:15], v[14:15], v[218:219] op_sel_hi:[1,0]
    v_pk_mul_f32 v[32:33], v[32:33], v[218:219] op_sel_hi:[1,0]
    v_pk_mul_f32 v[34:35], v[34:35], v[218:219] op_sel_hi:[1,0]
    v_pk_mul_f32 v[52:53], v[52:53], v[218:219] op_sel_hi:[1,0]
    v_pk_mul_f32 v[54:55], v[54:55], v[218:219] op_sel_hi:[1,0]
    v_pk_mul_f32 v[72:73], v[72:73], v[218:219] op_sel_hi:[1,0]
    v_pk_mul_f32 v[74:75], v[74:75], v[218:219] op_sel_hi:[1,0]
    v_pk_mul_f32 v[92:93], v[92:93], v[218:219] op_sel_hi:[1,0]
    v_pk_mul_f32 v[94:95], v[94:95], v[218:219] op_sel_hi:[1,0]
    v_pk_mul_f32 v[112:113], v[112:113], v[218:219] op_sel_hi:[1,0]
    v_pk_mul_f32 v[114:115], v[114:115], v[218:219] op_sel_hi:[1,0]
    v_pk_mul_f32 v[132:133], v[132:133], v[218:219] op_sel_hi:[1,0]
    v_pk_mul_f32 v[134:135], v[134:135], v[218:219] op_sel_hi:[1,0]
    v_pk_mul_f32 v[152:153], v[152:153], v[218:219] op_sel_hi:[1,0]
    v_pk_mul_f32 v[154:155], v[154:155], v[218:219] op_sel_hi:[1,0]
    v_mfma_f32_16x16x32_bf16 v[76:79], a[124:127], v[200:203], v[76:79]
    v_cvt_pk_bf16_f32 v12, v12, v13
    v_cvt_pk_bf16_f32 v13, v14, v15
    v_cvt_pk_bf16_f32 v14, v32, v33
    v_cvt_pk_bf16_f32 v15, v34, v35
    v_mfma_f32_16x16x32_bf16 v[96:99], a[128:131], v[200:203], v[96:99]
    ds_write_b128 v176, v[12:15] offset:1024
    v_cvt_pk_bf16_f32 v52, v52, v53
    v_cvt_pk_bf16_f32 v53, v54, v55
    v_cvt_pk_bf16_f32 v54, v72, v73
    v_cvt_pk_bf16_f32 v55, v74, v75
    v_mfma_f32_16x16x32_bf16 v[116:119], a[132:135], v[200:203], v[116:119]
    ds_write_b128 v176, v[52:55] offset:6144
    v_cvt_pk_bf16_f32 v92, v92, v93
    v_cvt_pk_bf16_f32 v93, v94, v95
    v_cvt_pk_bf16_f32 v94, v112, v113
    v_cvt_pk_bf16_f32 v95, v114, v115
    v_mfma_f32_16x16x32_bf16 v[136:139], a[136:139], v[200:203], v[136:139]
    ds_write_b128 v176, v[92:95] offset:11264
    v_cvt_pk_bf16_f32 v132, v132, v133
    v_cvt_pk_bf16_f32 v133, v134, v135
    v_cvt_pk_bf16_f32 v134, v152, v153
    v_cvt_pk_bf16_f32 v135, v154, v155
    v_mfma_f32_16x16x32_bf16 v[156:159], a[140:143], v[200:203], v[156:159]
    ds_write_b128 v177, v[132:135] offset:0
    v_mfma_f32_16x16x32_bf16 v[20:23], a[112:115], v[204:207], v[20:23]
    v_mfma_f32_16x16x32_bf16 v[40:43], a[116:119], v[204:207], v[40:43]
    v_mfma_f32_16x16x32_bf16 v[60:63], a[120:123], v[204:207], v[60:63]
    v_pk_mul_f32 v[16:17], v[16:17], v[218:219] op_sel:[0,1] op_sel_hi:[1,1]
    v_pk_mul_f32 v[18:19], v[18:19], v[218:219] op_sel:[0,1] op_sel_hi:[1,1]
    v_pk_mul_f32 v[36:37], v[36:37], v[218:219] op_sel:[0,1] op_sel_hi:[1,1]
    v_pk_mul_f32 v[38:39], v[38:39], v[218:219] op_sel:[0,1] op_sel_hi:[1,1]
    v_pk_mul_f32 v[56:57], v[56:57], v[218:219] op_sel:[0,1] op_sel_hi:[1,1]
    v_pk_mul_f32 v[58:59], v[58:59], v[218:219] op_sel:[0,1] op_sel_hi:[1,1]
    v_pk_mul_f32 v[76:77], v[76:77], v[218:219] op_sel:[0,1] op_sel_hi:[1,1]
    v_pk_mul_f32 v[78:79], v[78:79], v[218:219] op_sel:[0,1] op_sel_hi:[1,1]
    v_pk_mul_f32 v[96:97], v[96:97], v[218:219] op_sel:[0,1] op_sel_hi:[1,1]
    v_pk_mul_f32 v[98:99], v[98:99], v[218:219] op_sel:[0,1] op_sel_hi:[1,1]
    v_pk_mul_f32 v[116:117], v[116:117], v[218:219] op_sel:[0,1] op_sel_hi:[1,1]
    v_pk_mul_f32 v[118:119], v[118:119], v[218:219] op_sel:[0,1] op_sel_hi:[1,1]
    v_pk_mul_f32 v[136:137], v[136:137], v[218:219] op_sel:[0,1] op_sel_hi:[1,1]
    v_pk_mul_f32 v[138:139], v[138:139], v[218:219] op_sel:[0,1] op_sel_hi:[1,1]
    v_pk_mul_f32 v[156:157], v[156:157], v[218:219] op_sel:[0,1] op_sel_hi:[1,1]
    v_pk_mul_f32 v[158:159], v[158:159], v[218:219] op_sel:[0,1] op_sel_hi:[1,1]
    v_mfma_f32_16x16x32_bf16 v[80:83], a[124:127], v[204:207], v[80:83]
    v_cvt_pk_bf16_f32 v16, v16, v17
    v_cvt_pk_bf16_f32 v17, v18, v19
    v_cvt_pk_bf16_f32 v18, v36, v37
    v_cvt_pk_bf16_f32 v19, v38, v39
    v_mfma_f32_16x16x32_bf16 v[100:103], a[128:131], v[204:207], v[100:103]
    ds_write_b128 v176, v[16:19] offset:2048
    v_cvt_pk_bf16_f32 v56, v56, v57
    v_cvt_pk_bf16_f32 v57, v58, v59
    v_cvt_pk_bf16_f32 v58, v76, v77
    v_cvt_pk_bf16_f32 v59, v78, v79
    v_mfma_f32_16x16x32_bf16 v[120:123], a[132:135], v[204:207], v[120:123]
    ds_write_b128 v176, v[56:59] offset:7168
    v_cvt_pk_bf16_f32 v96, v96, v97
    v_cvt_pk_bf16_f32 v97, v98, v99
    v_cvt_pk_bf16_f32 v98, v116, v117
    v_cvt_pk_bf16_f32 v99, v118, v119
    v_mfma_f32_16x16x32_bf16 v[140:143], a[136:139], v[204:207], v[140:143]
    ds_write_b128 v176, v[96:99] offset:12288
    v_cvt_pk_bf16_f32 v136, v136, v137
    v_cvt_pk_bf16_f32 v137, v138, v139
    v_cvt_pk_bf16_f32 v138, v156, v157
    v_cvt_pk_bf16_f32 v139, v158, v159
    v_mfma_f32_16x16x32_bf16 v[160:163], a[140:143], v[204:207], v[160:163]
    ds_write_b128 v177, v[136:139] offset:1024
    v_mfma_f32_16x16x32_bf16 v[24:27], a[112:115], v[208:211], v[24:27]
    v_mfma_f32_16x16x32_bf16 v[44:47], a[116:119], v[208:211], v[44:47]
    v_mfma_f32_16x16x32_bf16 v[64:67], a[120:123], v[208:211], v[64:67]
    v_pk_mul_f32 v[20:21], v[20:21], v[220:221] op_sel_hi:[1,0]
    v_pk_mul_f32 v[22:23], v[22:23], v[220:221] op_sel_hi:[1,0]
    v_pk_mul_f32 v[40:41], v[40:41], v[220:221] op_sel_hi:[1,0]
    v_pk_mul_f32 v[42:43], v[42:43], v[220:221] op_sel_hi:[1,0]
    v_pk_mul_f32 v[60:61], v[60:61], v[220:221] op_sel_hi:[1,0]
    v_pk_mul_f32 v[62:63], v[62:63], v[220:221] op_sel_hi:[1,0]
    v_pk_mul_f32 v[80:81], v[80:81], v[220:221] op_sel_hi:[1,0]
    v_pk_mul_f32 v[82:83], v[82:83], v[220:221] op_sel_hi:[1,0]
    v_pk_mul_f32 v[100:101], v[100:101], v[220:221] op_sel_hi:[1,0]
    v_pk_mul_f32 v[102:103], v[102:103], v[220:221] op_sel_hi:[1,0]
    v_pk_mul_f32 v[120:121], v[120:121], v[220:221] op_sel_hi:[1,0]
    v_pk_mul_f32 v[122:123], v[122:123], v[220:221] op_sel_hi:[1,0]
    v_pk_mul_f32 v[140:141], v[140:141], v[220:221] op_sel_hi:[1,0]
    v_pk_mul_f32 v[142:143], v[142:143], v[220:221] op_sel_hi:[1,0]
    v_pk_mul_f32 v[160:161], v[160:161], v[220:221] op_sel_hi:[1,0]
    v_pk_mul_f32 v[162:163], v[162:163], v[220:221] op_sel_hi:[1,0]
    v_mfma_f32_16x16x32_bf16 v[84:87], a[124:127], v[208:211], v[84:87]
    v_cvt_pk_bf16_f32 v20, v20, v21
    v_cvt_pk_bf16_f32 v21, v22, v23
    v_cvt_pk_bf16_f32 v22, v40, v41
    v_cvt_pk_bf16_f32 v23, v42, v43
    v_mfma_f32_16x16x32_bf16 v[104:107], a[128:131], v[208:211], v[104:107]
    ds_write_b128 v176, v[20:23] offset:3072
    v_cvt_pk_bf16_f32 v60, v60, v61
    v_cvt_pk_bf16_f32 v61, v62, v63
    v_cvt_pk_bf16_f32 v62, v80, v81
    v_cvt_pk_bf16_f32 v63, v82, v83
    v_mfma_f32_16x16x32_bf16 v[124:127], a[132:135], v[208:211], v[124:127]
    ds_write_b128 v176, v[60:63] offset:8192
    v_cvt_pk_bf16_f32 v100, v100, v101
    v_cvt_pk_bf16_f32 v101, v102, v103
    v_cvt_pk_bf16_f32 v102, v120, v121
    v_cvt_pk_bf16_f32 v103, v122, v123
    v_mfma_f32_16x16x32_bf16 v[144:147], a[136:139], v[208:211], v[144:147]
    ds_write_b128 v176, v[100:103] offset:13312
    v_cvt_pk_bf16_f32 v140, v140, v141
    v_cvt_pk_bf16_f32 v141, v142, v143
    v_cvt_pk_bf16_f32 v142, v160, v161
    v_cvt_pk_bf16_f32 v143, v162, v163
    v_mfma_f32_16x16x32_bf16 v[164:167], a[140:143], v[208:211], v[164:167]
    ds_write_b128 v177, v[140:143] offset:2048
    v_pk_mul_f32 v[24:25], v[24:25], v[220:221] op_sel:[0,1] op_sel_hi:[1,1]
    v_pk_mul_f32 v[26:27], v[26:27], v[220:221] op_sel:[0,1] op_sel_hi:[1,1]
    v_pk_mul_f32 v[44:45], v[44:45], v[220:221] op_sel:[0,1] op_sel_hi:[1,1]
    v_pk_mul_f32 v[46:47], v[46:47], v[220:221] op_sel:[0,1] op_sel_hi:[1,1]
    v_pk_mul_f32 v[64:65], v[64:65], v[220:221] op_sel:[0,1] op_sel_hi:[1,1]
    v_pk_mul_f32 v[66:67], v[66:67], v[220:221] op_sel:[0,1] op_sel_hi:[1,1]
    v_pk_mul_f32 v[84:85], v[84:85], v[220:221] op_sel:[0,1] op_sel_hi:[1,1]
    v_pk_mul_f32 v[86:87], v[86:87], v[220:221] op_sel:[0,1] op_sel_hi:[1,1]
    v_pk_mul_f32 v[104:105], v[104:105], v[220:221] op_sel:[0,1] op_sel_hi:[1,1]
    v_pk_mul_f32 v[106:107], v[106:107], v[220:221] op_sel:[0,1] op_sel_hi:[1,1]
    v_pk_mul_f32 v[124:125], v[124:125], v[220:221] op_sel:[0,1] op_sel_hi:[1,1]
    v_pk_mul_f32 v[126:127], v[126:127], v[220:221] op_sel:[0,1] op_sel_hi:[1,1]
    v_pk_mul_f32 v[144:145], v[144:145], v[220:221] op_sel:[0,1] op_sel_hi:[1,1]
    v_pk_mul_f32 v[146:147], v[146:147], v[220:221] op_sel:[0,1] op_sel_hi:[1,1]
    v_pk_mul_f32 v[164:165], v[164:165], v[220:221] op_sel:[0,1] op_sel_hi:[1,1]
    v_pk_mul_f32 v[166:167], v[166:167], v[220:221] op_sel:[0,1] op_sel_hi:[1,1]
    v_cvt_pk_bf16_f32 v24, v24, v25
    v_cvt_pk_bf16_f32 v25, v26, v27
    v_cvt_pk_bf16_f32 v26, v44, v45
    v_cvt_pk_bf16_f32 v27, v46, v47
    ds_write_b128 v176, v[24:27] offset:4096
    v_cvt_pk_bf16_f32 v64, v64, v65
    v_cvt_pk_bf16_f32 v65, v66, v67
    v_cvt_pk_bf16_f32 v66, v84, v85
    v_cvt_pk_bf16_f32 v67, v86, v87
    ds_write_b128 v176, v[64:67] offset:9216
    v_cvt_pk_bf16_f32 v104, v104, v105
    v_cvt_pk_bf16_f32 v105, v106, v107
    v_cvt_pk_bf16_f32 v106, v124, v125
    v_cvt_pk_bf16_f32 v107, v126, v127
    ds_write_b128 v176, v[104:107] offset:14336
    v_cvt_pk_bf16_f32 v144, v144, v145
    v_cvt_pk_bf16_f32 v145, v146, v147
    v_cvt_pk_bf16_f32 v146, v164, v165
    v_cvt_pk_bf16_f32 v147, v166, v167
    ds_write_b128 v177, v[144:147] offset:3072
    s_xor_b32 s80, s77, 1
    s_or_b32 s80, s80, s3
    s_cmp_lg_u32 s80, 0
    s_cbranch_scc1 L_nosig
    s_lshl_b32 s74, s77, 4
    s_add_u32 s74, s74, s78
    s_lshl_b32 s74, s74, 7
    s_add_u32 s74, s74, 25165824
    s_add_u32 s36, s60, s74
    s_addc_u32 s37, s61, 0
    s_and_b32 s37, s37, 0xffff
    s_mov_b32 s38, 64
    s_mov_b32 s39, 0x20000
    s_mov_b64 exec, 1
    v_mov_b32 v1, 1
    v_mov_b32 v7, 32
    s_lshl_b32 s74, s76, 2
    buffer_store_dword v1, v7, s[36:39], s74 offen sc1
    s_mov_b64 exec, -1
L_nosig:
L_join:
    s_mov_b32 s74, 0x5f800000
    v_add_f32 v184, v212, v213
    v_add_f32 v185, v214, v215
    v_add_f32 v184, v184, v216
    v_add_f32 v184, v184, v185
    v_cmp_ngt_f32 vcc, s74, v184
    v_subrev_u32 v226, 0x10000, v226
    v_subrev_u32 v227, 0x10000, v227
    v_subrev_u32 v228, 0x10000, v228
    v_subrev_u32 v229, 0x10000, v229
    v_subrev_u32 v230, 0x10000, v230
    v_subrev_u32 v231, 0x10000, v231
    v_subrev_u32 v232, 0x10000, v232
    v_subrev_u32 v233, 0x10000, v233
    s_cmp_lg_u32 s73, 0
    s_cbranch_scc1 L_epi
    s_cbranch_vccnz L_fallback
L_epi:
    s_cmp_gt_u32 s3, 1
    s_cbranch_scc1 L_nocf
    s_add_u32 s40, s58, 0
    s_addc_u32 s41, s59, 0
    s_and_b32 s41, s41, 0xffff
    s_mov_b32 s42, 256
    s_mov_b32 s43, 0x20000
    s_mov_b64 exec, 1
    v_mov_b32 v6, 0
    buffer_load_dword v6, v6, s[40:43], 0 offen sc1
    s_mov_b64 exec, -1
L_nocf:
    s_waitcnt vmcnt(8) lgkmcnt(0)
    ds_read_b128 a[144:147], v176 offset:0
    ds_read_b128 a[148:151], v176 offset:1024
    ds_read_b128 a[152:155], v176 offset:2048
    ds_read_b128 a[156:159], v176 offset:3072
    ds_read_b128 a[160:163], v176 offset:4096
    ds_read_b64_tr_b16 a[80:81], v226 offset:0
    ds_read_b64_tr_b16 a[84:85], v227 offset:0
    ds_read_b64_tr_b16 a[88:89], v228 offset:0
    ds_read_b64_tr_b16 a[92:93], v229 offset:0
    ds_read_b64_tr_b16 a[96:97], v230 offset:0
    ds_read_b64_tr_b16 a[100:101], v231 offset:0
    ds_read_b64_tr_b16 a[104:105], v232 offset:0
    ds_read_b64_tr_b16 a[108:109], v233 offset:0
    ds_read_b64_tr_b16 a[82:83], v226 offset:4096
    ds_read_b64_tr_b16 a[86:87], v227 offset:4096
    ds_read_b64_tr_b16 a[90:91], v228 offset:4096
    ds_read_b64_tr_b16 a[94:95], v229 offset:4096
    ds_read_b64_tr_b16 a[98:99], v230 offset:4096
    ds_read_b64_tr_b16 a[102:103], v231 offset:4096
    ds_read_b64_tr_b16 a[106:107], v232 offset:4096
    ds_read_b64_tr_b16 a[110:111], v233 offset:4096
    s_waitcnt lgkmcnt(5)
    v_mfma_f32_16x16x32_bf16 v[8:11], a[80:83], a[144:147], 0
    s_mov_b32 m0, s62
    v_mfma_f32_16x16x32_bf16 v[12:15], a[80:83], a[148:151], 0
    buffer_load_dwordx4 v244, s[20:23], s79 offen offset:0 lds
    v_mfma_f32_16x16x32_bf16 v[16:19], a[80:83], a[152:155], 0
    v_mfma_f32_16x16x32_bf16 v[20:23], a[80:83], a[156:159], 0
    v_mfma_f32_16x16x32_bf16 v[24:27], a[80:83], a[160:163], 0
    v_mfma_f32_16x16x32_bf16 v[28:31], a[84:87], a[144:147], 0
    buffer_load_dwordx4 v245, s[20:23], s79 offen offset:1024 lds
    v_mfma_f32_16x16x32_bf16 v[32:35], a[84:87], a[148:151], 0
    v_mfma_f32_16x16x32_bf16 v[36:39], a[84:87], a[152:155], 0
    v_mfma_f32_16x16x32_bf16 v[40:43], a[84:87], a[156:159], 0
    v_mfma_f32_16x16x32_bf16 v[44:47], a[84:87], a[160:163], 0
    buffer_load_dwordx4 v246, s[20:23], s79 offen offset:2048 lds
    v_mfma_f32_16x16x32_bf16 v[48:51], a[88:91], a[144:147], 0
    s_waitcnt lgkmcnt(0)
    v_mfma_f32_16x16x32_bf16 v[52:55], a[88:91], a[148:151], 0
    v_mfma_f32_16x16x32_bf16 v[56:59], a[88:91], a[152:155], 0
    v_mfma_f32_16x16x32_bf16 v[60:63], a[88:91], a[156:159], 0
    buffer_load_dwordx4 v247, s[20:23], s79 offen offset:3072 lds
    v_mfma_f32_16x16x32_bf16 v[64:67], a[88:91], a[160:163], 0
    ds_read_b128 a[164:167], v176 offset:5120
    v_mfma_f32_16x16x32_bf16 v[68:71], a[92:95], a[144:147], 0
    ds_read_b128 a[168:171], v176 offset:6144
    v_mfma_f32_16x16x32_bf16 v[72:75], a[92:95], a[148:151], 0
    s_mov_b32 m0, s63
    ds_read_b128 a[172:175], v176 offset:7168
    v_mfma_f32_16x16x32_bf16 v[76:79], a[92:95], a[152:155], 0
    buffer_load_dwordx4 v248, s[20:23], s79 offen offset:0 lds
    v_mfma_f32_16x16x32_bf16 v[80:83], a[92:95], a[156:159], 0
    ds_read_b128 a[176:179], v176 offset:8192
    v_mfma_f32_16x16x32_bf16 v[84:87], a[92:95], a[160:163], 0
    ds_read_b128 a[180:183], v176 offset:9216
    v_mfma_f32_16x16x32_bf16 v[88:91], a[96:99], a[144:147], 0
    s_waitcnt vmcnt(9)
    ds_read_b64_tr_b16 a[112:113], v226 offset:8192
    v_mfma_f32_16x16x32_bf16 v[92:95], a[96:99], a[148:151], 0
    buffer_load_dwordx4 v249, s[20:23], s79 offen offset:1024 lds
    v_mfma_f32_16x16x32_bf16 v[96:99], a[96:99], a[152:155], 0
    ds_read_b64_tr_b16 a[116:117], v227 offset:8192
    v_mfma_f32_16x16x32_bf16 v[100:103], a[96:99], a[156:159], 0
    ds_read_b64_tr_b16 a[120:121], v228 offset:8192
    v_mfma_f32_16x16x32_bf16 v[104:107], a[96:99], a[160:163], 0
    ds_read_b64_tr_b16 a[124:125], v229 offset:8192
    v_mfma_f32_16x16x32_bf16 v[108:111], a[100:103], a[144:147], 0
    buffer_load_dwordx4 v250, s[20:23], s79 offen offset:2048 lds
    v_mfma_f32_16x16x32_bf16 v[112:115], a[100:103], a[148:151], 0
    ds_read_b64_tr_b16 a[128:129], v230 offset:8192
    v_mfma_f32_16x16x32_bf16 v[116:119], a[100:103], a[152:155], 0
    ds_read_b64_tr_b16 a[132:133], v231 offset:8192
    v_mfma_f32_16x16x32_bf16 v[120:123], a[100:103], a[156:159], 0
    ds_read_b64_tr_b16 a[136:137], v232 offset:8192
    v_mfma_f32_16x16x32_bf16 v[124:127], a[100:103], a[160:163], 0
    buffer_load_dwordx4 v251, s[20:23], s79 offen offset:3072 lds
    v_mfma_f32_16x16x32_bf16 v[128:131], a[104:107], a[144:147], 0
    s_add_u32 s79, s79, 32768
    ds_read_b64_tr_b16 a[140:141], v233 offset:8192
    v_mfma_f32_16x16x32_bf16 v[132:135], a[104:107], a[148:151], 0
    s_and_b32 s79, s79, 524287
    s_waitcnt vmcnt(8)
    ds_read_b64_tr_b16 a[114:115], v226 offset:12288
    v_mfma_f32_16x16x32_bf16 v[136:139], a[104:107], a[152:155], 0
    ds_read_b64_tr_b16 a[118:119], v227 offset:12288
    v_mfma_f32_16x16x32_bf16 v[140:143], a[104:107], a[156:159], 0
    ds_read_b64_tr_b16 a[122:123], v228 offset:12288
    v_mfma_f32_16x16x32_bf16 v[144:147], a[104:107], a[160:163], 0
    ds_read_b64_tr_b16 a[126:127], v229 offset:12288
    v_mfma_f32_16x16x32_bf16 v[148:151], a[108:111], a[144:147], 0
    ds_read_b64_tr_b16 a[130:131], v230 offset:12288
    v_mfma_f32_16x16x32_bf16 v[152:155], a[108:111], a[148:151], 0
    ds_read_b64_tr_b16 a[134:135], v231 offset:12288
    v_mfma_f32_16x16x32_bf16 v[156:159], a[108:111], a[152:155], 0
    ds_read_b64_tr_b16 a[138:139], v232 offset:12288
    v_mfma_f32_16x16x32_bf16 v[160:163], a[108:111], a[156:159], 0
    ds_read_b64_tr_b16 a[142:143], v233 offset:12288
    v_mfma_f32_16x16x32_bf16 v[164:167], a[108:111], a[160:163], 0
    s_waitcnt lgkmcnt(5)
    v_mfma_f32_16x16x32_bf16 v[8:11], a[112:115], a[164:167], v[8:11]
    s_mov_b32 m0, s64
    v_mfma_f32_16x16x32_bf16 v[12:15], a[112:115], a[168:171], v[12:15]
    buffer_load_dwordx4 v244, s[20:23], s79 offen offset:0 lds
    v_mfma_f32_16x16x32_bf16 v[16:19], a[112:115], a[172:175], v[16:19]
    v_mfma_f32_16x16x32_bf16 v[20:23], a[112:115], a[176:179], v[20:23]
    v_mfma_f32_16x16x32_bf16 v[24:27], a[112:115], a[180:183], v[24:27]
    v_mfma_f32_16x16x32_bf16 v[28:31], a[116:119], a[164:167], v[28:31]
    buffer_load_dwordx4 v245, s[20:23], s79 offen offset:1024 lds
    v_mfma_f32_16x16x32_bf16 v[32:35], a[116:119], a[168:171], v[32:35]
    v_mfma_f32_16x16x32_bf16 v[36:39], a[116:119], a[172:175], v[36:39]
    v_mfma_f32_16x16x32_bf16 v[40:43], a[116:119], a[176:179], v[40:43]
    v_mfma_f32_16x16x32_bf16 v[44:47], a[116:119], a[180:183], v[44:47]
    buffer_load_dwordx4 v246, s[20:23], s79 offen offset:2048 lds
    v_mfma_f32_16x16x32_bf16 v[48:51], a[120:123], a[164:167], v[48:51]
    s_waitcnt lgkmcnt(0)
    v_mfma_f32_16x16x32_bf16 v[52:55], a[120:123], a[168:171], v[52:55]
    v_mfma_f32_16x16x32_bf16 v[56:59], a[120:123], a[172:175], v[56:59]
    v_mfma_f32_16x16x32_bf16 v[60:63], a[120:123], a[176:179], v[60:63]
    buffer_load_dwordx4 v247, s[20:23], s79 offen offset:3072 lds
    v_mfma_f32_16x16x32_bf16 v[64:67], a[120:123], a[180:183], v[64:67]
    ds_read_b128 a[144:147], v176 offset:10240
    v_mfma_f32_16x16x32_bf16 v[68:71], a[124:127], a[164:167], v[68:71]
    ds_read_b128 a[148:151], v176 offset:11264
    v_mfma_f32_16x16x32_bf16 v[72:75], a[124:127], a[168:171], v[72:75]
    s_mov_b32 m0, s65
    ds_read_b128 a[152:155], v176 offset:12288
    v_mfma_f32_16x16x32_bf16 v[76:79], a[124:127], a[172:175], v[76:79]
    buffer_load_dwordx4 v248, s[20:23], s79 offen offset:0 lds
    v_mfma_f32_16x16x32_bf16 v[80:83], a[124:127], a[176:179], v[80:83]
    ds_read_b128 a[156:159], v176 offset:13312
    v_mfma_f32_16x16x32_bf16 v[84:87], a[124:127], a[180:183], v[84:87]
    ds_read_b128 a[160:163], v176 offset:14336
    v_mfma_f32_16x16x32_bf16 v[88:91], a[128:131], a[164:167], v[88:91]
    s_waitcnt vmcnt(9)
    ds_read_b64_tr_b16 a[80:81], v226 offset:0
    v_mfma_f32_16x16x32_bf16 v[92:95], a[128:131], a[168:171], v[92:95]
    buffer_load_dwordx4 v249, s[20:23], s79 offen offset:1024 lds
    v_mfma_f32_16x16x32_bf16 v[96:99], a[128:131], a[172:175], v[96:99]
    ds_read_b64_tr_b16 a[84:85], v227 offset:0
    v_mfma_f32_16x16x32_bf16 v[100:103], a[128:131], a[176:179], v[100:103]
    ds_read_b64_tr_b16 a[88:89], v228 offset:0
    v_mfma_f32_16x16x32_bf16 v[104:107], a[128:131], a[180:183], v[104:107]
    ds_read_b64_tr_b16 a[92:93], v229 offset:0
    v_mfma_f32_16x16x32_bf16 v[108:111], a[132:135], a[164:167], v[108:111]
    buffer_load_dwordx4 v250, s[20:23], s79 offen offset:2048 lds
    v_mfma_f32_16x16x32_bf16 v[112:115], a[132:135], a[168:171], v[112:115]
    ds_read_b64_tr_b16 a[96:97], v230 offset:0
    v_mfma_f32_16x16x32_bf16 v[116:119], a[132:135], a[172:175], v[116:119]
    ds_read_b64_tr_b16 a[100:101], v231 offset:0
    v_mfma_f32_16x16x32_bf16 v[120:123], a[132:135], a[176:179], v[120:123]
    ds_read_b64_tr_b16 a[104:105], v232 offset:0
    v_mfma_f32_16x16x32_bf16 v[124:127], a[132:135], a[180:183], v[124:127]
    buffer_load_dwordx4 v251, s[20:23], s79 offen offset:3072 lds
    v_mfma_f32_16x16x32_bf16 v[128:131], a[136:139], a[164:167], v[128:131]
    s_add_u32 s79, s79, 32768
    ds_read_b64_tr_b16 a[108:109], v233 offset:0
    v_mfma_f32_16x16x32_bf16 v[132:135], a[136:139], a[168:171], v[132:135]
    s_and_b32 s79, s79, 524287
    s_waitcnt vmcnt(8)
    ds_read_b64_tr_b16 a[82:83], v226 offset:4096
    v_mfma_f32_16x16x32_bf16 v[136:139], a[136:139], a[172:175], v[136:139]
    ds_read_b64_tr_b16 a[86:87], v227 offset:4096
    v_mfma_f32_16x16x32_bf16 v[140:143], a[136:139], a[176:179], v[140:143]
    ds_read_b64_tr_b16 a[90:91], v228 offset:4096
    v_mfma_f32_16x16x32_bf16 v[144:147], a[136:139], a[180:183], v[144:147]
    ds_read_b64_tr_b16 a[94:95], v229 offset:4096
    v_mfma_f32_16x16x32_bf16 v[148:151], a[140:143], a[164:167], v[148:151]
    ds_read_b64_tr_b16 a[98:99], v230 offset:4096
    v_mfma_f32_16x16x32_bf16 v[152:155], a[140:143], a[168:171], v[152:155]
    ds_read_b64_tr_b16 a[102:103], v231 offset:4096
    v_mfma_f32_16x16x32_bf16 v[156:159], a[140:143], a[172:175], v[156:159]
    ds_read_b64_tr_b16 a[106:107], v232 offset:4096
    v_mfma_f32_16x16x32_bf16 v[160:163], a[140:143], a[176:179], v[160:163]
    ds_read_b64_tr_b16 a[110:111], v233 offset:4096
    v_mfma_f32_16x16x32_bf16 v[164:167], a[140:143], a[180:183], v[164:167]
    s_waitcnt lgkmcnt(5)
    v_mfma_f32_16x16x32_bf16 v[8:11], a[80:83], a[144:147], v[8:11]
    s_mov_b32 m0, s62
    v_mfma_f32_16x16x32_bf16 v[12:15], a[80:83], a[148:151], v[12:15]
    buffer_load_dwordx4 v244, s[20:23], s79 offen offset:0 lds
    v_mfma_f32_16x16x32_bf16 v[16:19], a[80:83], a[152:155], v[16:19]
    v_mfma_f32_16x16x32_bf16 v[20:23], a[80:83], a[156:159], v[20:23]
    v_mfma_f32_16x16x32_bf16 v[24:27], a[80:83], a[160:163], v[24:27]
    v_mfma_f32_16x16x32_bf16 v[28:31], a[84:87], a[144:147], v[28:31]
    buffer_load_dwordx4 v245, s[20:23], s79 offen offset:1024 lds
    v_mfma_f32_16x16x32_bf16 v[32:35], a[84:87], a[148:151], v[32:35]
    v_mfma_f32_16x16x32_bf16 v[36:39], a[84:87], a[152:155], v[36:39]
    v_mfma_f32_16x16x32_bf16 v[40:43], a[84:87], a[156:159], v[40:43]
    v_mfma_f32_16x16x32_bf16 v[44:47], a[84:87], a[160:163], v[44:47]
    buffer_load_dwordx4 v246, s[20:23], s79 offen offset:2048 lds
    v_mfma_f32_16x16x32_bf16 v[48:51], a[88:91], a[144:147], v[48:51]
    s_waitcnt lgkmcnt(0)
    v_mfma_f32_16x16x32_bf16 v[52:55], a[88:91], a[148:151], v[52:55]
    v_mfma_f32_16x16x32_bf16 v[56:59], a[88:91], a[152:155], v[56:59]
    v_mfma_f32_16x16x32_bf16 v[60:63], a[88:91], a[156:159], v[60:63]
    buffer_load_dwordx4 v247, s[20:23], s79 offen offset:3072 lds
    v_mfma_f32_16x16x32_bf16 v[64:67], a[88:91], a[160:163], v[64:67]
    ds_read_b128 a[164:167], v176 offset:15360
    v_mfma_f32_16x16x32_bf16 v[68:71], a[92:95], a[144:147], v[68:71]
    ds_read_b128 a[168:171], v177 offset:0
    v_mfma_f32_16x16x32_bf16 v[72:75], a[92:95], a[148:151], v[72:75]
    s_mov_b32 m0, s63
    ds_read_b128 a[172:175], v177 offset:1024
    v_mfma_f32_16x16x32_bf16 v[76:79], a[92:95], a[152:155], v[76:79]
    buffer_load_dwordx4 v248, s[20:23], s79 offen offset:0 lds
    v_mfma_f32_16x16x32_bf16 v[80:83], a[92:95], a[156:159], v[80:83]
    ds_read_b128 a[176:179], v177 offset:2048
    v_mfma_f32_16x16x32_bf16 v[84:87], a[92:95], a[160:163], v[84:87]
    ds_read_b128 a[180:183], v177 offset:3072
    v_mfma_f32_16x16x32_bf16 v[88:91], a[96:99], a[144:147], v[88:91]
    s_waitcnt vmcnt(9)
    ds_read_b64_tr_b16 a[112:113], v226 offset:8192
    v_mfma_f32_16x16x32_bf16 v[92:95], a[96:99], a[148:151], v[92:95]
    buffer_load_dwordx4 v249, s[20:23], s79 offen offset:1024 lds
    v_mfma_f32_16x16x32_bf16 v[96:99], a[96:99], a[152:155], v[96:99]
    ds_read_b64_tr_b16 a[116:117], v227 offset:8192
    v_mfma_f32_16x16x32_bf16 v[100:103], a[96:99], a[156:159], v[100:103]
    ds_read_b64_tr_b16 a[120:121], v228 offset:8192
    v_mfma_f32_16x16x32_bf16 v[104:107], a[96:99], a[160:163], v[104:107]
    ds_read_b64_tr_b16 a[124:125], v229 offset:8192
    v_mfma_f32_16x16x32_bf16 v[108:111], a[100:103], a[144:147], v[108:111]
    buffer_load_dwordx4 v250, s[20:23], s79 offen offset:2048 lds
    v_mfma_f32_16x16x32_bf16 v[112:115], a[100:103], a[148:151], v[112:115]
    ds_read_b64_tr_b16 a[128:129], v230 offset:8192
    v_mfma_f32_16x16x32_bf16 v[116:119], a[100:103], a[152:155], v[116:119]
    ds_read_b64_tr_b16 a[132:133], v231 offset:8192
    v_mfma_f32_16x16x32_bf16 v[120:123], a[100:103], a[156:159], v[120:123]
    ds_read_b64_tr_b16 a[136:137], v232 offset:8192
    v_mfma_f32_16x16x32_bf16 v[124:127], a[100:103], a[160:163], v[124:127]
    buffer_load_dwordx4 v251, s[20:23], s79 offen offset:3072 lds
    v_mfma_f32_16x16x32_bf16 v[128:131], a[104:107], a[144:147], v[128:131]
    s_add_u32 s79, s79, 32768
    ds_read_b64_tr_b16 a[140:141], v233 offset:8192
    v_mfma_f32_16x16x32_bf16 v[132:135], a[104:107], a[148:151], v[132:135]
    s_and_b32 s79, s79, 524287
    s_waitcnt vmcnt(8)
    ds_read_b64_tr_b16 a[114:115], v226 offset:12288
    v_mfma_f32_16x16x32_bf16 v[136:139], a[104:107], a[152:155], v[136:139]
    ds_read_b64_tr_b16 a[118:119], v227 offset:12288
    v_mfma_f32_16x16x32_bf16 v[140:143], a[104:107], a[156:159], v[140:143]
    ds_read_b64_tr_b16 a[122:123], v228 offset:12288
    v_mfma_f32_16x16x32_bf16 v[144:147], a[104:107], a[160:163], v[144:147]
    ds_read_b64_tr_b16 a[126:127], v229 offset:12288
    v_mfma_f32_16x16x32_bf16 v[148:151], a[108:111], a[144:147], v[148:151]
    ds_read_b64_tr_b16 a[130:131], v230 offset:12288
    v_mfma_f32_16x16x32_bf16 v[152:155], a[108:111], a[148:151], v[152:155]
    ds_read_b64_tr_b16 a[134:135], v231 offset:12288
    v_mfma_f32_16x16x32_bf16 v[156:159], a[108:111], a[152:155], v[156:159]
    ds_read_b64_tr_b16 a[138:139], v232 offset:12288
    v_mfma_f32_16x16x32_bf16 v[160:163], a[108:111], a[156:159], v[160:163]
    ds_read_b64_tr_b16 a[142:143], v233 offset:12288
    v_mfma_f32_16x16x32_bf16 v[164:167], a[108:111], a[160:163], v[164:167]
    s_waitcnt lgkmcnt(5)
    v_mfma_f32_16x16x32_bf16 v[8:11], a[112:115], a[164:167], v[8:11]
    s_mov_b32 m0, s64
    v_mfma_f32_16x16x32_bf16 v[12:15], a[112:115], a[168:171], v[12:15]
    buffer_load_dwordx4 v244, s[20:23], s79 offen offset:0 lds
    v_mfma_f32_16x16x32_bf16 v[16:19], a[112:115], a[172:175], v[16:19]
    s_add_u32 s100, s100, 1
    v_mfma_f32_16x16x32_bf16 v[20:23], a[112:115], a[176:179], v[20:23]
    s_and_b32 s100, s100, 3
    v_mfma_f32_16x16x32_bf16 v[24:27], a[112:115], a[180:183], v[24:27]
    v_mfma_f32_16x16x32_bf16 v[28:31], a[116:119], a[164:167], v[28:31]
    s_lshl_b32 s74, s100, 14
    buffer_load_dwordx4 v245, s[20:23], s79 offen offset:1024 lds
    v_mfma_f32_16x16x32_bf16 v[32:35], a[116:119], a[168:171], v[32:35]
    s_lshl_b32 s75, s100, 12
    v_mfma_f32_16x16x32_bf16 v[36:39], a[116:119], a[172:175], v[36:39]
    v_mfma_f32_16x16x32_bf16 v[40:43], a[116:119], a[176:179], v[40:43]
    v_add_u32 v176, s74, v240
    v_add_u32 v177, s75, v241
    v_mfma_f32_16x16x32_bf16 v[44:47], a[116:119], a[180:183], v[44:47]
    buffer_load_dwordx4 v246, s[20:23], s79 offen offset:2048 lds
    v_mfma_f32_16x16x32_bf16 v[48:51], a[120:123], a[164:167], v[48:51]
    s_waitcnt lgkmcnt(0)
    v_mfma_f32_16x16x32_bf16 v[52:55], a[120:123], a[168:171], v[52:55]
    v_mfma_f32_16x16x32_bf16 v[56:59], a[120:123], a[172:175], v[56:59]
    s_barrier
    v_mfma_f32_16x16x32_bf16 v[60:63], a[120:123], a[176:179], v[60:63]
    buffer_load_dwordx4 v247, s[20:23], s79 offen offset:3072 lds
    v_mfma_f32_16x16x32_bf16 v[64:67], a[120:123], a[180:183], v[64:67]
    ds_read_b128 a[144:147], v176 offset:0
    v_mfma_f32_16x16x32_bf16 v[68:71], a[124:127], a[164:167], v[68:71]
    ds_read_b128 a[148:151], v176 offset:1024
    v_mfma_f32_16x16x32_bf16 v[72:75], a[124:127], a[168:171], v[72:75]
    s_mov_b32 m0, s65
    ds_read_b128 a[152:155], v176 offset:2048
    v_mfma_f32_16x16x32_bf16 v[76:79], a[124:127], a[172:175], v[76:79]
    buffer_load_dwordx4 v248, s[20:23], s79 offen offset:0 lds
    v_mfma_f32_16x16x32_bf16 v[80:83], a[124:127], a[176:179], v[80:83]
    ds_read_b128 a[156:159], v176 offset:3072
    v_mfma_f32_16x16x32_bf16 v[84:87], a[124:127], a[180:183], v[84:87]
    ds_read_b128 a[160:163], v176 offset:4096
    v_mfma_f32_16x16x32_bf16 v[88:91], a[128:131], a[164:167], v[88:91]
    s_waitcnt vmcnt(9)
    ds_read_b64_tr_b16 a[80:81], v226 offset:0
    v_mfma_f32_16x16x32_bf16 v[92:95], a[128:131], a[168:171], v[92:95]
    buffer_load_dwordx4 v249, s[20:23], s79 offen offset:1024 lds
    v_mfma_f32_16x16x32_bf16 v[96:99], a[128:131], a[172:175], v[96:99]
    ds_read_b64_tr_b16 a[84:85], v227 offset:0
    v_mfma_f32_16x16x32_bf16 v[100:103], a[128:131], a[176:179], v[100:103]
    ds_read_b64_tr_b16 a[88:89], v228 offset:0
    v_mfma_f32_16x16x32_bf16 v[104:107], a[128:131], a[180:183], v[104:107]
    ds_read_b64_tr_b16 a[92:93], v229 offset:0
    v_mfma_f32_16x16x32_bf16 v[108:111], a[132:135], a[164:167], v[108:111]
    buffer_load_dwordx4 v250, s[20:23], s79 offen offset:2048 lds
    v_mfma_f32_16x16x32_bf16 v[112:115], a[132:135], a[168:171], v[112:115]
    ds_read_b64_tr_b16 a[96:97], v230 offset:0
    v_mfma_f32_16x16x32_bf16 v[116:119], a[132:135], a[172:175], v[116:119]
    ds_read_b64_tr_b16 a[100:101], v231 offset:0
    v_mfma_f32_16x16x32_bf16 v[120:123], a[132:135], a[176:179], v[120:123]
    ds_read_b64_tr_b16 a[104:105], v232 offset:0
    v_mfma_f32_16x16x32_bf16 v[124:127], a[132:135], a[180:183], v[124:127]
    buffer_load_dwordx4 v251, s[20:23], s79 offen offset:3072 lds
    v_mfma_f32_16x16x32_bf16 v[128:131], a[136:139], a[164:167], v[128:131]
    s_add_u32 s79, s79, 32768
    ds_read_b64_tr_b16 a[108:109], v233 offset:0
    v_mfma_f32_16x16x32_bf16 v[132:135], a[136:139], a[168:171], v[132:135]
    s_and_b32 s79, s79, 524287
    s_waitcnt vmcnt(8)
    ds_read_b64_tr_b16 a[82:83], v226 offset:4096
    v_mfma_f32_16x16x32_bf16 v[136:139], a[136:139], a[172:175], v[136:139]
    ds_read_b64_tr_b16 a[86:87], v227 offset:4096
    v_mfma_f32_16x16x32_bf16 v[140:143], a[136:139], a[176:179], v[140:143]
    ds_read_b64_tr_b16 a[90:91], v228 offset:4096
    v_mfma_f32_16x16x32_bf16 v[144:147], a[136:139], a[180:183], v[144:147]
    ds_read_b64_tr_b16 a[94:95], v229 offset:4096
    v_mfma_f32_16x16x32_bf16 v[148:151], a[140:143], a[164:167], v[148:151]
    ds_read_b64_tr_b16 a[98:99], v230 offset:4096
    v_mfma_f32_16x16x32_bf16 v[152:155], a[140:143], a[168:171], v[152:155]
    ds_read_b64_tr_b16 a[102:103], v231 offset:4096
    v_mfma_f32_16x16x32_bf16 v[156:159], a[140:143], a[172:175], v[156:159]
    ds_read_b64_tr_b16 a[106:107], v232 offset:4096
    v_mfma_f32_16x16x32_bf16 v[160:163], a[140:143], a[176:179], v[160:163]
    ds_read_b64_tr_b16 a[110:111], v233 offset:4096
    v_mfma_f32_16x16x32_bf16 v[164:167], a[140:143], a[180:183], v[164:167]
    s_waitcnt lgkmcnt(5)
    v_mfma_f32_16x16x32_bf16 v[8:11], a[80:83], a[144:147], v[8:11]
    s_mov_b32 m0, s62
    v_mfma_f32_16x16x32_bf16 v[12:15], a[80:83], a[148:151], v[12:15]
    buffer_load_dwordx4 v244, s[20:23], s79 offen offset:0 lds
    v_mfma_f32_16x16x32_bf16 v[16:19], a[80:83], a[152:155], v[16:19]
    v_mfma_f32_16x16x32_bf16 v[20:23], a[80:83], a[156:159], v[20:23]
    v_mfma_f32_16x16x32_bf16 v[24:27], a[80:83], a[160:163], v[24:27]
    v_mfma_f32_16x16x32_bf16 v[28:31], a[84:87], a[144:147], v[28:31]
    buffer_load_dwordx4 v245, s[20:23], s79 offen offset:1024 lds
    v_mfma_f32_16x16x32_bf16 v[32:35], a[84:87], a[148:151], v[32:35]
    v_mfma_f32_16x16x32_bf16 v[36:39], a[84:87], a[152:155], v[36:39]
    v_mfma_f32_16x16x32_bf16 v[40:43], a[84:87], a[156:159], v[40:43]
    v_mfma_f32_16x16x32_bf16 v[44:47], a[84:87], a[160:163], v[44:47]
    buffer_load_dwordx4 v246, s[20:23], s79 offen offset:2048 lds
    v_mfma_f32_16x16x32_bf16 v[48:51], a[88:91], a[144:147], v[48:51]
    s_waitcnt lgkmcnt(0)
    v_mfma_f32_16x16x32_bf16 v[52:55], a[88:91], a[148:151], v[52:55]
    v_mfma_f32_16x16x32_bf16 v[56:59], a[88:91], a[152:155], v[56:59]
    v_mfma_f32_16x16x32_bf16 v[60:63], a[88:91], a[156:159], v[60:63]
    buffer_load_dwordx4 v247, s[20:23], s79 offen offset:3072 lds
    v_mfma_f32_16x16x32_bf16 v[64:67], a[88:91], a[160:163], v[64:67]
    ds_read_b128 a[164:167], v176 offset:5120
    v_mfma_f32_16x16x32_bf16 v[68:71], a[92:95], a[144:147], v[68:71]
    ds_read_b128 a[168:171], v176 offset:6144
    v_mfma_f32_16x16x32_bf16 v[72:75], a[92:95], a[148:151], v[72:75]
    s_mov_b32 m0, s63
    ds_read_b128 a[172:175], v176 offset:7168
    v_mfma_f32_16x16x32_bf16 v[76:79], a[92:95], a[152:155], v[76:79]
    buffer_load_dwordx4 v248, s[20:23], s79 offen offset:0 lds
    v_mfma_f32_16x16x32_bf16 v[80:83], a[92:95], a[156:159], v[80:83]
    ds_read_b128 a[176:179], v176 offset:8192
    v_mfma_f32_16x16x32_bf16 v[84:87], a[92:95], a[160:163], v[84:87]
    ds_read_b128 a[180:183], v176 offset:9216
    v_mfma_f32_16x16x32_bf16 v[88:91], a[96:99], a[144:147], v[88:91]
    s_waitcnt vmcnt(9)
    ds_read_b64_tr_b16 a[112:113], v226 offset:8192
    v_mfma_f32_16x16x32_bf16 v[92:95], a[96:99], a[148:151], v[92:95]
    buffer_load_dwordx4 v249, s[20:23], s79 offen offset:1024 lds
    v_mfma_f32_16x16x32_bf16 v[96:99], a[96:99], a[152:155], v[96:99]
    ds_read_b64_tr_b16 a[116:117], v227 offset:8192
    v_mfma_f32_16x16x32_bf16 v[100:103], a[96:99], a[156:159], v[100:103]
    ds_read_b64_tr_b16 a[120:121], v228 offset:8192
    v_mfma_f32_16x16x32_bf16 v[104:107], a[96:99], a[160:163], v[104:107]
    ds_read_b64_tr_b16 a[124:125], v229 offset:8192
    v_mfma_f32_16x16x32_bf16 v[108:111], a[100:103], a[144:147], v[108:111]
    buffer_load_dwordx4 v250, s[20:23], s79 offen offset:2048 lds
    v_mfma_f32_16x16x32_bf16 v[112:115], a[100:103], a[148:151], v[112:115]
    ds_read_b64_tr_b16 a[128:129], v230 offset:8192
    v_mfma_f32_16x16x32_bf16 v[116:119], a[100:103], a[152:155], v[116:119]
    ds_read_b64_tr_b16 a[132:133], v231 offset:8192
    v_mfma_f32_16x16x32_bf16 v[120:123], a[100:103], a[156:159], v[120:123]
    ds_read_b64_tr_b16 a[136:137], v232 offset:8192
    v_mfma_f32_16x16x32_bf16 v[124:127], a[100:103], a[160:163], v[124:127]
    buffer_load_dwordx4 v251, s[20:23], s79 offen offset:3072 lds
    v_mfma_f32_16x16x32_bf16 v[128:131], a[104:107], a[144:147], v[128:131]
    s_add_u32 s79, s79, 32768
    ds_read_b64_tr_b16 a[140:141], v233 offset:8192
    v_mfma_f32_16x16x32_bf16 v[132:135], a[104:107], a[148:151], v[132:135]
    s_and_b32 s79, s79, 524287
    s_waitcnt vmcnt(8)
    ds_read_b64_tr_b16 a[114:115], v226 offset:12288
    v_mfma_f32_16x16x32_bf16 v[136:139], a[104:107], a[152:155], v[136:139]
    ds_read_b64_tr_b16 a[118:119], v227 offset:12288
    v_mfma_f32_16x16x32_bf16 v[140:143], a[104:107], a[156:159], v[140:143]
    ds_read_b64_tr_b16 a[122:123], v228 offset:12288
    v_mfma_f32_16x16x32_bf16 v[144:147], a[104:107], a[160:163], v[144:147]
    ds_read_b64_tr_b16 a[126:127], v229 offset:12288
    v_mfma_f32_16x16x32_bf16 v[148:151], a[108:111], a[144:147], v[148:151]
    ds_read_b64_tr_b16 a[130:131], v230 offset:12288
    v_mfma_f32_16x16x32_bf16 v[152:155], a[108:111], a[148:151], v[152:155]
    ds_read_b64_tr_b16 a[134:135], v231 offset:12288
    v_mfma_f32_16x16x32_bf16 v[156:159], a[108:111], a[152:155], v[156:159]
    ds_read_b64_tr_b16 a[138:139], v232 offset:12288
    v_mfma_f32_16x16x32_bf16 v[160:163], a[108:111], a[156:159], v[160:163]
    ds_read_b64_tr_b16 a[142:143], v233 offset:12288
    v_mfma_f32_16x16x32_bf16 v[164:167], a[108:111], a[160:163], v[164:167]
    s_waitcnt lgkmcnt(5)
    v_mfma_f32_16x16x32_bf16 v[8:11], a[112:115], a[164:167], v[8:11]
    s_mov_b32 m0, s64
    v_mfma_f32_16x16x32_bf16 v[12:15], a[112:115], a[168:171], v[12:15]
    buffer_load_dwordx4 v244, s[20:23], s79 offen offset:0 lds
    v_mfma_f32_16x16x32_bf16 v[16:19], a[112:115], a[172:175], v[16:19]
    v_mfma_f32_16x16x32_bf16 v[20:23], a[112:115], a[176:179], v[20:23]
    v_mfma_f32_16x16x32_bf16 v[24:27], a[112:115], a[180:183], v[24:27]
    v_mfma_f32_16x16x32_bf16 v[28:31], a[116:119], a[164:167], v[28:31]
    buffer_load_dwordx4 v245, s[20:23], s79 offen offset:1024 lds
    v_mfma_f32_16x16x32_bf16 v[32:35], a[116:119], a[168:171], v[32:35]
    v_mfma_f32_16x16x32_bf16 v[36:39], a[116:119], a[172:175], v[36:39]
    v_mfma_f32_16x16x32_bf16 v[40:43], a[116:119], a[176:179], v[40:43]
    v_mfma_f32_16x16x32_bf16 v[44:47], a[116:119], a[180:183], v[44:47]
    buffer_load_dwordx4 v246, s[20:23], s79 offen offset:2048 lds
    v_mfma_f32_16x16x32_bf16 v[48:51], a[120:123], a[164:167], v[48:51]
    s_waitcnt lgkmcnt(0)
    v_mfma_f32_16x16x32_bf16 v[52:55], a[120:123], a[168:171], v[52:55]
    v_mfma_f32_16x16x32_bf16 v[56:59], a[120:123], a[172:175], v[56:59]
    v_mfma_f32_16x16x32_bf16 v[60:63], a[120:123], a[176:179], v[60:63]
    buffer_load_dwordx4 v247, s[20:23], s79 offen offset:3072 lds
    v_mfma_f32_16x16x32_bf16 v[64:67], a[120:123], a[180:183], v[64:67]
    ds_read_b128 a[144:147], v176 offset:10240
    v_mfma_f32_16x16x32_bf16 v[68:71], a[124:127], a[164:167], v[68:71]
    ds_read_b128 a[148:151], v176 offset:11264
    v_mfma_f32_16x16x32_bf16 v[72:75], a[124:127], a[168:171], v[72:75]
    s_mov_b32 m0, s65
    ds_read_b128 a[152:155], v176 offset:12288
    v_mfma_f32_16x16x32_bf16 v[76:79], a[124:127], a[172:175], v[76:79]
    buffer_load_dwordx4 v248, s[20:23], s79 offen offset:0 lds
    v_mfma_f32_16x16x32_bf16 v[80:83], a[124:127], a[176:179], v[80:83]
    ds_read_b128 a[156:159], v176 offset:13312
    v_mfma_f32_16x16x32_bf16 v[84:87], a[124:127], a[180:183], v[84:87]
    ds_read_b128 a[160:163], v176 offset:14336
    v_mfma_f32_16x16x32_bf16 v[88:91], a[128:131], a[164:167], v[88:91]
    s_waitcnt vmcnt(9)
    ds_read_b64_tr_b16 a[80:81], v226 offset:0
    v_mfma_f32_16x16x32_bf16 v[92:95], a[128:131], a[168:171], v[92:95]
    buffer_load_dwordx4 v249, s[20:23], s79 offen offset:1024 lds
    v_mfma_f32_16x16x32_bf16 v[96:99], a[128:131], a[172:175], v[96:99]
    ds_read_b64_tr_b16 a[84:85], v227 offset:0
    v_mfma_f32_16x16x32_bf16 v[100:103], a[128:131], a[176:179], v[100:103]
    ds_read_b64_tr_b16 a[88:89], v228 offset:0
    v_mfma_f32_16x16x32_bf16 v[104:107], a[128:131], a[180:183], v[104:107]
    ds_read_b64_tr_b16 a[92:93], v229 offset:0
    v_mfma_f32_16x16x32_bf16 v[108:111], a[132:135], a[164:167], v[108:111]
    buffer_load_dwordx4 v250, s[20:23], s79 offen offset:2048 lds
    v_mfma_f32_16x16x32_bf16 v[112:115], a[132:135], a[168:171], v[112:115]
    ds_read_b64_tr_b16 a[96:97], v230 offset:0
    v_mfma_f32_16x16x32_bf16 v[116:119], a[132:135], a[172:175], v[116:119]
    ds_read_b64_tr_b16 a[100:101], v231 offset:0
    v_mfma_f32_16x16x32_bf16 v[120:123], a[132:135], a[176:179], v[120:123]
    ds_read_b64_tr_b16 a[104:105], v232 offset:0
    v_mfma_f32_16x16x32_bf16 v[124:127], a[132:135], a[180:183], v[124:127]
    buffer_load_dwordx4 v251, s[20:23], s79 offen offset:3072 lds
    v_mfma_f32_16x16x32_bf16 v[128:131], a[136:139], a[164:167], v[128:131]
    s_add_u32 s79, s79, 32768
    ds_read_b64_tr_b16 a[108:109], v233 offset:0
    v_mfma_f32_16x16x32_bf16 v[132:135], a[136:139], a[168:171], v[132:135]
    s_and_b32 s79, s79, 524287
    s_waitcnt vmcnt(8)
    ds_read_b64_tr_b16 a[82:83], v226 offset:4096
    v_mfma_f32_16x16x32_bf16 v[136:139], a[136:139], a[172:175], v[136:139]
    ds_read_b64_tr_b16 a[86:87], v227 offset:4096
    v_mfma_f32_16x16x32_bf16 v[140:143], a[136:139], a[176:179], v[140:143]
    ds_read_b64_tr_b16 a[90:91], v228 offset:4096
    v_mfma_f32_16x16x32_bf16 v[144:147], a[136:139], a[180:183], v[144:147]
    ds_read_b64_tr_b16 a[94:95], v229 offset:4096
    v_mfma_f32_16x16x32_bf16 v[148:151], a[140:143], a[164:167], v[148:151]
    ds_read_b64_tr_b16 a[98:99], v230 offset:4096
    v_mfma_f32_16x16x32_bf16 v[152:155], a[140:143], a[168:171], v[152:155]
    ds_read_b64_tr_b16 a[102:103], v231 offset:4096
    v_mfma_f32_16x16x32_bf16 v[156:159], a[140:143], a[172:175], v[156:159]
    ds_read_b64_tr_b16 a[106:107], v232 offset:4096
    v_mfma_f32_16x16x32_bf16 v[160:163], a[140:143], a[176:179], v[160:163]
    ds_read_b64_tr_b16 a[110:111], v233 offset:4096
    v_mfma_f32_16x16x32_bf16 v[164:167], a[140:143], a[180:183], v[164:167]
    s_waitcnt lgkmcnt(5)
    v_mfma_f32_16x16x32_bf16 v[8:11], a[80:83], a[144:147], v[8:11]
    s_mov_b32 m0, s62
    v_mfma_f32_16x16x32_bf16 v[12:15], a[80:83], a[148:151], v[12:15]
    buffer_load_dwordx4 v244, s[20:23], s79 offen offset:0 lds
    v_mfma_f32_16x16x32_bf16 v[16:19], a[80:83], a[152:155], v[16:19]
    v_mfma_f32_16x16x32_bf16 v[20:23], a[80:83], a[156:159], v[20:23]
    v_mfma_f32_16x16x32_bf16 v[24:27], a[80:83], a[160:163], v[24:27]
    v_mfma_f32_16x16x32_bf16 v[28:31], a[84:87], a[144:147], v[28:31]
    buffer_load_dwordx4 v245, s[20:23], s79 offen offset:1024 lds
    v_mfma_f32_16x16x32_bf16 v[32:35], a[84:87], a[148:151], v[32:35]
    v_mfma_f32_16x16x32_bf16 v[36:39], a[84:87], a[152:155], v[36:39]
    v_mfma_f32_16x16x32_bf16 v[40:43], a[84:87], a[156:159], v[40:43]
    v_mfma_f32_16x16x32_bf16 v[44:47], a[84:87], a[160:163], v[44:47]
    buffer_load_dwordx4 v246, s[20:23], s79 offen offset:2048 lds
    v_mfma_f32_16x16x32_bf16 v[48:51], a[88:91], a[144:147], v[48:51]
    s_waitcnt lgkmcnt(0)
    v_mfma_f32_16x16x32_bf16 v[52:55], a[88:91], a[148:151], v[52:55]
    v_mfma_f32_16x16x32_bf16 v[56:59], a[88:91], a[152:155], v[56:59]
    v_mfma_f32_16x16x32_bf16 v[60:63], a[88:91], a[156:159], v[60:63]
    buffer_load_dwordx4 v247, s[20:23], s79 offen offset:3072 lds
    v_mfma_f32_16x16x32_bf16 v[64:67], a[88:91], a[160:163], v[64:67]
    ds_read_b128 a[164:167], v176 offset:15360
    v_mfma_f32_16x16x32_bf16 v[68:71], a[92:95], a[144:147], v[68:71]
    ds_read_b128 a[168:171], v177 offset:0
    v_mfma_f32_16x16x32_bf16 v[72:75], a[92:95], a[148:151], v[72:75]
    s_mov_b32 m0, s63
    ds_read_b128 a[172:175], v177 offset:1024
    v_mfma_f32_16x16x32_bf16 v[76:79], a[92:95], a[152:155], v[76:79]
    buffer_load_dwordx4 v248, s[20:23], s79 offen offset:0 lds
    v_mfma_f32_16x16x32_bf16 v[80:83], a[92:95], a[156:159], v[80:83]
    ds_read_b128 a[176:179], v177 offset:2048
    v_mfma_f32_16x16x32_bf16 v[84:87], a[92:95], a[160:163], v[84:87]
    ds_read_b128 a[180:183], v177 offset:3072
    v_mfma_f32_16x16x32_bf16 v[88:91], a[96:99], a[144:147], v[88:91]
    s_waitcnt vmcnt(9)
    ds_read_b64_tr_b16 a[112:113], v226 offset:8192
    v_mfma_f32_16x16x32_bf16 v[92:95], a[96:99], a[148:151], v[92:95]
    buffer_load_dwordx4 v249, s[20:23], s79 offen offset:1024 lds
    v_mfma_f32_16x16x32_bf16 v[96:99], a[96:99], a[152:155], v[96:99]
    ds_read_b64_tr_b16 a[116:117], v227 offset:8192
    v_mfma_f32_16x16x32_bf16 v[100:103], a[96:99], a[156:159], v[100:103]
    ds_read_b64_tr_b16 a[120:121], v228 offset:8192
    v_mfma_f32_16x16x32_bf16 v[104:107], a[96:99], a[160:163], v[104:107]
    ds_read_b64_tr_b16 a[124:125], v229 offset:8192
    v_mfma_f32_16x16x32_bf16 v[108:111], a[100:103], a[144:147], v[108:111]
    buffer_load_dwordx4 v250, s[20:23], s79 offen offset:2048 lds
    v_mfma_f32_16x16x32_bf16 v[112:115], a[100:103], a[148:151], v[112:115]
    ds_read_b64_tr_b16 a[128:129], v230 offset:8192
    v_mfma_f32_16x16x32_bf16 v[116:119], a[100:103], a[152:155], v[116:119]
    ds_read_b64_tr_b16 a[132:133], v231 offset:8192
    v_mfma_f32_16x16x32_bf16 v[120:123], a[100:103], a[156:159], v[120:123]
    ds_read_b64_tr_b16 a[136:137], v232 offset:8192
    v_mfma_f32_16x16x32_bf16 v[124:127], a[100:103], a[160:163], v[124:127]
    buffer_load_dwordx4 v251, s[20:23], s79 offen offset:3072 lds
    v_mfma_f32_16x16x32_bf16 v[128:131], a[104:107], a[144:147], v[128:131]
    s_add_u32 s79, s79, 32768
    ds_read_b64_tr_b16 a[140:141], v233 offset:8192
    v_mfma_f32_16x16x32_bf16 v[132:135], a[104:107], a[148:151], v[132:135]
    s_and_b32 s79, s79, 524287
    s_waitcnt vmcnt(8)
    ds_read_b64_tr_b16 a[114:115], v226 offset:12288
    v_mfma_f32_16x16x32_bf16 v[136:139], a[104:107], a[152:155], v[136:139]
    ds_read_b64_tr_b16 a[118:119], v227 offset:12288
    v_mfma_f32_16x16x32_bf16 v[140:143], a[104:107], a[156:159], v[140:143]
    ds_read_b64_tr_b16 a[122:123], v228 offset:12288
    v_mfma_f32_16x16x32_bf16 v[144:147], a[104:107], a[160:163], v[144:147]
    ds_read_b64_tr_b16 a[126:127], v229 offset:12288
    v_mfma_f32_16x16x32_bf16 v[148:151], a[108:111], a[144:147], v[148:151]
    ds_read_b64_tr_b16 a[130:131], v230 offset:12288
    v_mfma_f32_16x16x32_bf16 v[152:155], a[108:111], a[148:151], v[152:155]
    ds_read_b64_tr_b16 a[134:135], v231 offset:12288
    v_mfma_f32_16x16x32_bf16 v[156:159], a[108:111], a[152:155], v[156:159]
    ds_read_b64_tr_b16 a[138:139], v232 offset:12288
    v_mfma_f32_16x16x32_bf16 v[160:163], a[108:111], a[156:159], v[160:163]
    ds_read_b64_tr_b16 a[142:143], v233 offset:12288
    v_mfma_f32_16x16x32_bf16 v[164:167], a[108:111], a[160:163], v[164:167]
    s_waitcnt lgkmcnt(5)
    v_mfma_f32_16x16x32_bf16 v[8:11], a[112:115], a[164:167], v[8:11]
    s_mov_b32 m0, s64
    v_mfma_f32_16x16x32_bf16 v[12:15], a[112:115], a[168:171], v[12:15]
    buffer_load_dwordx4 v244, s[20:23], s79 offen offset:0 lds
    v_mfma_f32_16x16x32_bf16 v[16:19], a[112:115], a[172:175], v[16:19]
    s_add_u32 s100, s100, 1
    v_mfma_f32_16x16x32_bf16 v[20:23], a[112:115], a[176:179], v[20:23]
    s_and_b32 s100, s100, 3
    v_mfma_f32_16x16x32_bf16 v[24:27], a[112:115], a[180:183], v[24:27]
    v_mfma_f32_16x16x32_bf16 v[28:31], a[116:119], a[164:167], v[28:31]
    s_lshl_b32 s74, s100, 14
    buffer_load_dwordx4 v245, s[20:23], s79 offen offset:1024 lds
    v_mfma_f32_16x16x32_bf16 v[32:35], a[116:119], a[168:171], v[32:35]
    s_lshl_b32 s75, s100, 12
    v_mfma_f32_16x16x32_bf16 v[36:39], a[116:119], a[172:175], v[36:39]
    v_mfma_f32_16x16x32_bf16 v[40:43], a[116:119], a[176:179], v[40:43]
    v_add_u32 v176, s74, v240
    v_add_u32 v177, s75, v241
    v_mfma_f32_16x16x32_bf16 v[44:47], a[116:119], a[180:183], v[44:47]
    buffer_load_dwordx4 v246, s[20:23], s79 offen offset:2048 lds
    v_mfma_f32_16x16x32_bf16 v[48:51], a[120:123], a[164:167], v[48:51]
    s_waitcnt lgkmcnt(0)
    v_mfma_f32_16x16x32_bf16 v[52:55], a[120:123], a[168:171], v[52:55]
    v_mfma_f32_16x16x32_bf16 v[56:59], a[120:123], a[172:175], v[56:59]
    v_mfma_f32_16x16x32_bf16 v[60:63], a[120:123], a[176:179], v[60:63]
    buffer_load_dwordx4 v247, s[20:23], s79 offen offset:3072 lds
    v_mfma_f32_16x16x32_bf16 v[64:67], a[120:123], a[180:183], v[64:67]
    ds_read_b128 a[144:147], v176 offset:0
    v_mfma_f32_16x16x32_bf16 v[68:71], a[124:127], a[164:167], v[68:71]
    ds_read_b128 a[148:151], v176 offset:1024
    v_mfma_f32_16x16x32_bf16 v[72:75], a[124:127], a[168:171], v[72:75]
    s_mov_b32 m0, s65
    ds_read_b128 a[152:155], v176 offset:2048
    v_mfma_f32_16x16x32_bf16 v[76:79], a[124:127], a[172:175], v[76:79]
    buffer_load_dwordx4 v248, s[20:23], s79 offen offset:0 lds
    v_mfma_f32_16x16x32_bf16 v[80:83], a[124:127], a[176:179], v[80:83]
    ds_read_b128 a[156:159], v176 offset:3072
    v_mfma_f32_16x16x32_bf16 v[84:87], a[124:127], a[180:183], v[84:87]
    ds_read_b128 a[160:163], v176 offset:4096
    v_mfma_f32_16x16x32_bf16 v[88:91], a[128:131], a[164:167], v[88:91]
    s_waitcnt vmcnt(9)
    ds_read_b64_tr_b16 a[80:81], v226 offset:0
    v_mfma_f32_16x16x32_bf16 v[92:95], a[128:131], a[168:171], v[92:95]
    buffer_load_dwordx4 v249, s[20:23], s79 offen offset:1024 lds
    v_mfma_f32_16x16x32_bf16 v[96:99], a[128:131], a[172:175], v[96:99]
    ds_read_b64_tr_b16 a[84:85], v227 offset:0
    v_mfma_f32_16x16x32_bf16 v[100:103], a[128:131], a[176:179], v[100:103]
    ds_read_b64_tr_b16 a[88:89], v228 offset:0
    v_mfma_f32_16x16x32_bf16 v[104:107], a[128:131], a[180:183], v[104:107]
    ds_read_b64_tr_b16 a[92:93], v229 offset:0
    v_mfma_f32_16x16x32_bf16 v[108:111], a[132:135], a[164:167], v[108:111]
    buffer_load_dwordx4 v250, s[20:23], s79 offen offset:2048 lds
    v_mfma_f32_16x16x32_bf16 v[112:115], a[132:135], a[168:171], v[112:115]
    ds_read_b64_tr_b16 a[96:97], v230 offset:0
    v_mfma_f32_16x16x32_bf16 v[116:119], a[132:135], a[172:175], v[116:119]
    ds_read_b64_tr_b16 a[100:101], v231 offset:0
    v_mfma_f32_16x16x32_bf16 v[120:123], a[132:135], a[176:179], v[120:123]
    ds_read_b64_tr_b16 a[104:105], v232 offset:0
    v_mfma_f32_16x16x32_bf16 v[124:127], a[132:135], a[180:183], v[124:127]
    buffer_load_dwordx4 v251, s[20:23], s79 offen offset:3072 lds
    v_mfma_f32_16x16x32_bf16 v[128:131], a[136:139], a[164:167], v[128:131]
    s_add_u32 s79, s79, 32768
    ds_read_b64_tr_b16 a[108:109], v233 offset:0
    v_mfma_f32_16x16x32_bf16 v[132:135], a[136:139], a[168:171], v[132:135]
    s_and_b32 s79, s79, 524287
    s_waitcnt vmcnt(8)
    ds_read_b64_tr_b16 a[82:83], v226 offset:4096
    v_mfma_f32_16x16x32_bf16 v[136:139], a[136:139], a[172:175], v[136:139]
    ds_read_b64_tr_b16 a[86:87], v227 offset:4096
    v_mfma_f32_16x16x32_bf16 v[140:143], a[136:139], a[176:179], v[140:143]
    ds_read_b64_tr_b16 a[90:91], v228 offset:4096
    v_mfma_f32_16x16x32_bf16 v[144:147], a[136:139], a[180:183], v[144:147]
    ds_read_b64_tr_b16 a[94:95], v229 offset:4096
    v_mfma_f32_16x16x32_bf16 v[148:151], a[140:143], a[164:167], v[148:151]
    ds_read_b64_tr_b16 a[98:99], v230 offset:4096
    v_mfma_f32_16x16x32_bf16 v[152:155], a[140:143], a[168:171], v[152:155]
    ds_read_b64_tr_b16 a[102:103], v231 offset:4096
    v_mfma_f32_16x16x32_bf16 v[156:159], a[140:143], a[172:175], v[156:159]
    ds_read_b64_tr_b16 a[106:107], v232 offset:4096
    v_mfma_f32_16x16x32_bf16 v[160:163], a[140:143], a[176:179], v[160:163]
    ds_read_b64_tr_b16 a[110:111], v233 offset:4096
    v_mfma_f32_16x16x32_bf16 v[164:167], a[140:143], a[180:183], v[164:167]
    s_waitcnt lgkmcnt(5)
    v_mfma_f32_16x16x32_bf16 v[8:11], a[80:83], a[144:147], v[8:11]
    s_mov_b32 m0, s62
    v_mfma_f32_16x16x32_bf16 v[12:15], a[80:83], a[148:151], v[12:15]
    buffer_load_dwordx4 v244, s[20:23], s79 offen offset:0 lds
    v_mfma_f32_16x16x32_bf16 v[16:19], a[80:83], a[152:155], v[16:19]
    v_mfma_f32_16x16x32_bf16 v[20:23], a[80:83], a[156:159], v[20:23]
    v_mfma_f32_16x16x32_bf16 v[24:27], a[80:83], a[160:163], v[24:27]
    v_mfma_f32_16x16x32_bf16 v[28:31], a[84:87], a[144:147], v[28:31]
    buffer_load_dwordx4 v245, s[20:23], s79 offen offset:1024 lds
    v_mfma_f32_16x16x32_bf16 v[32:35], a[84:87], a[148:151], v[32:35]
    v_mfma_f32_16x16x32_bf16 v[36:39], a[84:87], a[152:155], v[36:39]
    v_mfma_f32_16x16x32_bf16 v[40:43], a[84:87], a[156:159], v[40:43]
    v_mfma_f32_16x16x32_bf16 v[44:47], a[84:87], a[160:163], v[44:47]
    buffer_load_dwordx4 v246, s[20:23], s79 offen offset:2048 lds
    v_mfma_f32_16x16x32_bf16 v[48:51], a[88:91], a[144:147], v[48:51]
    s_waitcnt lgkmcnt(0)
    v_mfma_f32_16x16x32_bf16 v[52:55], a[88:91], a[148:151], v[52:55]
    v_mfma_f32_16x16x32_bf16 v[56:59], a[88:91], a[152:155], v[56:59]
    v_mfma_f32_16x16x32_bf16 v[60:63], a[88:91], a[156:159], v[60:63]
    buffer_load_dwordx4 v247, s[20:23], s79 offen offset:3072 lds
    v_mfma_f32_16x16x32_bf16 v[64:67], a[88:91], a[160:163], v[64:67]
    ds_read_b128 a[164:167], v176 offset:5120
    v_mfma_f32_16x16x32_bf16 v[68:71], a[92:95], a[144:147], v[68:71]
    ds_read_b128 a[168:171], v176 offset:6144
    v_mfma_f32_16x16x32_bf16 v[72:75], a[92:95], a[148:151], v[72:75]
    s_mov_b32 m0, s63
    ds_read_b128 a[172:175], v176 offset:7168
    v_mfma_f32_16x16x32_bf16 v[76:79], a[92:95], a[152:155], v[76:79]
    buffer_load_dwordx4 v248, s[20:23], s79 offen offset:0 lds
    v_mfma_f32_16x16x32_bf16 v[80:83], a[92:95], a[156:159], v[80:83]
    ds_read_b128 a[176:179], v176 offset:8192
    v_mfma_f32_16x16x32_bf16 v[84:87], a[92:95], a[160:163], v[84:87]
    ds_read_b128 a[180:183], v176 offset:9216
    v_mfma_f32_16x16x32_bf16 v[88:91], a[96:99], a[144:147], v[88:91]
    s_waitcnt vmcnt(9)
    ds_read_b64_tr_b16 a[112:113], v226 offset:8192
    v_mfma_f32_16x16x32_bf16 v[92:95], a[96:99], a[148:151], v[92:95]
    buffer_load_dwordx4 v249, s[20:23], s79 offen offset:1024 lds
    v_mfma_f32_16x16x32_bf16 v[96:99], a[96:99], a[152:155], v[96:99]
    ds_read_b64_tr_b16 a[116:117], v227 offset:8192
    v_mfma_f32_16x16x32_bf16 v[100:103], a[96:99], a[156:159], v[100:103]
    ds_read_b64_tr_b16 a[120:121], v228 offset:8192
    v_mfma_f32_16x16x32_bf16 v[104:107], a[96:99], a[160:163], v[104:107]
    ds_read_b64_tr_b16 a[124:125], v229 offset:8192
    v_mfma_f32_16x16x32_bf16 v[108:111], a[100:103], a[144:147], v[108:111]
    buffer_load_dwordx4 v250, s[20:23], s79 offen offset:2048 lds
    v_mfma_f32_16x16x32_bf16 v[112:115], a[100:103], a[148:151], v[112:115]
    ds_read_b64_tr_b16 a[128:129], v230 offset:8192
    v_mfma_f32_16x16x32_bf16 v[116:119], a[100:103], a[152:155], v[116:119]
    ds_read_b64_tr_b16 a[132:133], v231 offset:8192
    v_mfma_f32_16x16x32_bf16 v[120:123], a[100:103], a[156:159], v[120:123]
    ds_read_b64_tr_b16 a[136:137], v232 offset:8192
    v_mfma_f32_16x16x32_bf16 v[124:127], a[100:103], a[160:163], v[124:127]
    buffer_load_dwordx4 v251, s[20:23], s79 offen offset:3072 lds
    v_mfma_f32_16x16x32_bf16 v[128:131], a[104:107], a[144:147], v[128:131]
    s_add_u32 s79, s79, 32768
    ds_read_b64_tr_b16 a[140:141], v233 offset:8192
    v_mfma_f32_16x16x32_bf16 v[132:135], a[104:107], a[148:151], v[132:135]
    s_and_b32 s79, s79, 524287
    s_waitcnt vmcnt(8)
    ds_read_b64_tr_b16 a[114:115], v226 offset:12288
    v_mfma_f32_16x16x32_bf16 v[136:139], a[104:107], a[152:155], v[136:139]
    ds_read_b64_tr_b16 a[118:119], v227 offset:12288
    v_mfma_f32_16x16x32_bf16 v[140:143], a[104:107], a[156:159], v[140:143]
    ds_read_b64_tr_b16 a[122:123], v228 offset:12288
    v_mfma_f32_16x16x32_bf16 v[144:147], a[104:107], a[160:163], v[144:147]
    ds_read_b64_tr_b16 a[126:127], v229 offset:12288
    v_mfma_f32_16x16x32_bf16 v[148:151], a[108:111], a[144:147], v[148:151]
    ds_read_b64_tr_b16 a[130:131], v230 offset:12288
    v_mfma_f32_16x16x32_bf16 v[152:155], a[108:111], a[148:151], v[152:155]
    ds_read_b64_tr_b16 a[134:135], v231 offset:12288
    v_mfma_f32_16x16x32_bf16 v[156:159], a[108:111], a[152:155], v[156:159]
    ds_read_b64_tr_b16 a[138:139], v232 offset:12288
    v_mfma_f32_16x16x32_bf16 v[160:163], a[108:111], a[156:159], v[160:163]
    ds_read_b64_tr_b16 a[142:143], v233 offset:12288
    v_mfma_f32_16x16x32_bf16 v[164:167], a[108:111], a[160:163], v[164:167]
    s_waitcnt lgkmcnt(5)
    v_mfma_f32_16x16x32_bf16 v[8:11], a[112:115], a[164:167], v[8:11]
    s_mov_b32 m0, s64
    v_mfma_f32_16x16x32_bf16 v[12:15], a[112:115], a[168:171], v[12:15]
    buffer_load_dwordx4 v244, s[20:23], s79 offen offset:0 lds
    v_mfma_f32_16x16x32_bf16 v[16:19], a[112:115], a[172:175], v[16:19]
    v_mfma_f32_16x16x32_bf16 v[20:23], a[112:115], a[176:179], v[20:23]
    v_mfma_f32_16x16x32_bf16 v[24:27], a[112:115], a[180:183], v[24:27]
    v_mfma_f32_16x16x32_bf16 v[28:31], a[116:119], a[164:167], v[28:31]
    buffer_load_dwordx4 v245, s[20:23], s79 offen offset:1024 lds
    v_mfma_f32_16x16x32_bf16 v[32:35], a[116:119], a[168:171], v[32:35]
    v_mfma_f32_16x16x32_bf16 v[36:39], a[116:119], a[172:175], v[36:39]
    v_mfma_f32_16x16x32_bf16 v[40:43], a[116:119], a[176:179], v[40:43]
    v_mfma_f32_16x16x32_bf16 v[44:47], a[116:119], a[180:183], v[44:47]
    buffer_load_dwordx4 v246, s[20:23], s79 offen offset:2048 lds
    v_mfma_f32_16x16x32_bf16 v[48:51], a[120:123], a[164:167], v[48:51]
    s_waitcnt lgkmcnt(0)
    v_mfma_f32_16x16x32_bf16 v[52:55], a[120:123], a[168:171], v[52:55]
    v_mfma_f32_16x16x32_bf16 v[56:59], a[120:123], a[172:175], v[56:59]
    v_mfma_f32_16x16x32_bf16 v[60:63], a[120:123], a[176:179], v[60:63]
    buffer_load_dwordx4 v247, s[20:23], s79 offen offset:3072 lds
    v_mfma_f32_16x16x32_bf16 v[64:67], a[120:123], a[180:183], v[64:67]
    ds_read_b128 a[144:147], v176 offset:10240
    v_mfma_f32_16x16x32_bf16 v[68:71], a[124:127], a[164:167], v[68:71]
    ds_read_b128 a[148:151], v176 offset:11264
    v_mfma_f32_16x16x32_bf16 v[72:75], a[124:127], a[168:171], v[72:75]
    s_mov_b32 m0, s65
    ds_read_b128 a[152:155], v176 offset:12288
    v_mfma_f32_16x16x32_bf16 v[76:79], a[124:127], a[172:175], v[76:79]
    buffer_load_dwordx4 v248, s[20:23], s79 offen offset:0 lds
    v_mfma_f32_16x16x32_bf16 v[80:83], a[124:127], a[176:179], v[80:83]
    ds_read_b128 a[156:159], v176 offset:13312
    v_mfma_f32_16x16x32_bf16 v[84:87], a[124:127], a[180:183], v[84:87]
    ds_read_b128 a[160:163], v176 offset:14336
    v_mfma_f32_16x16x32_bf16 v[88:91], a[128:131], a[164:167], v[88:91]
    s_waitcnt vmcnt(9)
    ds_read_b64_tr_b16 a[80:81], v226 offset:0
    v_mfma_f32_16x16x32_bf16 v[92:95], a[128:131], a[168:171], v[92:95]
    buffer_load_dwordx4 v249, s[20:23], s79 offen offset:1024 lds
    v_mfma_f32_16x16x32_bf16 v[96:99], a[128:131], a[172:175], v[96:99]
    ds_read_b64_tr_b16 a[84:85], v227 offset:0
    v_mfma_f32_16x16x32_bf16 v[100:103], a[128:131], a[176:179], v[100:103]
    ds_read_b64_tr_b16 a[88:89], v228 offset:0
    v_mfma_f32_16x16x32_bf16 v[104:107], a[128:131], a[180:183], v[104:107]
    ds_read_b64_tr_b16 a[92:93], v229 offset:0
    v_mfma_f32_16x16x32_bf16 v[108:111], a[132:135], a[164:167], v[108:111]
    buffer_load_dwordx4 v250, s[20:23], s79 offen offset:2048 lds
    v_mfma_f32_16x16x32_bf16 v[112:115], a[132:135], a[168:171], v[112:115]
    ds_read_b64_tr_b16 a[96:97], v230 offset:0
    v_mfma_f32_16x16x32_bf16 v[116:119], a[132:135], a[172:175], v[116:119]
    ds_read_b64_tr_b16 a[100:101], v231 offset:0
    v_mfma_f32_16x16x32_bf16 v[120:123], a[132:135], a[176:179], v[120:123]
    ds_read_b64_tr_b16 a[104:105], v232 offset:0
    v_mfma_f32_16x16x32_bf16 v[124:127], a[132:135], a[180:183], v[124:127]
    buffer_load_dwordx4 v251, s[20:23], s79 offen offset:3072 lds
    v_mfma_f32_16x16x32_bf16 v[128:131], a[136:139], a[164:167], v[128:131]
    s_add_u32 s79, s79, 32768
    ds_read_b64_tr_b16 a[108:109], v233 offset:0
    v_mfma_f32_16x16x32_bf16 v[132:135], a[136:139], a[168:171], v[132:135]
    s_and_b32 s79, s79, 524287
    s_waitcnt vmcnt(8)
    ds_read_b64_tr_b16 a[82:83], v226 offset:4096
    v_mfma_f32_16x16x32_bf16 v[136:139], a[136:139], a[172:175], v[136:139]
    ds_read_b64_tr_b16 a[86:87], v227 offset:4096
    v_mfma_f32_16x16x32_bf16 v[140:143], a[136:139], a[176:179], v[140:143]
    ds_read_b64_tr_b16 a[90:91], v228 offset:4096
    v_mfma_f32_16x16x32_bf16 v[144:147], a[136:139], a[180:183], v[144:147]
    ds_read_b64_tr_b16 a[94:95], v229 offset:4096
    v_mfma_f32_16x16x32_bf16 v[148:151], a[140:143], a[164:167], v[148:151]
    ds_read_b64_tr_b16 a[98:99], v230 offset:4096
    v_mfma_f32_16x16x32_bf16 v[152:155], a[140:143], a[168:171], v[152:155]
    ds_read_b64_tr_b16 a[102:103], v231 offset:4096
    v_mfma_f32_16x16x32_bf16 v[156:159], a[140:143], a[172:175], v[156:159]
    ds_read_b64_tr_b16 a[106:107], v232 offset:4096
    v_mfma_f32_16x16x32_bf16 v[160:163], a[140:143], a[176:179], v[160:163]
    ds_read_b64_tr_b16 a[110:111], v233 offset:4096
    v_mfma_f32_16x16x32_bf16 v[164:167], a[140:143], a[180:183], v[164:167]
    s_waitcnt lgkmcnt(5)
    v_mfma_f32_16x16x32_bf16 v[8:11], a[80:83], a[144:147], v[8:11]
    s_mov_b32 m0, s62
    v_mfma_f32_16x16x32_bf16 v[12:15], a[80:83], a[148:151], v[12:15]
    buffer_load_dwordx4 v244, s[20:23], s79 offen offset:0 lds
    v_mfma_f32_16x16x32_bf16 v[16:19], a[80:83], a[152:155], v[16:19]
    v_mfma_f32_16x16x32_bf16 v[20:23], a[80:83], a[156:159], v[20:23]
    v_mfma_f32_16x16x32_bf16 v[24:27], a[80:83], a[160:163], v[24:27]
    v_mfma_f32_16x16x32_bf16 v[28:31], a[84:87], a[144:147], v[28:31]
    buffer_load_dwordx4 v245, s[20:23], s79 offen offset:1024 lds
    v_mfma_f32_16x16x32_bf16 v[32:35], a[84:87], a[148:151], v[32:35]
    v_mfma_f32_16x16x32_bf16 v[36:39], a[84:87], a[152:155], v[36:39]
    v_mfma_f32_16x16x32_bf16 v[40:43], a[84:87], a[156:159], v[40:43]
    v_mfma_f32_16x16x32_bf16 v[44:47], a[84:87], a[160:163], v[44:47]
    buffer_load_dwordx4 v246, s[20:23], s79 offen offset:2048 lds
    v_mfma_f32_16x16x32_bf16 v[48:51], a[88:91], a[144:147], v[48:51]
    s_waitcnt lgkmcnt(0)
    v_mfma_f32_16x16x32_bf16 v[52:55], a[88:91], a[148:151], v[52:55]
    v_mfma_f32_16x16x32_bf16 v[56:59], a[88:91], a[152:155], v[56:59]
    v_mfma_f32_16x16x32_bf16 v[60:63], a[88:91], a[156:159], v[60:63]
    buffer_load_dwordx4 v247, s[20:23], s79 offen offset:3072 lds
    v_mfma_f32_16x16x32_bf16 v[64:67], a[88:91], a[160:163], v[64:67]
    ds_read_b128 a[164:167], v176 offset:15360
    v_mfma_f32_16x16x32_bf16 v[68:71], a[92:95], a[144:147], v[68:71]
    ds_read_b128 a[168:171], v177 offset:0
    v_mfma_f32_16x16x32_bf16 v[72:75], a[92:95], a[148:151], v[72:75]
    s_mov_b32 m0, s63
    ds_read_b128 a[172:175], v177 offset:1024
    v_mfma_f32_16x16x32_bf16 v[76:79], a[92:95], a[152:155], v[76:79]
    buffer_load_dwordx4 v248, s[20:23], s79 offen offset:0 lds
    v_mfma_f32_16x16x32_bf16 v[80:83], a[92:95], a[156:159], v[80:83]
    ds_read_b128 a[176:179], v177 offset:2048
    v_mfma_f32_16x16x32_bf16 v[84:87], a[92:95], a[160:163], v[84:87]
    ds_read_b128 a[180:183], v177 offset:3072
    v_mfma_f32_16x16x32_bf16 v[88:91], a[96:99], a[144:147], v[88:91]
    s_waitcnt vmcnt(9)
    ds_read_b64_tr_b16 a[112:113], v226 offset:8192
    v_mfma_f32_16x16x32_bf16 v[92:95], a[96:99], a[148:151], v[92:95]
    buffer_load_dwordx4 v249, s[20:23], s79 offen offset:1024 lds
    v_mfma_f32_16x16x32_bf16 v[96:99], a[96:99], a[152:155], v[96:99]
    ds_read_b64_tr_b16 a[116:117], v227 offset:8192
    v_mfma_f32_16x16x32_bf16 v[100:103], a[96:99], a[156:159], v[100:103]
    ds_read_b64_tr_b16 a[120:121], v228 offset:8192
    v_mfma_f32_16x16x32_bf16 v[104:107], a[96:99], a[160:163], v[104:107]
    ds_read_b64_tr_b16 a[124:125], v229 offset:8192
    v_mfma_f32_16x16x32_bf16 v[108:111], a[100:103], a[144:147], v[108:111]
    buffer_load_dwordx4 v250, s[20:23], s79 offen offset:2048 lds
    v_mfma_f32_16x16x32_bf16 v[112:115], a[100:103], a[148:151], v[112:115]
    ds_read_b64_tr_b16 a[128:129], v230 offset:8192
    v_mfma_f32_16x16x32_bf16 v[116:119], a[100:103], a[152:155], v[116:119]
    ds_read_b64_tr_b16 a[132:133], v231 offset:8192
    v_mfma_f32_16x16x32_bf16 v[120:123], a[100:103], a[156:159], v[120:123]
    ds_read_b64_tr_b16 a[136:137], v232 offset:8192
    v_mfma_f32_16x16x32_bf16 v[124:127], a[100:103], a[160:163], v[124:127]
    buffer_load_dwordx4 v251, s[20:23], s79 offen offset:3072 lds
    v_mfma_f32_16x16x32_bf16 v[128:131], a[104:107], a[144:147], v[128:131]
    s_add_u32 s79, s79, 32768
    ds_read_b64_tr_b16 a[140:141], v233 offset:8192
    v_mfma_f32_16x16x32_bf16 v[132:135], a[104:107], a[148:151], v[132:135]
    s_and_b32 s79, s79, 524287
    s_waitcnt vmcnt(8)
    ds_read_b64_tr_b16 a[114:115], v226 offset:12288
    v_mfma_f32_16x16x32_bf16 v[136:139], a[104:107], a[152:155], v[136:139]
    ds_read_b64_tr_b16 a[118:119], v227 offset:12288
    v_mfma_f32_16x16x32_bf16 v[140:143], a[104:107], a[156:159], v[140:143]
    ds_read_b64_tr_b16 a[122:123], v228 offset:12288
    v_mfma_f32_16x16x32_bf16 v[144:147], a[104:107], a[160:163], v[144:147]
    ds_read_b64_tr_b16 a[126:127], v229 offset:12288
    v_mfma_f32_16x16x32_bf16 v[148:151], a[108:111], a[144:147], v[148:151]
    ds_read_b64_tr_b16 a[130:131], v230 offset:12288
    v_mfma_f32_16x16x32_bf16 v[152:155], a[108:111], a[148:151], v[152:155]
    ds_read_b64_tr_b16 a[134:135], v231 offset:12288
    v_mfma_f32_16x16x32_bf16 v[156:159], a[108:111], a[152:155], v[156:159]
    ds_read_b64_tr_b16 a[138:139], v232 offset:12288
    v_mfma_f32_16x16x32_bf16 v[160:163], a[108:111], a[156:159], v[160:163]
    ds_read_b64_tr_b16 a[142:143], v233 offset:12288
    v_mfma_f32_16x16x32_bf16 v[164:167], a[108:111], a[160:163], v[164:167]
    s_waitcnt lgkmcnt(5)
    v_mfma_f32_16x16x32_bf16 v[8:11], a[112:115], a[164:167], v[8:11]
    s_mov_b32 m0, s64
    v_mfma_f32_16x16x32_bf16 v[12:15], a[112:115], a[168:171], v[12:15]
    buffer_load_dwordx4 v244, s[20:23], s79 offen offset:0 lds
    v_mfma_f32_16x16x32_bf16 v[16:19], a[112:115], a[172:175], v[16:19]
    s_add_u32 s100, s100, 1
    v_mfma_f32_16x16x32_bf16 v[20:23], a[112:115], a[176:179], v[20:23]
    s_and_b32 s100, s100, 3
    v_mfma_f32_16x16x32_bf16 v[24:27], a[112:115], a[180:183], v[24:27]
    v_mfma_f32_16x16x32_bf16 v[28:31], a[116:119], a[164:167], v[28:31]
    s_lshl_b32 s74, s100, 14
    buffer_load_dwordx4 v245, s[20:23], s79 offen offset:1024 lds
    v_mfma_f32_16x16x32_bf16 v[32:35], a[116:119], a[168:171], v[32:35]
    s_lshl_b32 s75, s100, 12
    v_mfma_f32_16x16x32_bf16 v[36:39], a[116:119], a[172:175], v[36:39]
    v_mfma_f32_16x16x32_bf16 v[40:43], a[116:119], a[176:179], v[40:43]
    v_add_u32 v176, s74, v240
    v_add_u32 v177, s75, v241
    v_mfma_f32_16x16x32_bf16 v[44:47], a[116:119], a[180:183], v[44:47]
    buffer_load_dwordx4 v246, s[20:23], s79 offen offset:2048 lds
    v_mfma_f32_16x16x32_bf16 v[48:51], a[120:123], a[164:167], v[48:51]
    s_waitcnt lgkmcnt(0)
    v_mfma_f32_16x16x32_bf16 v[52:55], a[120:123], a[168:171], v[52:55]
    v_mfma_f32_16x16x32_bf16 v[56:59], a[120:123], a[172:175], v[56:59]
    v_mfma_f32_16x16x32_bf16 v[60:63], a[120:123], a[176:179], v[60:63]
    buffer_load_dwordx4 v247, s[20:23], s79 offen offset:3072 lds
    v_mfma_f32_16x16x32_bf16 v[64:67], a[120:123], a[180:183], v[64:67]
    ds_read_b128 a[144:147], v176 offset:0
    v_mfma_f32_16x16x32_bf16 v[68:71], a[124:127], a[164:167], v[68:71]
    ds_read_b128 a[148:151], v176 offset:1024
    v_mfma_f32_16x16x32_bf16 v[72:75], a[124:127], a[168:171], v[72:75]
    s_mov_b32 m0, s65
    ds_read_b128 a[152:155], v176 offset:2048
    v_mfma_f32_16x16x32_bf16 v[76:79], a[124:127], a[172:175], v[76:79]
    buffer_load_dwordx4 v248, s[20:23], s79 offen offset:0 lds
    v_mfma_f32_16x16x32_bf16 v[80:83], a[124:127], a[176:179], v[80:83]
    ds_read_b128 a[156:159], v176 offset:3072
    v_mfma_f32_16x16x32_bf16 v[84:87], a[124:127], a[180:183], v[84:87]
    ds_read_b128 a[160:163], v176 offset:4096
    v_mfma_f32_16x16x32_bf16 v[88:91], a[128:131], a[164:167], v[88:91]
    s_waitcnt vmcnt(9)
    ds_read_b64_tr_b16 a[80:81], v226 offset:0
    v_mfma_f32_16x16x32_bf16 v[92:95], a[128:131], a[168:171], v[92:95]
    buffer_load_dwordx4 v249, s[20:23], s79 offen offset:1024 lds
    v_mfma_f32_16x16x32_bf16 v[96:99], a[128:131], a[172:175], v[96:99]
    ds_read_b64_tr_b16 a[84:85], v227 offset:0
    v_mfma_f32_16x16x32_bf16 v[100:103], a[128:131], a[176:179], v[100:103]
    ds_read_b64_tr_b16 a[88:89], v228 offset:0
    v_mfma_f32_16x16x32_bf16 v[104:107], a[128:131], a[180:183], v[104:107]
    ds_read_b64_tr_b16 a[92:93], v229 offset:0
    v_mfma_f32_16x16x32_bf16 v[108:111], a[132:135], a[164:167], v[108:111]
    buffer_load_dwordx4 v250, s[20:23], s79 offen offset:2048 lds
    v_mfma_f32_16x16x32_bf16 v[112:115], a[132:135], a[168:171], v[112:115]
    ds_read_b64_tr_b16 a[96:97], v230 offset:0
    v_mfma_f32_16x16x32_bf16 v[116:119], a[132:135], a[172:175], v[116:119]
    ds_read_b64_tr_b16 a[100:101], v231 offset:0
    v_mfma_f32_16x16x32_bf16 v[120:123], a[132:135], a[176:179], v[120:123]
    ds_read_b64_tr_b16 a[104:105], v232 offset:0
    v_mfma_f32_16x16x32_bf16 v[124:127], a[132:135], a[180:183], v[124:127]
    buffer_load_dwordx4 v251, s[20:23], s79 offen offset:3072 lds
    v_mfma_f32_16x16x32_bf16 v[128:131], a[136:139], a[164:167], v[128:131]
    s_add_u32 s79, s79, 32768
    ds_read_b64_tr_b16 a[108:109], v233 offset:0
    v_mfma_f32_16x16x32_bf16 v[132:135], a[136:139], a[168:171], v[132:135]
    s_and_b32 s79, s79, 524287
    s_waitcnt vmcnt(8)
    ds_read_b64_tr_b16 a[82:83], v226 offset:4096
    v_mfma_f32_16x16x32_bf16 v[136:139], a[136:139], a[172:175], v[136:139]
    ds_read_b64_tr_b16 a[86:87], v227 offset:4096
    v_mfma_f32_16x16x32_bf16 v[140:143], a[136:139], a[176:179], v[140:143]
    ds_read_b64_tr_b16 a[90:91], v228 offset:4096
    v_mfma_f32_16x16x32_bf16 v[144:147], a[136:139], a[180:183], v[144:147]
    ds_read_b64_tr_b16 a[94:95], v229 offset:4096
    v_mfma_f32_16x16x32_bf16 v[148:151], a[140:143], a[164:167], v[148:151]
    ds_read_b64_tr_b16 a[98:99], v230 offset:4096
    v_mfma_f32_16x16x32_bf16 v[152:155], a[140:143], a[168:171], v[152:155]
    ds_read_b64_tr_b16 a[102:103], v231 offset:4096
    v_mfma_f32_16x16x32_bf16 v[156:159], a[140:143], a[172:175], v[156:159]
    ds_read_b64_tr_b16 a[106:107], v232 offset:4096
    v_mfma_f32_16x16x32_bf16 v[160:163], a[140:143], a[176:179], v[160:163]
    ds_read_b64_tr_b16 a[110:111], v233 offset:4096
    v_mfma_f32_16x16x32_bf16 v[164:167], a[140:143], a[180:183], v[164:167]
L_o12:
    s_waitcnt lgkmcnt(5)
    v_mfma_f32_16x16x32_bf16 v[8:11], a[80:83], a[144:147], v[8:11]
    s_mov_b32 m0, s62
    v_mfma_f32_16x16x32_bf16 v[12:15], a[80:83], a[148:151], v[12:15]
    buffer_load_dwordx4 v244, s[20:23], s79 offen offset:0 lds
    v_mfma_f32_16x16x32_bf16 v[16:19], a[80:83], a[152:155], v[16:19]
    v_mfma_f32_16x16x32_bf16 v[20:23], a[80:83], a[156:159], v[20:23]
    v_mfma_f32_16x16x32_bf16 v[24:27], a[80:83], a[160:163], v[24:27]
    v_mfma_f32_16x16x32_bf16 v[28:31], a[84:87], a[144:147], v[28:31]
    buffer_load_dwordx4 v245, s[20:23], s79 offen offset:1024 lds
    v_mfma_f32_16x16x32_bf16 v[32:35], a[84:87], a[148:151], v[32:35]
    v_mfma_f32_16x16x32_bf16 v[36:39], a[84:87], a[152:155], v[36:39]
    v_mfma_f32_16x16x32_bf16 v[40:43], a[84:87], a[156:159], v[40:43]
    v_mfma_f32_16x16x32_bf16 v[44:47], a[84:87], a[160:163], v[44:47]
    buffer_load_dwordx4 v246, s[20:23], s79 offen offset:2048 lds
    v_mfma_f32_16x16x32_bf16 v[48:51], a[88:91], a[144:147], v[48:51]
    s_waitcnt lgkmcnt(0)
    v_mfma_f32_16x16x32_bf16 v[52:55], a[88:91], a[148:151], v[52:55]
    v_mfma_f32_16x16x32_bf16 v[56:59], a[88:91], a[152:155], v[56:59]
    v_mfma_f32_16x16x32_bf16 v[60:63], a[88:91], a[156:159], v[60:63]
    buffer_load_dwordx4 v247, s[20:23], s79 offen offset:3072 lds
    v_mfma_f32_16x16x32_bf16 v[64:67], a[88:91], a[160:163], v[64:67]
    ds_read_b128 a[164:167], v176 offset:5120
    v_mfma_f32_16x16x32_bf16 v[68:71], a[92:95], a[144:147], v[68:71]
    ds_read_b128 a[168:171], v176 offset:6144
    v_mfma_f32_16x16x32_bf16 v[72:75], a[92:95], a[148:151], v[72:75]
    s_mov_b32 m0, s63
    ds_read_b128 a[172:175], v176 offset:7168
    v_mfma_f32_16x16x32_bf16 v[76:79], a[92:95], a[152:155], v[76:79]
    buffer_load_dwordx4 v248, s[20:23], s79 offen offset:0 lds
    v_mfma_f32_16x16x32_bf16 v[80:83], a[92:95], a[156:159], v[80:83]
    ds_read_b128 a[176:179], v176 offset:8192
    v_mfma_f32_16x16x32_bf16 v[84:87], a[92:95], a[160:163], v[84:87]
    ds_read_b128 a[180:183], v176 offset:9216
    v_mfma_f32_16x16x32_bf16 v[88:91], a[96:99], a[144:147], v[88:91]
    s_waitcnt vmcnt(9)
    ds_read_b64_tr_b16 a[112:113], v226 offset:8192
    v_mfma_f32_16x16x32_bf16 v[92:95], a[96:99], a[148:151], v[92:95]
    buffer_load_dwordx4 v249, s[20:23], s79 offen offset:1024 lds
    v_mfma_f32_16x16x32_bf16 v[96:99], a[96:99], a[152:155], v[96:99]
    ds_read_b64_tr_b16 a[116:117], v227 offset:8192
    v_mfma_f32_16x16x32_bf16 v[100:103], a[96:99], a[156:159], v[100:103]
    ds_read_b64_tr_b16 a[120:121], v228 offset:8192
    v_mfma_f32_16x16x32_bf16 v[104:107], a[96:99], a[160:163], v[104:107]
    ds_read_b64_tr_b16 a[124:125], v229 offset:8192
    v_mfma_f32_16x16x32_bf16 v[108:111], a[100:103], a[144:147], v[108:111]
    buffer_load_dwordx4 v250, s[20:23], s79 offen offset:2048 lds
    v_mfma_f32_16x16x32_bf16 v[112:115], a[100:103], a[148:151], v[112:115]
    ds_read_b64_tr_b16 a[128:129], v230 offset:8192
    v_mfma_f32_16x16x32_bf16 v[116:119], a[100:103], a[152:155], v[116:119]
    ds_read_b64_tr_b16 a[132:133], v231 offset:8192
    v_mfma_f32_16x16x32_bf16 v[120:123], a[100:103], a[156:159], v[120:123]
    ds_read_b64_tr_b16 a[136:137], v232 offset:8192
    v_mfma_f32_16x16x32_bf16 v[124:127], a[100:103], a[160:163], v[124:127]
    buffer_load_dwordx4 v251, s[20:23], s79 offen offset:3072 lds
    v_mfma_f32_16x16x32_bf16 v[128:131], a[104:107], a[144:147], v[128:131]
    s_add_u32 s79, s79, 32768
    ds_read_b64_tr_b16 a[140:141], v233 offset:8192
    v_mfma_f32_16x16x32_bf16 v[132:135], a[104:107], a[148:151], v[132:135]
    s_and_b32 s79, s79, 524287
    s_waitcnt vmcnt(8)
    ds_read_b64_tr_b16 a[114:115], v226 offset:12288
    v_mfma_f32_16x16x32_bf16 v[136:139], a[104:107], a[152:155], v[136:139]
    ds_read_b64_tr_b16 a[118:119], v227 offset:12288
    v_mfma_f32_16x16x32_bf16 v[140:143], a[104:107], a[156:159], v[140:143]
    ds_read_b64_tr_b16 a[122:123], v228 offset:12288
    v_mfma_f32_16x16x32_bf16 v[144:147], a[104:107], a[160:163], v[144:147]
    ds_read_b64_tr_b16 a[126:127], v229 offset:12288
    v_mfma_f32_16x16x32_bf16 v[148:151], a[108:111], a[144:147], v[148:151]
    ds_read_b64_tr_b16 a[130:131], v230 offset:12288
    v_mfma_f32_16x16x32_bf16 v[152:155], a[108:111], a[148:151], v[152:155]
    ds_read_b64_tr_b16 a[134:135], v231 offset:12288
    v_mfma_f32_16x16x32_bf16 v[156:159], a[108:111], a[152:155], v[156:159]
    ds_read_b64_tr_b16 a[138:139], v232 offset:12288
    v_mfma_f32_16x16x32_bf16 v[160:163], a[108:111], a[156:159], v[160:163]
    ds_read_b64_tr_b16 a[142:143], v233 offset:12288
    v_mfma_f32_16x16x32_bf16 v[164:167], a[108:111], a[160:163], v[164:167]
    s_waitcnt lgkmcnt(5)
    v_mfma_f32_16x16x32_bf16 v[8:11], a[112:115], a[164:167], v[8:11]
    s_mov_b32 m0, s64
    v_mfma_f32_16x16x32_bf16 v[12:15], a[112:115], a[168:171], v[12:15]
    buffer_load_dwordx4 v244, s[20:23], s79 offen offset:0 lds
    v_mfma_f32_16x16x32_bf16 v[16:19], a[112:115], a[172:175], v[16:19]
    v_mfma_f32_16x16x32_bf16 v[20:23], a[112:115], a[176:179], v[20:23]
    buffer_load_dwordx4 v245, s[20:23], s79 offen offset:1024 lds
    v_mfma_f32_16x16x32_bf16 v[24:27], a[112:115], a[180:183], v[24:27]
    v_mfma_f32_16x16x32_bf16 v[28:31], a[116:119], a[164:167], v[28:31]
    buffer_load_dwordx4 v246, s[20:23], s79 offen offset:2048 lds
    v_mfma_f32_16x16x32_bf16 v[32:35], a[116:119], a[168:171], v[32:35]
    v_mfma_f32_16x16x32_bf16 v[36:39], a[116:119], a[172:175], v[36:39]
    buffer_load_dwordx4 v247, s[20:23], s79 offen offset:3072 lds
    v_mfma_f32_16x16x32_bf16 v[40:43], a[116:119], a[176:179], v[40:43]
    s_mov_b32 m0, s65
    v_mfma_f32_16x16x32_bf16 v[44:47], a[116:119], a[180:183], v[44:47]
    buffer_load_dwordx4 v248, s[20:23], s79 offen offset:0 lds
    v_mfma_f32_16x16x32_bf16 v[48:51], a[120:123], a[164:167], v[48:51]
    s_waitcnt lgkmcnt(0)
    v_mfma_f32_16x16x32_bf16 v[52:55], a[120:123], a[168:171], v[52:55]
    buffer_load_dwordx4 v249, s[20:23], s79 offen offset:1024 lds
    v_mfma_f32_16x16x32_bf16 v[56:59], a[120:123], a[172:175], v[56:59]
    v_mfma_f32_16x16x32_bf16 v[60:63], a[120:123], a[176:179], v[60:63]
    ds_read_b128 a[144:147], v176 offset:10240
    v_mfma_f32_16x16x32_bf16 v[64:67], a[120:123], a[180:183], v[64:67]
    buffer_load_dwordx4 v250, s[20:23], s79 offen offset:2048 lds
    v_mfma_f32_16x16x32_bf16 v[68:71], a[124:127], a[164:167], v[68:71]
    ds_read_b128 a[148:151], v176 offset:11264
    v_mfma_f32_16x16x32_bf16 v[72:75], a[124:127], a[168:171], v[72:75]
    buffer_load_dwordx4 v251, s[20:23], s79 offen offset:3072 lds
    v_mfma_f32_16x16x32_bf16 v[76:79], a[124:127], a[172:175], v[76:79]
    s_add_u32 s79, s79, 32768
    ds_read_b128 a[152:155], v176 offset:12288
    v_mfma_f32_16x16x32_bf16 v[80:83], a[124:127], a[176:179], v[80:83]
    s_and_b32 s79, s79, 524287
    ds_read_b128 a[156:159], v176 offset:13312
    v_mfma_f32_16x16x32_bf16 v[84:87], a[124:127], a[180:183], v[84:87]
    ds_read_b128 a[160:163], v176 offset:14336
    v_mfma_f32_16x16x32_bf16 v[88:91], a[128:131], a[164:167], v[88:91]
    s_waitcnt vmcnt(12)
    ds_read_b64_tr_b16 a[80:81], v226 offset:0
    v_mfma_f32_16x16x32_bf16 v[92:95], a[128:131], a[168:171], v[92:95]
    ds_read_b64_tr_b16 a[84:85], v227 offset:0
    v_mfma_f32_16x16x32_bf16 v[96:99], a[128:131], a[172:175], v[96:99]
    ds_read_b64_tr_b16 a[88:89], v228 offset:0
    v_mfma_f32_16x16x32_bf16 v[100:103], a[128:131], a[176:179], v[100:103]
    ds_read_b64_tr_b16 a[92:93], v229 offset:0
    v_mfma_f32_16x16x32_bf16 v[104:107], a[128:131], a[180:183], v[104:107]
    ds_read_b64_tr_b16 a[96:97], v230 offset:0
    v_mfma_f32_16x16x32_bf16 v[108:111], a[132:135], a[164:167], v[108:111]
    ds_read_b64_tr_b16 a[100:101], v231 offset:0
    v_mfma_f32_16x16x32_bf16 v[112:115], a[132:135], a[168:171], v[112:115]
    ds_read_b64_tr_b16 a[104:105], v232 offset:0
    v_mfma_f32_16x16x32_bf16 v[116:119], a[132:135], a[172:175], v[116:119]
    ds_read_b64_tr_b16 a[108:109], v233 offset:0
    v_mfma_f32_16x16x32_bf16 v[120:123], a[132:135], a[176:179], v[120:123]
    s_waitcnt vmcnt(8)
    ds_read_b64_tr_b16 a[82:83], v226 offset:4096
    v_mfma_f32_16x16x32_bf16 v[124:127], a[132:135], a[180:183], v[124:127]
    ds_read_b64_tr_b16 a[86:87], v227 offset:4096
    v_mfma_f32_16x16x32_bf16 v[128:131], a[136:139], a[164:167], v[128:131]
    ds_read_b64_tr_b16 a[90:91], v228 offset:4096
    v_mfma_f32_16x16x32_bf16 v[132:135], a[136:139], a[168:171], v[132:135]
    ds_read_b64_tr_b16 a[94:95], v229 offset:4096
    v_mfma_f32_16x16x32_bf16 v[136:139], a[136:139], a[172:175], v[136:139]
    ds_read_b64_tr_b16 a[98:99], v230 offset:4096
    v_mfma_f32_16x16x32_bf16 v[140:143], a[136:139], a[176:179], v[140:143]
    ds_read_b64_tr_b16 a[102:103], v231 offset:4096
    v_mfma_f32_16x16x32_bf16 v[144:147], a[136:139], a[180:183], v[144:147]
    ds_read_b64_tr_b16 a[106:107], v232 offset:4096
    v_mfma_f32_16x16x32_bf16 v[148:151], a[140:143], a[164:167], v[148:151]
    ds_read_b64_tr_b16 a[110:111], v233 offset:4096
    v_mfma_f32_16x16x32_bf16 v[152:155], a[140:143], a[168:171], v[152:155]
    v_mfma_f32_16x16x32_bf16 v[156:159], a[140:143], a[172:175], v[156:159]
    v_mfma_f32_16x16x32_bf16 v[160:163], a[140:143], a[176:179], v[160:163]
    v_mfma_f32_16x16x32_bf16 v[164:167], a[140:143], a[180:183], v[164:167]
    s_cmp_lg_u32 s77, 0
    s_cbranch_scc1 L_nodefer
    s_cmp_lg_u32 s3, 0
    s_cbranch_scc1 L_defer_bar
    s_mov_b32 s74, 16
    s_add_u32 s74, s74, s78
    s_lshl_b32 s74, s74, 7
    s_add_u32 s74, s74, 25165824
    s_add_u32 s36, s60, s74
    s_addc_u32 s37, s61, 0
    s_and_b32 s37, s37, 0xffff
    s_mov_b32 s38, 64
    s_mov_b32 s39, 0x20000
    s_mov_b64 exec, 1
    v_mov_b32 v7, 32
    s_lshl_b32 s74, s76, 2
    s_mov_b32 s72, 0
    v_cmp_gt_u32 vcc, 0x100, v6
    s_cbranch_vccnz L_defer_out
L_defer_poll:
    buffer_load_dword v5, v7, s[36:39], s74 offen sc1
    s_add_u32 s72, s72, 1
    s_cmp_gt_u32 s72, 0x400
    s_cbranch_scc1 L_defer_out
    s_waitcnt vmcnt(0)
    v_cmp_ne_u32 vcc, 1, v5
    s_cbranch_vccnz L_defer_poll
L_defer_out:
    s_mov_b64 exec, -1
L_defer_bar:
    s_barrier
L_nodefer:
    s_waitcnt lgkmcnt(0)
    v_mfma_f32_16x16x32_bf16 v[8:11], a[80:83], a[144:147], v[8:11]
    v_mfma_f32_16x16x32_bf16 v[28:31], a[84:87], a[144:147], v[28:31]
    ds_read_b128 a[164:167], v176 offset:15360
    v_mfma_f32_16x16x32_bf16 v[12:15], a[80:83], a[148:151], v[12:15]
    ds_read_b128 a[168:171], v177 offset:0
    v_mfma_f32_16x16x32_bf16 v[32:35], a[84:87], a[148:151], v[32:35]
    ds_read_b128 a[172:175], v177 offset:1024
    v_mfma_f32_16x16x32_bf16 v[16:19], a[80:83], a[152:155], v[16:19]
    ds_read_b128 a[176:179], v177 offset:2048
    v_mfma_f32_16x16x32_bf16 v[36:39], a[84:87], a[152:155], v[36:39]
    ds_read_b128 a[180:183], v177 offset:3072
    v_mfma_f32_16x16x32_bf16 v[20:23], a[80:83], a[156:159], v[20:23]
    s_waitcnt vmcnt(0)
    ds_read_b64_tr_b16 a[112:113], v226 offset:8192
    v_mfma_f32_16x16x32_bf16 v[40:43], a[84:87], a[156:159], v[40:43]
    ds_read_b64_tr_b16 a[114:115], v226 offset:12288
    v_mfma_f32_16x16x32_bf16 v[24:27], a[80:83], a[160:163], v[24:27]
    ds_read_b64_tr_b16 a[116:117], v227 offset:8192
    v_mfma_f32_16x16x32_bf16 v[44:47], a[84:87], a[160:163], v[44:47]
    ds_read_b64_tr_b16 a[118:119], v227 offset:12288
    v_mfma_f32_16x16x32_bf16 v[48:51], a[88:91], a[144:147], v[48:51]
    ds_read_b64_tr_b16 a[120:121], v228 offset:8192
    v_mfma_f32_16x16x32_bf16 v[68:71], a[92:95], a[144:147], v[68:71]
    ds_read_b64_tr_b16 a[122:123], v228 offset:12288
    v_mfma_f32_16x16x32_bf16 v[52:55], a[88:91], a[148:151], v[52:55]
    ds_read_b64_tr_b16 a[124:125], v229 offset:8192
    v_mfma_f32_16x16x32_bf16 v[72:75], a[92:95], a[148:151], v[72:75]
    ds_read_b64_tr_b16 a[126:127], v229 offset:12288
    v_mfma_f32_16x16x32_bf16 v[56:59], a[88:91], a[152:155], v[56:59]
    ds_read_b64_tr_b16 a[128:129], v230 offset:8192
    v_mfma_f32_16x16x32_bf16 v[76:79], a[92:95], a[152:155], v[76:79]
    ds_read_b64_tr_b16 a[130:131], v230 offset:12288
    v_mfma_f32_16x16x32_bf16 v[60:63], a[88:91], a[156:159], v[60:63]
    ds_read_b64_tr_b16 a[132:133], v231 offset:8192
    v_mfma_f32_16x16x32_bf16 v[80:83], a[92:95], a[156:159], v[80:83]
    ds_read_b64_tr_b16 a[134:135], v231 offset:12288
    v_mfma_f32_16x16x32_bf16 v[64:67], a[88:91], a[160:163], v[64:67]
    ds_read_b64_tr_b16 a[136:137], v232 offset:8192
    v_mfma_f32_16x16x32_bf16 v[84:87], a[92:95], a[160:163], v[84:87]
    s_waitcnt lgkmcnt(5)
    ds_read_b64_tr_b16 a[138:139], v232 offset:12288
    v_mfma_f32_16x16x32_bf16 v[8:11], a[112:115], a[164:167], v[8:11]
    ds_read_b64_tr_b16 a[140:141], v233 offset:8192
    v_mfma_f32_16x16x32_bf16 v[28:31], a[116:119], a[164:167], v[28:31]
    ds_read_b64_tr_b16 a[142:143], v233 offset:12288
    v_mfma_f32_16x16x32_bf16 v[12:15], a[112:115], a[168:171], v[12:15]
    v_mfma_f32_16x16x32_bf16 v[32:35], a[116:119], a[168:171], v[32:35]
    v_mfma_f32_16x16x32_bf16 v[16:19], a[112:115], a[172:175], v[16:19]
    v_mfma_f32_16x16x32_bf16 v[36:39], a[116:119], a[172:175], v[36:39]
    v_mfma_f32_16x16x32_bf16 v[20:23], a[112:115], a[176:179], v[20:23]
    v_cvt_pk_bf16_f32 v8, v8, v9
    v_cvt_pk_bf16_f32 v9, v10, v11
    v_mfma_f32_16x16x32_bf16 v[40:43], a[116:119], a[176:179], v[40:43]
    s_mov_b32 s74, 0
    v_cvt_pk_bf16_f32 v10, v28, v29
    v_cvt_pk_bf16_f32 v11, v30, v31
    v_mfma_f32_16x16x32_bf16 v[24:27], a[112:115], a[180:183], v[24:27]
    buffer_store_dwordx4 v[8:11], v242, s[28:31], s74 offen offset:0 sc1
    v_mfma_f32_16x16x32_bf16 v[44:47], a[116:119], a[180:183], v[44:47]
    v_mfma_f32_16x16x32_bf16 v[48:51], a[120:123], a[164:167], v[48:51]
    s_waitcnt lgkmcnt(0)
    v_cvt_pk_bf16_f32 v12, v12, v13
    v_cvt_pk_bf16_f32 v13, v14, v15
    v_mfma_f32_16x16x32_bf16 v[68:71], a[124:127], a[164:167], v[68:71]
    v_cvt_pk_bf16_f32 v14, v32, v33
    v_cvt_pk_bf16_f32 v15, v34, v35
    v_mfma_f32_16x16x32_bf16 v[52:55], a[120:123], a[168:171], v[52:55]
    buffer_store_dwordx4 v[12:15], v242, s[28:31], s74 offen offset:1024 sc1
    v_mfma_f32_16x16x32_bf16 v[72:75], a[124:127], a[168:171], v[72:75]
    v_mfma_f32_16x16x32_bf16 v[56:59], a[120:123], a[172:175], v[56:59]
    v_cvt_pk_bf16_f32 v16, v16, v17
    v_cvt_pk_bf16_f32 v17, v18, v19
    v_mfma_f32_16x16x32_bf16 v[76:79], a[124:127], a[172:175], v[76:79]
    v_cvt_pk_bf16_f32 v18, v36, v37
    v_cvt_pk_bf16_f32 v19, v38, v39
    v_mfma_f32_16x16x32_bf16 v[60:63], a[120:123], a[176:179], v[60:63]
    buffer_store_dwordx4 v[16:19], v242, s[28:31], s74 offen offset:2048 sc1
    v_mfma_f32_16x16x32_bf16 v[80:83], a[124:127], a[176:179], v[80:83]
    v_mfma_f32_16x16x32_bf16 v[64:67], a[120:123], a[180:183], v[64:67]
    v_cvt_pk_bf16_f32 v20, v20, v21
    v_cvt_pk_bf16_f32 v21, v22, v23
    v_mfma_f32_16x16x32_bf16 v[84:87], a[124:127], a[180:183], v[84:87]
    v_cvt_pk_bf16_f32 v22, v40, v41
    v_cvt_pk_bf16_f32 v23, v42, v43
    v_mfma_f32_16x16x32_bf16 v[88:91], a[96:99], a[144:147], v[88:91]
    buffer_store_dwordx4 v[20:23], v242, s[28:31], s74 offen offset:3072 sc1
    v_mfma_f32_16x16x32_bf16 v[108:111], a[100:103], a[144:147], v[108:111]
    v_mfma_f32_16x16x32_bf16 v[92:95], a[96:99], a[148:151], v[92:95]
    v_cvt_pk_bf16_f32 v24, v24, v25
    v_cvt_pk_bf16_f32 v25, v26, v27
    v_mfma_f32_16x16x32_bf16 v[112:115], a[100:103], a[148:151], v[112:115]
    s_mov_b32 s74, 4096
    v_cvt_pk_bf16_f32 v26, v44, v45
    v_cvt_pk_bf16_f32 v27, v46, v47
    v_mfma_f32_16x16x32_bf16 v[96:99], a[96:99], a[152:155], v[96:99]
    buffer_store_dwordx4 v[24:27], v242, s[28:31], s74 offen offset:0 sc1
    v_mfma_f32_16x16x32_bf16 v[116:119], a[100:103], a[152:155], v[116:119]
    v_mfma_f32_16x16x32_bf16 v[100:103], a[96:99], a[156:159], v[100:103]
    v_cvt_pk_bf16_f32 v48, v48, v49
    v_cvt_pk_bf16_f32 v49, v50, v51
    v_mfma_f32_16x16x32_bf16 v[120:123], a[100:103], a[156:159], v[120:123]
    v_cvt_pk_bf16_f32 v50, v68, v69
    v_cvt_pk_bf16_f32 v51, v70, v71
    v_mfma_f32_16x16x32_bf16 v[104:107], a[96:99], a[160:163], v[104:107]
    buffer_store_dwordx4 v[48:51], v242, s[28:31], s74 offen offset:1024 sc1
    v_mfma_f32_16x16x32_bf16 v[124:127], a[100:103], a[160:163], v[124:127]
    v_mfma_f32_16x16x32_bf16 v[128:131], a[104:107], a[144:147], v[128:131]
    v_cvt_pk_bf16_f32 v52, v52, v53
    v_cvt_pk_bf16_f32 v53, v54, v55
    v_mfma_f32_16x16x32_bf16 v[148:151], a[108:111], a[144:147], v[148:151]
    v_cvt_pk_bf16_f32 v54, v72, v73
    v_cvt_pk_bf16_f32 v55, v74, v75
    v_mfma_f32_16x16x32_bf16 v[132:135], a[104:107], a[148:151], v[132:135]
    buffer_store_dwordx4 v[52:55], v242, s[28:31], s74 offen offset:2048 sc1
    v_mfma_f32_16x16x32_bf16 v[152:155], a[108:111], a[148:151], v[152:155]
    v_mfma_f32_16x16x32_bf16 v[136:139], a[104:107], a[152:155], v[136:139]
    v_cvt_pk_bf16_f32 v56, v56, v57
    v_cvt_pk_bf16_f32 v57, v58, v59
    v_mfma_f32_16x16x32_bf16 v[156:159], a[108:111], a[152:155], v[156:159]
    v_cvt_pk_bf16_f32 v58, v76, v77
    v_cvt_pk_bf16_f32 v59, v78, v79
    v_mfma_f32_16x16x32_bf16 v[140:143], a[104:107], a[156:159], v[140:143]
    buffer_store_dwordx4 v[56:59], v242, s[28:31], s74 offen offset:3072 sc1
    v_mfma_f32_16x16x32_bf16 v[160:163], a[108:111], a[156:159], v[160:163]
    v_mfma_f32_16x16x32_bf16 v[144:147], a[104:107], a[160:163], v[144:147]
    v_cvt_pk_bf16_f32 v60, v60, v61
    v_cvt_pk_bf16_f32 v61, v62, v63
    v_mfma_f32_16x16x32_bf16 v[164:167], a[108:111], a[160:163], v[164:167]
    s_mov_b32 s74, 8192
    v_cvt_pk_bf16_f32 v62, v80, v81
    v_cvt_pk_bf16_f32 v63, v82, v83
    v_mfma_f32_16x16x32_bf16 v[88:91], a[128:131], a[164:167], v[88:91]
    buffer_store_dwordx4 v[60:63], v242, s[28:31], s74 offen offset:0 sc1
    v_mfma_f32_16x16x32_bf16 v[108:111], a[132:135], a[164:167], v[108:111]
    v_mfma_f32_16x16x32_bf16 v[92:95], a[128:131], a[168:171], v[92:95]
    v_cvt_pk_bf16_f32 v64, v64, v65
    v_cvt_pk_bf16_f32 v65, v66, v67
    v_mfma_f32_16x16x32_bf16 v[112:115], a[132:135], a[168:171], v[112:115]
    v_cvt_pk_bf16_f32 v66, v84, v85
    v_cvt_pk_bf16_f32 v67, v86, v87
    v_mfma_f32_16x16x32_bf16 v[96:99], a[128:131], a[172:175], v[96:99]
    buffer_store_dwordx4 v[64:67], v242, s[28:31], s74 offen offset:1024 sc1
    v_mfma_f32_16x16x32_bf16 v[116:119], a[132:135], a[172:175], v[116:119]
    v_mfma_f32_16x16x32_bf16 v[100:103], a[128:131], a[176:179], v[100:103]
    v_cvt_pk_bf16_f32 v88, v88, v89
    v_cvt_pk_bf16_f32 v89, v90, v91
    v_mfma_f32_16x16x32_bf16 v[120:123], a[132:135], a[176:179], v[120:123]
    v_cvt_pk_bf16_f32 v90, v108, v109
    v_cvt_pk_bf16_f32 v91, v110, v111
    v_mfma_f32_16x16x32_bf16 v[104:107], a[128:131], a[180:183], v[104:107]
    buffer_store_dwordx4 v[88:91], v242, s[28:31], s74 offen offset:2048 sc1
    v_mfma_f32_16x16x32_bf16 v[124:127], a[132:135], a[180:183], v[124:127]
    v_cvt_pk_bf16_f32 v92, v92, v93
    v_cvt_pk_bf16_f32 v93, v94, v95
    v_mfma_f32_16x16x32_bf16 v[128:131], a[136:139], a[164:167], v[128:131]
    v_cvt_pk_bf16_f32 v94, v112, v113
    v_cvt_pk_bf16_f32 v95, v114, v115
    v_mfma_f32_16x16x32_bf16 v[148:151], a[140:143], a[164:167], v[148:151]
    buffer_store_dwordx4 v[92:95], v242, s[28:31], s74 offen offset:3072 sc1
    v_mfma_f32_16x16x32_bf16 v[132:135], a[136:139], a[168:171], v[132:135]
    v_cvt_pk_bf16_f32 v96, v96, v97
    v_cvt_pk_bf16_f32 v97, v98, v99
    v_mfma_f32_16x16x32_bf16 v[152:155], a[140:143], a[168:171], v[152:155]
    s_mov_b32 s74, 12288
    v_cvt_pk_bf16_f32 v98, v116, v117
    v_cvt_pk_bf16_f32 v99, v118, v119
    v_mfma_f32_16x16x32_bf16 v[136:139], a[136:139], a[172:175], v[136:139]
    buffer_store_dwordx4 v[96:99], v242, s[28:31], s74 offen offset:0 sc1
    v_mfma_f32_16x16x32_bf16 v[156:159], a[140:143], a[172:175], v[156:159]
    v_cvt_pk_bf16_f32 v100, v100, v101
    v_cvt_pk_bf16_f32 v101, v102, v103
    v_mfma_f32_16x16x32_bf16 v[140:143], a[136:139], a[176:179], v[140:143]
    v_cvt_pk_bf16_f32 v102, v120, v121
    v_cvt_pk_bf16_f32 v103, v122, v123
    v_mfma_f32_16x16x32_bf16 v[160:163], a[140:143], a[176:179], v[160:163]
    buffer_store_dwordx4 v[100:103], v242, s[28:31], s74 offen offset:1024 sc1
    v_mfma_f32_16x16x32_bf16 v[144:147], a[136:139], a[180:183], v[144:147]
    v_mfma_f32_16x16x32_bf16 v[164:167], a[140:143], a[180:183], v[164:167]
    v_cvt_pk_bf16_f32 v104, v104, v105
    v_cvt_pk_bf16_f32 v105, v106, v107
    v_cvt_pk_bf16_f32 v106, v124, v125
    v_cvt_pk_bf16_f32 v107, v126, v127
    buffer_store_dwordx4 v[104:107], v242, s[28:31], s74 offen offset:2048 sc1
    v_cvt_pk_bf16_f32 v128, v128, v129
    v_cvt_pk_bf16_f32 v129, v130, v131
    v_cvt_pk_bf16_f32 v130, v148, v149
    v_cvt_pk_bf16_f32 v131, v150, v151
    buffer_store_dwordx4 v[128:131], v242, s[28:31], s74 offen offset:3072 sc1
    v_cvt_pk_bf16_f32 v132, v132, v133
    v_cvt_pk_bf16_f32 v133, v134, v135
    v_cvt_pk_bf16_f32 v134, v152, v153
    v_cvt_pk_bf16_f32 v135, v154, v155
    s_mov_b32 s74, 16384
    buffer_store_dwordx4 v[132:135], v242, s[28:31], s74 offen offset:0 sc1
    v_cvt_pk_bf16_f32 v136, v136, v137
    v_cvt_pk_bf16_f32 v137, v138, v139
    v_cvt_pk_bf16_f32 v138, v156, v157
    v_cvt_pk_bf16_f32 v139, v158, v159
    buffer_store_dwordx4 v[136:139], v242, s[28:31], s74 offen offset:1024 sc1
    v_cvt_pk_bf16_f32 v140, v140, v141
    v_cvt_pk_bf16_f32 v141, v142, v143
    v_cvt_pk_bf16_f32 v142, v160, v161
    v_cvt_pk_bf16_f32 v143, v162, v163
    buffer_store_dwordx4 v[140:143], v242, s[28:31], s74 offen offset:2048 sc1
    v_cvt_pk_bf16_f32 v144, v144, v145
    v_cvt_pk_bf16_f32 v145, v146, v147
    v_cvt_pk_bf16_f32 v146, v164, v165
    v_cvt_pk_bf16_f32 v147, v166, v167
    buffer_store_dwordx4 v[144:147], v242, s[28:31], s74 offen offset:3072 sc1
    s_lshl_b32 s74, s77, 4
    s_add_u32 s74, s74, s78
    s_lshl_b32 s74, s74, 7
    s_add_u32 s74, s74, 25165824
    s_add_u32 s36, s60, s74
    s_addc_u32 s37, s61, 0
    s_and_b32 s37, s37, 0xffff
    s_mov_b32 s38, 64
    s_mov_b32 s39, 0x20000
    s_add_u32 s40, s58, 0
    s_addc_u32 s41, s59, 0
    s_and_b32 s41, s41, 0xffff
    s_mov_b32 s42, 256
    s_mov_b32 s43, 0x20000
    v_lshrrev_b32 v244, 2, v3
    v_and_b32 v245, 1, v3
    v_lshlrev_b32 v245, 4, v245
    v_mov_b32 v246, 0x3f80
    v_lshlrev_b32 v245, v245, v246
    v_cmp_eq_u32 vcc, v244, v4
    v_mov_b32 v246, 0
    s_nop 0
    v_cndmask_b32 v245, v246, v245, vcc
    v_and_b32 v244, 2, v3
    v_cmp_eq_u32 vcc, 0, v244
    s_nop 1
    v_cndmask_b32 v248, v246, v245, vcc
    v_cndmask_b32 v249, v245, v246, vcc
    v_mov_b32 v247, 0
    v_mov_b32 v250, 0
    v_mov_b32 v251, 0
    s_waitcnt vmcnt(0)
    s_barrier
    s_cmp_lg_u32 s3, 0
    s_cbranch_scc1 L_noflag
    s_mov_b64 exec, 1
    v_mov_b32 v8, 0
    v_mov_b32 v9, 1
    s_lshl_b32 s74, s76, 2
    buffer_store_dword v9, v8, s[36:39], s74 offen sc1
    s_mov_b64 exec, -1
L_noflag:
    s_mov_b32 s50, s77
    s_lshl_b32 s80, 1, s76
    s_andn2_b32 s51, 0xff, s80
    s_mul_i32 s79, s76, 10
    s_add_u32 s79, s79, s3
    s_mov_b32 s32, s56
    s_and_b32 s33, s57, 0xffff
    s_mov_b32 s34, 2621440
    s_mov_b32 s35, 0x20000
    v_lshlrev_b32 v140, 11, v3
    v_lshl_add_u32 v140, v4, 4, v140
L_pass:
    s_cmp_lg_u32 s3, 1
    s_cbranch_scc1 L_wait_done
    s_mov_b64 exec, 1
    v_mov_b32 v142, 0
    s_mov_b32 s72, 0
    v_cmp_le_u32 vcc, 0x100, v6
    s_cbranch_vccnz L_poll1i
L_poll0:
    buffer_load_dword v6, v142, s[40:43], 0 offen sc1
    s_add_u32 s72, s72, 1
    s_cmp_gt_u32 s72, 0x40000
    s_cbranch_scc1 L_poll1i
    s_waitcnt vmcnt(0)
    v_cmp_gt_u32 vcc, 0x100, v6
    s_cbranch_vccnz L_poll0
L_poll1i:
    s_mov_b32 exec_lo, s51
    v_lshrrev_b32 v142, 2, v242
L_poll1:
    buffer_load_dword v141, v142, s[36:39], 0 offen sc1
    s_add_u32 s72, s72, 1
    s_cmp_gt_u32 s72, 0x40000
    s_cbranch_scc1 L_polled
    s_waitcnt vmcnt(0)
    v_cmp_ne_u32 vcc, 1, v141
    s_cbranch_vccnz L_poll1
L_polled:
    s_mov_b64 exec, -1
L_wait_done:
    s_lshl_b32 s80, s50, 4
    s_add_u32 s80, s80, s78
    s_mul_i32 s80, s80, 655360
    s_add_u32 s28, s60, s80
    s_addc_u32 s29, s61, 0
    s_and_b32 s29, s29, 0xffff
    s_mov_b32 s30, 655360
    s_mov_b32 s31, 0x20000
    s_mul_i32 s75, s78, 163840
    s_lshl_b32 s74, s50, 10
    s_add_u32 s75, s75, s74
    s_barrier
    s_add_u32 s80, s79, 0
    s_lshl_b32 s80, s80, 10
    buffer_load_dwordx4 v[8:11], v242, s[28:31], s80 offen sc1
    s_add_u32 s80, s80, 81920
    buffer_load_dwordx4 v[12:15], v242, s[28:31], s80 offen sc1
    s_add_u32 s80, s80, 81920
    buffer_load_dwordx4 v[16:19], v242, s[28:31], s80 offen sc1
    s_add_u32 s80, s80, 81920
    buffer_load_dwordx4 v[20:23], v242, s[28:31], s80 offen sc1
    s_add_u32 s80, s80, 81920
    buffer_load_dwordx4 v[24:27], v242, s[28:31], s80 offen sc1
    s_add_u32 s80, s80, 81920
    buffer_load_dwordx4 v[28:31], v242, s[28:31], s80 offen sc1
    s_add_u32 s80, s80, 81920
    buffer_load_dwordx4 v[32:35], v242, s[28:31], s80 offen sc1
    s_add_u32 s80, s80, 81920
    buffer_load_dwordx4 v[36:39], v242, s[28:31], s80 offen sc1
    s_add_u32 s80, s79, 4
    s_lshl_b32 s80, s80, 10
    buffer_load_dwordx4 v[40:43], v242, s[28:31], s80 offen sc1
    s_add_u32 s80, s80, 81920
    buffer_load_dwordx4 v[44:47], v242, s[28:31], s80 offen sc1
    s_add_u32 s80, s80, 81920
    buffer_load_dwordx4 v[48:51], v242, s[28:31], s80 offen sc1
    s_add_u32 s80, s80, 81920
    buffer_load_dwordx4 v[52:55], v242, s[28:31], s80 offen sc1
    s_add_u32 s80, s80, 81920
    buffer_load_dwordx4 v[56:59], v242, s[28:31], s80 offen sc1
    s_add_u32 s80, s80, 81920
    buffer_load_dwordx4 v[60:63], v242, s[28:31], s80 offen sc1
    s_add_u32 s80, s80, 81920
    buffer_load_dwordx4 v[64:67], v242, s[28:31], s80 offen sc1
    s_add_u32 s80, s80, 81920
    buffer_load_dwordx4 v[68:71], v242, s[28:31], s80 offen sc1
    s_cmp_ge_u32 s3, 2
    s_cbranch_scc1 L_red2
    s_add_u32 s80, s79, 8
    s_lshl_b32 s80, s80, 10
    buffer_load_dwordx4 v[72:75], v242, s[28:31], s80 offen sc1
    s_add_u32 s80, s80, 81920
    buffer_load_dwordx4 v[76:79], v242, s[28:31], s80 offen sc1
    s_add_u32 s80, s80, 81920
    buffer_load_dwordx4 v[80:83], v242, s[28:31], s80 offen sc1
    s_add_u32 s80, s80, 81920
    buffer_load_dwordx4 v[84:87], v242, s[28:31], s80 offen sc1
    s_add_u32 s80, s80, 81920
    buffer_load_dwordx4 v[88:91], v242, s[28:31], s80 offen sc1
    s_add_u32 s80, s80, 81920
    buffer_load_dwordx4 v[92:95], v242, s[28:31], s80 offen sc1
    s_add_u32 s80, s80, 81920
    buffer_load_dwordx4 v[96:99], v242, s[28:31], s80 offen sc1
    s_add_u32 s80, s80, 81920
    buffer_load_dwordx4 v[100:103], v242, s[28:31], s80 offen sc1
    s_add_u32 s80, s79, 0
    s_mul_hi_u32 s81, s80, 858993460
    s_mul_i32 s74, s81, 5
    s_sub_u32 s80, s80, s74
    s_lshl_b32 s80, s80, 15
    s_lshl_b32 s81, s81, 6
    s_add_u32 s80, s80, s81
    s_add_u32 s46, s80, s75
    s_waitcnt vmcnt(23)
    v_mfma_f32_16x16x32_bf16 v[112:115], v[248:251], v[8:11], 0
    v_mfma_f32_16x16x32_bf16 v[116:119], v[246:249], v[8:11], 0
    s_waitcnt vmcnt(22)
    v_mfma_f32_16x16x32_bf16 v[112:115], v[248:251], v[12:15], v[112:115]
    v_mfma_f32_16x16x32_bf16 v[116:119], v[246:249], v[12:15], v[116:119]
    s_waitcnt vmcnt(21)
    v_mfma_f32_16x16x32_bf16 v[112:115], v[248:251], v[16:19], v[112:115]
    v_mfma_f32_16x16x32_bf16 v[116:119], v[246:249], v[16:19], v[116:119]
    s_waitcnt vmcnt(20)
    v_mfma_f32_16x16x32_bf16 v[112:115], v[248:251], v[20:23], v[112:115]
    v_mfma_f32_16x16x32_bf16 v[116:119], v[246:249], v[20:23], v[116:119]
    s_waitcnt vmcnt(19)
    v_mfma_f32_16x16x32_bf16 v[112:115], v[248:251], v[24:27], v[112:115]
    v_mfma_f32_16x16x32_bf16 v[116:119], v[246:249], v[24:27], v[116:119]
    s_waitcnt vmcnt(18)
    v_mfma_f32_16x16x32_bf16 v[112:115], v[248:251], v[28:31], v[112:115]
    v_mfma_f32_16x16x32_bf16 v[116:119], v[246:249], v[28:31], v[116:119]
    s_waitcnt vmcnt(17)
    v_mfma_f32_16x16x32_bf16 v[112:115], v[248:251], v[32:35], v[112:115]
    v_mfma_f32_16x16x32_bf16 v[116:119], v[246:249], v[32:35], v[116:119]
    s_waitcnt vmcnt(16)
    v_mfma_f32_16x16x32_bf16 v[112:115], v[248:251], v[36:39], v[112:115]
    v_mfma_f32_16x16x32_bf16 v[116:119], v[246:249], v[36:39], v[116:119]
    s_add_u32 s80, s79, 4
    s_mul_hi_u32 s81, s80, 858993460
    s_mul_i32 s74, s81, 5
    s_sub_u32 s80, s80, s74
    s_lshl_b32 s80, s80, 15
    s_lshl_b32 s81, s81, 6
    s_add_u32 s80, s80, s81
    s_add_u32 s47, s80, s75
    s_waitcnt vmcnt(15)
    v_mfma_f32_16x16x32_bf16 v[120:123], v[248:251], v[40:43], 0
    v_mfma_f32_16x16x32_bf16 v[124:127], v[246:249], v[40:43], 0
    s_waitcnt vmcnt(14)
    v_mfma_f32_16x16x32_bf16 v[120:123], v[248:251], v[44:47], v[120:123]
    v_mfma_f32_16x16x32_bf16 v[124:127], v[246:249], v[44:47], v[124:127]
    s_waitcnt vmcnt(13)
    v_mfma_f32_16x16x32_bf16 v[120:123], v[248:251], v[48:51], v[120:123]
    v_mfma_f32_16x16x32_bf16 v[124:127], v[246:249], v[48:51], v[124:127]
    s_waitcnt vmcnt(12)
    v_mfma_f32_16x16x32_bf16 v[120:123], v[248:251], v[52:55], v[120:123]
    v_mfma_f32_16x16x32_bf16 v[124:127], v[246:249], v[52:55], v[124:127]
    s_waitcnt vmcnt(11)
    v_mfma_f32_16x16x32_bf16 v[120:123], v[248:251], v[56:59], v[120:123]
    v_mfma_f32_16x16x32_bf16 v[124:127], v[246:249], v[56:59], v[124:127]
    s_waitcnt vmcnt(10)
    v_mfma_f32_16x16x32_bf16 v[120:123], v[248:251], v[60:63], v[120:123]
    v_mfma_f32_16x16x32_bf16 v[124:127], v[246:249], v[60:63], v[124:127]
    s_waitcnt vmcnt(9)
    v_mfma_f32_16x16x32_bf16 v[120:123], v[248:251], v[64:67], v[120:123]
    v_mfma_f32_16x16x32_bf16 v[124:127], v[246:249], v[64:67], v[124:127]
    s_waitcnt vmcnt(8)
    v_mfma_f32_16x16x32_bf16 v[120:123], v[248:251], v[68:71], v[120:123]
    v_mfma_f32_16x16x32_bf16 v[124:127], v[246:249], v[68:71], v[124:127]
    v_cvt_pk_bf16_f32 v112, v112, v113
    v_cvt_pk_bf16_f32 v113, v114, v115
    v_cvt_pk_bf16_f32 v114, v116, v117
    v_cvt_pk_bf16_f32 v115, v118, v119
    s_nop 0
    v_permlane32_swap_b32 v112, v114
    v_permlane32_swap_b32 v113, v115
    s_nop 0
    v_permlane16_swap_b32 v112, v114
    v_permlane16_swap_b32 v113, v115
    buffer_store_dwordx4 v[112:115], v140, s[32:35], s46 offen
    s_add_u32 s80, s79, 8
    s_mul_hi_u32 s81, s80, 858993460
    s_mul_i32 s74, s81, 5
    s_sub_u32 s80, s80, s74
    s_lshl_b32 s80, s80, 15
    s_lshl_b32 s81, s81, 6
    s_add_u32 s80, s80, s81
    s_add_u32 s48, s80, s75
    s_waitcnt vmcnt(8)
    v_mfma_f32_16x16x32_bf16 v[128:131], v[248:251], v[72:75], 0
    v_mfma_f32_16x16x32_bf16 v[132:135], v[246:249], v[72:75], 0
    s_waitcnt vmcnt(7)
    v_mfma_f32_16x16x32_bf16 v[128:131], v[248:251], v[76:79], v[128:131]
    v_mfma_f32_16x16x32_bf16 v[132:135], v[246:249], v[76:79], v[132:135]
    s_waitcnt vmcnt(6)
    v_mfma_f32_16x16x32_bf16 v[128:131], v[248:251], v[80:83], v[128:131]
    v_mfma_f32_16x16x32_bf16 v[132:135], v[246:249], v[80:83], v[132:135]
    s_waitcnt vmcnt(5)
    v_mfma_f32_16x16x32_bf16 v[128:131], v[248:251], v[84:87], v[128:131]
    v_mfma_f32_16x16x32_bf16 v[132:135], v[246:249], v[84:87], v[132:135]
    s_waitcnt vmcnt(4)
    v_mfma_f32_16x16x32_bf16 v[128:131], v[248:251], v[88:91], v[128:131]
    v_mfma_f32_16x16x32_bf16 v[132:135], v[246:249], v[88:91], v[132:135]
    s_waitcnt vmcnt(3)
    v_mfma_f32_16x16x32_bf16 v[128:131], v[248:251], v[92:95], v[128:131]
    v_mfma_f32_16x16x32_bf16 v[132:135], v[246:249], v[92:95], v[132:135]
    s_waitcnt vmcnt(2)
    v_mfma_f32_16x16x32_bf16 v[128:131], v[248:251], v[96:99], v[128:131]
    v_mfma_f32_16x16x32_bf16 v[132:135], v[246:249], v[96:99], v[132:135]
    s_waitcnt vmcnt(1)
    v_mfma_f32_16x16x32_bf16 v[128:131], v[248:251], v[100:103], v[128:131]
    v_mfma_f32_16x16x32_bf16 v[132:135], v[246:249], v[100:103], v[132:135]
    v_cvt_pk_bf16_f32 v120, v120, v121
    v_cvt_pk_bf16_f32 v121, v122, v123
    v_cvt_pk_bf16_f32 v122, v124, v125
    v_cvt_pk_bf16_f32 v123, v126, v127
    s_nop 0
    v_permlane32_swap_b32 v120, v122
    v_permlane32_swap_b32 v121, v123
    s_nop 0
    v_permlane16_swap_b32 v120, v122
    v_permlane16_swap_b32 v121, v123
    buffer_store_dwordx4 v[120:123], v140, s[32:35], s47 offen
    v_cvt_pk_bf16_f32 v128, v128, v129
    v_cvt_pk_bf16_f32 v129, v130, v131
    v_cvt_pk_bf16_f32 v130, v132, v133
    v_cvt_pk_bf16_f32 v131, v134, v135
    s_nop 0
    v_permlane32_swap_b32 v128, v130
    v_permlane32_swap_b32 v129, v131
    s_nop 0
    v_permlane16_swap_b32 v128, v130
    v_permlane16_swap_b32 v129, v131
    buffer_store_dwordx4 v[128:131], v140, s[32:35], s48 offen
    s_branch L_red_next
L_red2:
    s_add_u32 s80, s79, 0
    s_mul_hi_u32 s81, s80, 858993460
    s_mul_i32 s74, s81, 5
    s_sub_u32 s80, s80, s74
    s_lshl_b32 s80, s80, 15
    s_lshl_b32 s81, s81, 6
    s_add_u32 s80, s80, s81
    s_add_u32 s46, s80, s75
    s_waitcnt vmcnt(15)
    v_mfma_f32_16x16x32_bf16 v[112:115], v[248:251], v[8:11], 0
    v_mfma_f32_16x16x32_bf16 v[116:119], v[246:249], v[8:11], 0
    s_waitcnt vmcnt(14)
    v_mfma_f32_16x16x32_bf16 v[112:115], v[248:251], v[12:15], v[112:115]
    v_mfma_f32_16x16x32_bf16 v[116:119], v[246:249], v[12:15], v[116:119]
    s_waitcnt vmcnt(13)
    v_mfma_f32_16x16x32_bf16 v[112:115], v[248:251], v[16:19], v[112:115]
    v_mfma_f32_16x16x32_bf16 v[116:119], v[246:249], v[16:19], v[116:119]
    s_waitcnt vmcnt(12)
    v_mfma_f32_16x16x32_bf16 v[112:115], v[248:251], v[20:23], v[112:115]
    v_mfma_f32_16x16x32_bf16 v[116:119], v[246:249], v[20:23], v[116:119]
    s_waitcnt vmcnt(11)
    v_mfma_f32_16x16x32_bf16 v[112:115], v[248:251], v[24:27], v[112:115]
    v_mfma_f32_16x16x32_bf16 v[116:119], v[246:249], v[24:27], v[116:119]
    s_waitcnt vmcnt(10)
    v_mfma_f32_16x16x32_bf16 v[112:115], v[248:251], v[28:31], v[112:115]
    v_mfma_f32_16x16x32_bf16 v[116:119], v[246:249], v[28:31], v[116:119]
    s_waitcnt vmcnt(9)
    v_mfma_f32_16x16x32_bf16 v[112:115], v[248:251], v[32:35], v[112:115]
    v_mfma_f32_16x16x32_bf16 v[116:119], v[246:249], v[32:35], v[116:119]
    s_waitcnt vmcnt(8)
    v_mfma_f32_16x16x32_bf16 v[112:115], v[248:251], v[36:39], v[112:115]
    v_mfma_f32_16x16x32_bf16 v[116:119], v[246:249], v[36:39], v[116:119]
    s_add_u32 s80, s79, 4
    s_mul_hi_u32 s81, s80, 858993460
    s_mul_i32 s74, s81, 5
    s_sub_u32 s80, s80, s74
    s_lshl_b32 s80, s80, 15
    s_lshl_b32 s81, s81, 6
    s_add_u32 s80, s80, s81
    s_add_u32 s47, s80, s75
    s_waitcnt vmcnt(7)
    v_mfma_f32_16x16x32_bf16 v[120:123], v[248:251], v[40:43], 0
    v_mfma_f32_16x16x32_bf16 v[124:127], v[246:249], v[40:43], 0
    s_waitcnt vmcnt(6)
    v_mfma_f32_16x16x32_bf16 v[120:123], v[248:251], v[44:47], v[120:123]
    v_mfma_f32_16x16x32_bf16 v[124:127], v[246:249], v[44:47], v[124:127]
    s_waitcnt vmcnt(5)
    v_mfma_f32_16x16x32_bf16 v[120:123], v[248:251], v[48:51], v[120:123]
    v_mfma_f32_16x16x32_bf16 v[124:127], v[246:249], v[48:51], v[124:127]
    s_waitcnt vmcnt(4)
    v_mfma_f32_16x16x32_bf16 v[120:123], v[248:251], v[52:55], v[120:123]
    v_mfma_f32_16x16x32_bf16 v[124:127], v[246:249], v[52:55], v[124:127]
    s_waitcnt vmcnt(3)
    v_mfma_f32_16x16x32_bf16 v[120:123], v[248:251], v[56:59], v[120:123]
    v_mfma_f32_16x16x32_bf16 v[124:127], v[246:249], v[56:59], v[124:127]
    s_waitcnt vmcnt(2)
    v_mfma_f32_16x16x32_bf16 v[120:123], v[248:251], v[60:63], v[120:123]
    v_mfma_f32_16x16x32_bf16 v[124:127], v[246:249], v[60:63], v[124:127]
    s_waitcnt vmcnt(1)
    v_mfma_f32_16x16x32_bf16 v[120:123], v[248:251], v[64:67], v[120:123]
    v_mfma_f32_16x16x32_bf16 v[124:127], v[246:249], v[64:67], v[124:127]
    s_waitcnt vmcnt(0)
    v_mfma_f32_16x16x32_bf16 v[120:123], v[248:251], v[68:71], v[120:123]
    v_mfma_f32_16x16x32_bf16 v[124:127], v[246:249], v[68:71], v[124:127]
    v_cvt_pk_bf16_f32 v112, v112, v113
    v_cvt_pk_bf16_f32 v113, v114, v115
    v_cvt_pk_bf16_f32 v114, v116, v117
    v_cvt_pk_bf16_f32 v115, v118, v119
    s_nop 0
    v_permlane32_swap_b32 v112, v114
    v_permlane32_swap_b32 v113, v115
    s_nop 0
    v_permlane16_swap_b32 v112, v114
    v_permlane16_swap_b32 v113, v115
    buffer_store_dwordx4 v[112:115], v140, s[32:35], s46 offen
    v_cvt_pk_bf16_f32 v120, v120, v121
    v_cvt_pk_bf16_f32 v121, v122, v123
    v_cvt_pk_bf16_f32 v122, v124, v125
    v_cvt_pk_bf16_f32 v123, v126, v127
    s_nop 0
    v_permlane32_swap_b32 v120, v122
    v_permlane32_swap_b32 v121, v123
    s_nop 0
    v_permlane16_swap_b32 v120, v122
    v_permlane16_swap_b32 v121, v123
    buffer_store_dwordx4 v[120:123], v140, s[32:35], s47 offen
L_red_next:
L_red_done:
L_done:
    s_endpgm
L_fallback:
    s_mov_b32 s73, 1
    s_waitcnt vmcnt(0) lgkmcnt(0)
    s_mov_b32 s71, 0
    v_add_u32 v226, 0x10000, v226
    v_add_u32 v227, 0x10000, v227
    v_add_u32 v228, 0x10000, v228
    v_add_u32 v229, 0x10000, v229
    v_add_u32 v230, 0x10000, v230
    v_add_u32 v231, 0x10000, v231
    v_add_u32 v232, 0x10000, v232
    v_add_u32 v233, 0x10000, v233
    v_mov_b32 v212, 0xff800000
    v_mov_b32 v213, 0xff800000
    v_mov_b32 v214, 0xff800000
    v_mov_b32 v215, 0xff800000
    v_mov_b32 v216, 0xff800000
L_fb_loop:
    s_mov_b32 m0, s62
    s_nop 0
    buffer_load_dwordx4 v234, s[8:11], s71 offen offset:0 nt lds
    buffer_load_dwordx4 v235, s[8:11], s71 offen offset:1024 nt lds
    buffer_load_dwordx4 v234, s[8:11], s71 offen offset:2048 nt lds
    buffer_load_dwordx4 v235, s[8:11], s71 offen offset:3072 nt lds
    s_mov_b32 m0, s63
    s_nop 0
    buffer_load_dwordx4 v236, s[8:11], s71 offen offset:0 nt lds
    buffer_load_dwordx4 v237, s[8:11], s71 offen offset:1024 nt lds
    buffer_load_dwordx4 v236, s[8:11], s71 offen offset:2048 nt lds
    buffer_load_dwordx4 v237, s[8:11], s71 offen offset:3072 nt lds
    s_waitcnt vmcnt(0)
    ds_read_b128 a[80:83], v222 offset:0
    ds_read_b128 a[96:99], v222 offset:4096
    ds_read_b128 a[84:87], v223 offset:0
    ds_read_b128 a[100:103], v223 offset:4096
    ds_read_b128 a[88:91], v224 offset:0
    ds_read_b128 a[104:107], v224 offset:4096
    ds_read_b128 a[92:95], v225 offset:0
    ds_read_b128 a[108:111], v225 offset:4096
    s_waitcnt lgkmcnt(0)
    v_mfma_f32_16x16x32_bf16 v[168:171], a[80:83], a[0:3], 0
    v_mfma_f32_16x16x32_bf16 v[172:175], a[96:99], a[0:3], 0
    v_mfma_f32_16x16x32_bf16 v[168:171], a[84:87], a[4:7], v[168:171]
    v_mfma_f32_16x16x32_bf16 v[172:175], a[100:103], a[4:7], v[172:175]
    v_mfma_f32_16x16x32_bf16 v[168:171], a[88:91], a[8:11], v[168:171]
    v_mfma_f32_16x16x32_bf16 v[172:175], a[104:107], a[8:11], v[172:175]
    v_mfma_f32_16x16x32_bf16 v[168:171], a[92:95], a[12:15], v[168:171]
    v_mfma_f32_16x16x32_bf16 v[172:175], a[108:111], a[12:15], v[172:175]
    s_nop 6
    v_max3_f32 v212, v212, v168, v169
    v_max3_f32 v212, v212, v170, v171
    v_max3_f32 v212, v212, v172, v173
    v_max3_f32 v212, v212, v174, v175
    v_mfma_f32_16x16x32_bf16 v[176:179], a[80:83], a[16:19], 0
    v_mfma_f32_16x16x32_bf16 v[180:183], a[96:99], a[16:19], 0
    v_mfma_f32_16x16x32_bf16 v[176:179], a[84:87], a[20:23], v[176:179]
    v_mfma_f32_16x16x32_bf16 v[180:183], a[100:103], a[20:23], v[180:183]
    v_mfma_f32_16x16x32_bf16 v[176:179], a[88:91], a[24:27], v[176:179]
    v_mfma_f32_16x16x32_bf16 v[180:183], a[104:107], a[24:27], v[180:183]
    v_mfma_f32_16x16x32_bf16 v[176:179], a[92:95], a[28:31], v[176:179]
    v_mfma_f32_16x16x32_bf16 v[180:183], a[108:111], a[28:31], v[180:183]
    s_nop 6
    v_max3_f32 v213, v213, v176, v177
    v_max3_f32 v213, v213, v178, v179
    v_max3_f32 v213, v213, v180, v181
    v_max3_f32 v213, v213, v182, v183
    v_mfma_f32_16x16x32_bf16 v[168:171], a[80:83], a[32:35], 0
    v_mfma_f32_16x16x32_bf16 v[172:175], a[96:99], a[32:35], 0
    v_mfma_f32_16x16x32_bf16 v[168:171], a[84:87], a[36:39], v[168:171]
    v_mfma_f32_16x16x32_bf16 v[172:175], a[100:103], a[36:39], v[172:175]
    v_mfma_f32_16x16x32_bf16 v[168:171], a[88:91], a[40:43], v[168:171]
    v_mfma_f32_16x16x32_bf16 v[172:175], a[104:107], a[40:43], v[172:175]
    v_mfma_f32_16x16x32_bf16 v[168:171], a[92:95], a[44:47], v[168:171]
    v_mfma_f32_16x16x32_bf16 v[172:175], a[108:111], a[44:47], v[172:175]
    s_nop 6
    v_max3_f32 v214, v214, v168, v169
    v_max3_f32 v214, v214, v170, v171
    v_max3_f32 v214, v214, v172, v173
    v_max3_f32 v214, v214, v174, v175
    v_mfma_f32_16x16x32_bf16 v[176:179], a[80:83], a[48:51], 0
    v_mfma_f32_16x16x32_bf16 v[180:183], a[96:99], a[48:51], 0
    v_mfma_f32_16x16x32_bf16 v[176:179], a[84:87], a[52:55], v[176:179]
    v_mfma_f32_16x16x32_bf16 v[180:183], a[100:103], a[52:55], v[180:183]
    v_mfma_f32_16x16x32_bf16 v[176:179], a[88:91], a[56:59], v[176:179]
    v_mfma_f32_16x16x32_bf16 v[180:183], a[104:107], a[56:59], v[180:183]
    v_mfma_f32_16x16x32_bf16 v[176:179], a[92:95], a[60:63], v[176:179]
    v_mfma_f32_16x16x32_bf16 v[180:183], a[108:111], a[60:63], v[180:183]
    s_nop 6
    v_max3_f32 v215, v215, v176, v177
    v_max3_f32 v215, v215, v178, v179
    v_max3_f32 v215, v215, v180, v181
    v_max3_f32 v215, v215, v182, v183
    v_mfma_f32_16x16x32_bf16 v[168:171], a[80:83], a[64:67], 0
    v_mfma_f32_16x16x32_bf16 v[172:175], a[96:99], a[64:67], 0
    v_mfma_f32_16x16x32_bf16 v[168:171], a[84:87], a[68:71], v[168:171]
    v_mfma_f32_16x16x32_bf16 v[172:175], a[100:103], a[68:71], v[172:175]
    v_mfma_f32_16x16x32_bf16 v[168:171], a[88:91], a[72:75], v[168:171]
    v_mfma_f32_16x16x32_bf16 v[172:175], a[104:107], a[72:75], v[172:175]
    v_mfma_f32_16x16x32_bf16 v[168:171], a[92:95], a[76:79], v[168:171]
    v_mfma_f32_16x16x32_bf16 v[172:175], a[108:111], a[76:79], v[172:175]
    s_nop 6
    v_max3_f32 v216, v216, v168, v169
    v_max3_f32 v216, v216, v170, v171
    v_max3_f32 v216, v216, v172, v173
    v_max3_f32 v216, v216, v174, v175
    s_add_u32 s71, s71, 8192
    s_cmp_lt_u32 s71, 262144
    s_cbranch_scc1 L_fb_loop
    v_mov_b32 v217, v212
    v_mov_b32 v218, v213
    v_mov_b32 v219, v214
    v_mov_b32 v220, v215
    v_mov_b32 v221, v216
    v_permlane32_swap_b32 v217, v212
    v_permlane32_swap_b32 v218, v213
    v_permlane32_swap_b32 v219, v214
    v_permlane32_swap_b32 v220, v215
    v_permlane32_swap_b32 v221, v216
    v_max_f32 v212, v212, v217
    v_max_f32 v213, v213, v218
    v_max_f32 v214, v214, v219
    v_max_f32 v215, v215, v220
    v_max_f32 v216, v216, v221
    v_mov_b32 v217, v212
    v_mov_b32 v218, v213
    v_mov_b32 v219, v214
    v_mov_b32 v220, v215
    v_mov_b32 v221, v216
    v_permlane16_swap_b32 v217, v212
    v_permlane16_swap_b32 v218, v213
    v_permlane16_swap_b32 v219, v214
    v_permlane16_swap_b32 v220, v215
    v_permlane16_swap_b32 v221, v216
    v_max_f32 v212, v212, v217
    v_max_f32 v213, v213, v218
    v_max_f32 v214, v214, v219
    v_max_f32 v215, v215, v220
    v_max_f32 v216, v216, v221
    v_sub_f32 v192, 0, v212
    v_sub_f32 v193, 0, v212
    v_sub_f32 v194, 0, v212
    v_sub_f32 v195, 0, v212
    v_sub_f32 v196, 0, v213
    v_sub_f32 v197, 0, v213
    v_sub_f32 v198, 0, v213
    v_sub_f32 v199, 0, v213
    v_sub_f32 v200, 0, v214
    v_sub_f32 v201, 0, v214
    v_sub_f32 v202, 0, v214
    v_sub_f32 v203, 0, v214
    v_sub_f32 v204, 0, v215
    v_sub_f32 v205, 0, v215
    v_sub_f32 v206, 0, v215
    v_sub_f32 v207, 0, v215
    v_sub_f32 v208, 0, v216
    v_sub_f32 v209, 0, v216
    v_sub_f32 v210, 0, v216
    v_sub_f32 v211, 0, v216
    v_mov_b32 v212, 0
    v_mov_b32 v213, 0
    v_mov_b32 v214, 0
    v_mov_b32 v215, 0
    v_mov_b32 v216, 0
    v_mov_b32 v217, 0
    v_mov_b32 v218, 0
    v_mov_b32 v219, 0
    v_mov_b32 v220, 0
    v_mov_b32 v221, 0
    s_mov_b32 s71, s55
    s_mov_b32 m0, s62
    s_nop 0
    buffer_load_dwordx4 v234, s[8:11], s71 offen offset:0 nt lds
    buffer_load_dwordx4 v235, s[8:11], s71 offen offset:1024 nt lds
    buffer_load_dwordx4 v234, s[8:11], s71 offen offset:2048 nt lds
    buffer_load_dwordx4 v235, s[8:11], s71 offen offset:3072 nt lds
    s_mov_b32 m0, s63
    s_nop 0
    buffer_load_dwordx4 v236, s[8:11], s71 offen offset:0 nt lds
    buffer_load_dwordx4 v237, s[8:11], s71 offen offset:1024 nt lds
    buffer_load_dwordx4 v236, s[8:11], s71 offen offset:2048 nt lds
    buffer_load_dwordx4 v237, s[8:11], s71 offen offset:3072 nt lds
    s_mov_b32 m0, s66
    s_nop 0
    buffer_load_dwordx4 v234, s[12:15], s71 offen offset:0 nt lds
    buffer_load_dwordx4 v235, s[12:15], s71 offen offset:1024 nt lds
    buffer_load_dwordx4 v234, s[12:15], s71 offen offset:2048 nt lds
    buffer_load_dwordx4 v235, s[12:15], s71 offen offset:3072 nt lds
    s_mov_b32 m0, s67
    s_nop 0
    buffer_load_dwordx4 v236, s[12:15], s71 offen offset:0 nt lds
    buffer_load_dwordx4 v237, s[12:15], s71 offen offset:1024 nt lds
    buffer_load_dwordx4 v236, s[12:15], s71 offen offset:2048 nt lds
    buffer_load_dwordx4 v237, s[12:15], s71 offen offset:3072 nt lds
    s_add_u32 s71, s55, 8192
    s_and_b32 s71, s71, 262143
    s_mov_b32 m0, s64
    s_nop 0
    buffer_load_dwordx4 v234, s[8:11], s71 offen offset:0 nt lds
    buffer_load_dwordx4 v235, s[8:11], s71 offen offset:1024 nt lds
    buffer_load_dwordx4 v234, s[8:11], s71 offen offset:2048 nt lds
    buffer_load_dwordx4 v235, s[8:11], s71 offen offset:3072 nt lds
    s_mov_b32 m0, s65
    s_nop 0
    buffer_load_dwordx4 v236, s[8:11], s71 offen offset:0 nt lds
    buffer_load_dwordx4 v237, s[8:11], s71 offen offset:1024 nt lds
    buffer_load_dwordx4 v236, s[8:11], s71 offen offset:2048 nt lds
    buffer_load_dwordx4 v237, s[8:11], s71 offen offset:3072 nt lds
    s_mov_b32 m0, s68
    s_nop 0
    buffer_load_dwordx4 v234, s[12:15], s71 offen offset:0 nt lds
    buffer_load_dwordx4 v235, s[12:15], s71 offen offset:1024 nt lds
    buffer_load_dwordx4 v234, s[12:15], s71 offen offset:2048 nt lds
    buffer_load_dwordx4 v235, s[12:15], s71 offen offset:3072 nt lds
    s_mov_b32 m0, s69
    s_nop 0
    buffer_load_dwordx4 v236, s[12:15], s71 offen offset:0 nt lds
    buffer_load_dwordx4 v237, s[12:15], s71 offen offset:1024 nt lds
    buffer_load_dwordx4 v236, s[12:15], s71 offen offset:2048 nt lds
    buffer_load_dwordx4 v237, s[12:15], s71 offen offset:3072 nt lds
    s_waitcnt vmcnt(0)
    ds_read_b128 a[80:83], v222 offset:0
    ds_read_b128 a[96:99], v222 offset:4096
    ds_read_b128 a[84:87], v223 offset:0
    ds_read_b128 a[100:103], v223 offset:4096
    ds_read_b128 a[88:91], v224 offset:0
    ds_read_b128 a[104:107], v224 offset:4096
    ds_read_b128 a[92:95], v225 offset:0
    ds_read_b128 a[108:111], v225 offset:4096
    s_waitcnt lgkmcnt(0)
    s_add_u32 s71, s55, 16384
    s_and_b32 s71, s71, 262143
    s_mov_b32 m0, s62
    s_nop 0
    buffer_load_dwordx4 v234, s[8:11], s71 offen offset:0 nt lds
    buffer_load_dwordx4 v235, s[8:11], s71 offen offset:1024 nt lds
    buffer_load_dwordx4 v234, s[8:11], s71 offen offset:2048 nt lds
    buffer_load_dwordx4 v235, s[8:11], s71 offen offset:3072 nt lds
    s_mov_b32 m0, s63
    s_nop 0
    buffer_load_dwordx4 v236, s[8:11], s71 offen offset:0 nt lds
    buffer_load_dwordx4 v237, s[8:11], s71 offen offset:1024 nt lds
    buffer_load_dwordx4 v236, s[8:11], s71 offen offset:2048 nt lds
    buffer_load_dwordx4 v237, s[8:11], s71 offen offset:3072 nt lds
    s_waitcnt vmcnt(0)
    s_branch L_attn_start
L_gqa:
    s_lshl_b32 s74, s3, 11
    s_add_u32 s6, s74, 16384
    s_add_u32 s71, s6, s55
    s_and_b32 s71, s71, 262143
    v_mfma_f32_16x16x32_bf16 v[168:171], a[80:83], a[32:35], v[200:203]
    v_exp_f32 v176, v176
    v_mfma_f32_16x16x32_bf16 v[172:175], a[96:99], a[32:35], v[200:203]
    v_exp_f32 v177, v177
    v_mfma_f32_16x16x32_bf16 v[168:171], a[84:87], a[36:39], v[168:171]
    s_lshl_b32 s74, s3, 14
    v_cvt_pk_bf16_f32 v188, v176, v177
    v_add_f32 v213, v213, v176
    v_mfma_f32_16x16x32_bf16 v[172:175], a[100:103], a[36:39], v[172:175]
    s_sub_u32 s74, 0x4000, s74
    v_exp_f32 v178, v178
    v_mfma_f32_16x16x32_bf16 v[168:171], a[88:91], a[40:43], v[168:171]
    v_add_f32 v218, v218, v177
    v_add_f32 v213, v213, v178
    v_mfma_f32_16x16x32_bf16 v[172:175], a[104:107], a[40:43], v[172:175]
    v_exp_f32 v179, v179
    v_mfma_f32_16x16x32_bf16 v[168:171], a[92:95], a[44:47], v[168:171]
    v_cvt_pk_bf16_f32 v189, v178, v179
    v_add_f32 v218, v218, v179
    v_mfma_f32_16x16x32_bf16 v[172:175], a[108:111], a[44:47], v[172:175]
    s_waitcnt lgkmcnt(0)
    v_exp_f32 v180, v180
    v_mfma_f32_16x16x32_bf16 v[8:11], a[112:115], v[184:187], 0
    v_exp_f32 v181, v181
    v_mfma_f32_16x16x32_bf16 v[28:31], a[116:119], v[184:187], 0
    v_cvt_pk_bf16_f32 v190, v180, v181
    v_add_f32 v213, v213, v180
    v_mfma_f32_16x16x32_bf16 v[48:51], a[120:123], v[184:187], 0
    v_exp_f32 v182, v182
    v_mfma_f32_16x16x32_bf16 v[68:71], a[124:127], v[184:187], 0
    v_add_f32 v218, v218, v181
    v_add_f32 v213, v213, v182
    v_mfma_f32_16x16x32_bf16 v[88:91], a[128:131], v[184:187], 0
    v_exp_f32 v183, v183
    v_mfma_f32_16x16x32_bf16 v[108:111], a[132:135], v[184:187], 0
    v_cvt_pk_bf16_f32 v191, v182, v183
    v_add_f32 v218, v218, v183
    v_mfma_f32_16x16x32_bf16 v[128:131], a[136:139], v[184:187], 0
    v_mfma_f32_16x16x32_bf16 v[148:151], a[140:143], v[184:187], 0
    v_mfma_f32_16x16x32_bf16 v[176:179], a[80:83], a[48:51], v[204:207]
    v_exp_f32 v168, v168
    v_mfma_f32_16x16x32_bf16 v[180:183], a[96:99], a[48:51], v[204:207]
    v_exp_f32 v169, v169
    v_mfma_f32_16x16x32_bf16 v[176:179], a[84:87], a[52:55], v[176:179]
    v_cvt_pk_bf16_f32 v184, v168, v169
    v_add_f32 v214, v214, v168
    v_mfma_f32_16x16x32_bf16 v[180:183], a[100:103], a[52:55], v[180:183]
    v_exp_f32 v170, v170
    v_mfma_f32_16x16x32_bf16 v[176:179], a[88:91], a[56:59], v[176:179]
    v_add_f32 v219, v219, v169
    v_add_f32 v214, v214, v170
    v_mfma_f32_16x16x32_bf16 v[180:183], a[104:107], a[56:59], v[180:183]
    v_exp_f32 v171, v171
    v_mfma_f32_16x16x32_bf16 v[176:179], a[92:95], a[60:63], v[176:179]
    v_cvt_pk_bf16_f32 v185, v170, v171
    v_add_f32 v219, v219, v171
    v_mfma_f32_16x16x32_bf16 v[180:183], a[108:111], a[60:63], v[180:183]
    v_exp_f32 v172, v172
    v_mfma_f32_16x16x32_bf16 v[12:15], a[112:115], v[188:191], 0
    v_exp_f32 v173, v173
    v_mfma_f32_16x16x32_bf16 v[32:35], a[116:119], v[188:191], 0
    v_cvt_pk_bf16_f32 v186, v172, v173
    v_add_f32 v214, v214, v172
    v_mfma_f32_16x16x32_bf16 v[52:55], a[120:123], v[188:191], 0
    v_exp_f32 v174, v174
    v_mfma_f32_16x16x32_bf16 v[72:75], a[124:127], v[188:191], 0
    v_add_f32 v219, v219, v173
    v_add_f32 v214, v214, v174
    v_mfma_f32_16x16x32_bf16 v[92:95], a[128:131], v[188:191], 0
    v_exp_f32 v175, v175
    v_mfma_f32_16x16x32_bf16 v[112:115], a[132:135], v[188:191], 0
    v_cvt_pk_bf16_f32 v187, v174, v175
    v_add_f32 v219, v219, v175
    v_mfma_f32_16x16x32_bf16 v[132:135], a[136:139], v[188:191], 0
    s_waitcnt vmcnt(16)
    s_waitcnt vmcnt(8)
    v_mfma_f32_16x16x32_bf16 v[152:155], a[140:143], v[188:191], 0
    s_barrier
    v_mfma_f32_16x16x32_bf16 v[168:171], a[80:83], a[64:67], v[208:211]
    ds_read_b128 a[80:83], v222 offset:8192
    v_exp_f32 v176, v176
    v_mfma_f32_16x16x32_bf16 v[172:175], a[96:99], a[64:67], v[208:211]
    ds_read_b128 a[96:99], v222 offset:12288
    v_exp_f32 v177, v177
    v_mfma_f32_16x16x32_bf16 v[168:171], a[84:87], a[68:71], v[168:171]
    ds_read_b128 a[84:87], v223 offset:8192
    v_cvt_pk_bf16_f32 v188, v176, v177
    v_add_f32 v215, v215, v176
    v_mfma_f32_16x16x32_bf16 v[172:175], a[100:103], a[68:71], v[172:175]
    ds_read_b128 a[100:103], v223 offset:12288
    v_exp_f32 v178, v178
    v_mfma_f32_16x16x32_bf16 v[168:171], a[88:91], a[72:75], v[168:171]
    ds_read_b128 a[88:91], v224 offset:8192
    v_add_f32 v220, v220, v177
    v_add_f32 v215, v215, v178
    v_mfma_f32_16x16x32_bf16 v[172:175], a[104:107], a[72:75], v[172:175]
    ds_read_b128 a[104:107], v224 offset:12288
    v_exp_f32 v179, v179
    v_mfma_f32_16x16x32_bf16 v[168:171], a[92:95], a[76:79], v[168:171]
    ds_read_b128 a[92:95], v225 offset:8192
    v_cvt_pk_bf16_f32 v189, v178, v179
    v_add_f32 v220, v220, v179
    v_mfma_f32_16x16x32_bf16 v[172:175], a[108:111], a[76:79], v[172:175]
    ds_read_b128 a[108:111], v225 offset:12288
    v_exp_f32 v180, v180
    v_mfma_f32_16x16x32_bf16 v[16:19], a[112:115], v[184:187], 0
    s_add_u32 m0, s6, 0x10000
    v_add_u32 v222, s74, v222
    v_exp_f32 v181, v181
    v_mfma_f32_16x16x32_bf16 v[36:39], a[116:119], v[184:187], 0
    buffer_load_dwordx4 v234, s[12:15], s71 offen nt lds
    v_mfma_f32_16x16x32_bf16 v[56:59], a[120:123], v[184:187], 0
    buffer_load_dwordx4 v235, s[12:15], s71 offen offset:1024 nt lds
    v_add_u32 v223, s74, v223
    v_mfma_f32_16x16x32_bf16 v[76:79], a[124:127], v[184:187], 0
    s_add_u32 s71, s71, 8192
    s_add_u32 s6, s6, 8192
    s_and_b32 s6, s6, 0xffff
    s_and_b32 s71, s71, 262143
    v_exp_f32 v182, v182
    v_mfma_f32_16x16x32_bf16 v[96:99], a[128:131], v[184:187], 0
    v_add_u32 v224, s74, v224
    v_exp_f32 v183, v183
    v_mfma_f32_16x16x32_bf16 v[116:119], a[132:135], v[184:187], 0
    v_cvt_pk_bf16_f32 v190, v180, v181
    v_cvt_pk_bf16_f32 v191, v182, v183
    v_mfma_f32_16x16x32_bf16 v[136:139], a[136:139], v[184:187], 0
    v_add_u32 v225, s74, v225
    v_add_f32 v215, v215, v180
    v_add_f32 v220, v220, v181
    v_mfma_f32_16x16x32_bf16 v[156:159], a[140:143], v[184:187], 0
    s_waitcnt lgkmcnt(0)
    v_add_f32 v215, v215, v182
    v_add_f32 v220, v220, v183
    v_mfma_f32_16x16x32_bf16 v[176:179], a[80:83], a[0:3], v[192:195]
    v_exp_f32 v168, v168
    v_mfma_f32_16x16x32_bf16 v[180:183], a[96:99], a[0:3], v[192:195]
    v_exp_f32 v169, v169
    v_mfma_f32_16x16x32_bf16 v[176:179], a[84:87], a[4:7], v[176:179]
    v_cvt_pk_bf16_f32 v184, v168, v169
    v_add_f32 v216, v216, v168
    v_mfma_f32_16x16x32_bf16 v[180:183], a[100:103], a[4:7], v[180:183]
    v_exp_f32 v170, v170
    v_mfma_f32_16x16x32_bf16 v[176:179], a[88:91], a[8:11], v[176:179]
    v_add_f32 v221, v221, v169
    v_add_f32 v216, v216, v170
    v_mfma_f32_16x16x32_bf16 v[180:183], a[104:107], a[8:11], v[180:183]
    v_exp_f32 v171, v171
    v_mfma_f32_16x16x32_bf16 v[176:179], a[92:95], a[12:15], v[176:179]
    v_cvt_pk_bf16_f32 v185, v170, v171
    v_add_f32 v221, v221, v171
    v_mfma_f32_16x16x32_bf16 v[180:183], a[108:111], a[12:15], v[180:183]
    v_exp_f32 v172, v172
    v_mfma_f32_16x16x32_bf16 v[20:23], a[112:115], v[188:191], 0
    v_exp_f32 v173, v173
    v_mfma_f32_16x16x32_bf16 v[40:43], a[116:119], v[188:191], 0
    v_cvt_pk_bf16_f32 v186, v172, v173
    v_add_f32 v216, v216, v172
    v_mfma_f32_16x16x32_bf16 v[60:63], a[120:123], v[188:191], 0
    v_exp_f32 v174, v174
    v_mfma_f32_16x16x32_bf16 v[80:83], a[124:127], v[188:191], 0
    v_add_f32 v221, v221, v173
    v_add_f32 v216, v216, v174
    v_mfma_f32_16x16x32_bf16 v[100:103], a[128:131], v[188:191], 0
    v_exp_f32 v175, v175
    v_mfma_f32_16x16x32_bf16 v[120:123], a[132:135], v[188:191], 0
    v_cvt_pk_bf16_f32 v187, v174, v175
    v_add_f32 v221, v221, v175
    v_mfma_f32_16x16x32_bf16 v[140:143], a[136:139], v[188:191], 0
    v_mfma_f32_16x16x32_bf16 v[160:163], a[140:143], v[188:191], 0
    v_mfma_f32_16x16x32_bf16 v[168:171], a[80:83], a[16:19], v[196:199]
    v_exp_f32 v176, v176
    v_mfma_f32_16x16x32_bf16 v[172:175], a[96:99], a[16:19], v[196:199]
    v_exp_f32 v177, v177
    v_mfma_f32_16x16x32_bf16 v[168:171], a[84:87], a[20:23], v[168:171]
    v_cvt_pk_bf16_f32 v188, v176, v177
    v_add_f32 v212, v212, v176
    v_mfma_f32_16x16x32_bf16 v[172:175], a[100:103], a[20:23], v[172:175]
    v_exp_f32 v178, v178
    v_mfma_f32_16x16x32_bf16 v[168:171], a[88:91], a[24:27], v[168:171]
    v_add_f32 v217, v217, v177
    v_add_f32 v212, v212, v178
    v_mfma_f32_16x16x32_bf16 v[172:175], a[104:107], a[24:27], v[172:175]
    v_exp_f32 v179, v179
    v_mfma_f32_16x16x32_bf16 v[168:171], a[92:95], a[28:31], v[168:171]
    v_cvt_pk_bf16_f32 v189, v178, v179
    v_add_f32 v217, v217, v179
    v_mfma_f32_16x16x32_bf16 v[172:175], a[108:111], a[28:31], v[172:175]
    v_exp_f32 v180, v180
    v_mfma_f32_16x16x32_bf16 v[24:27], a[112:115], v[184:187], 0
    ds_read_b64_tr_b16 a[112:113], v226 offset:8192
    ds_read_b64_tr_b16 a[114:115], v226 offset:12288
    v_exp_f32 v181, v181
    v_mfma_f32_16x16x32_bf16 v[44:47], a[116:119], v[184:187], 0
    ds_read_b64_tr_b16 a[116:117], v227 offset:8192
    ds_read_b64_tr_b16 a[118:119], v227 offset:12288
    v_exp_f32 v182, v182
    v_mfma_f32_16x16x32_bf16 v[64:67], a[120:123], v[184:187], 0
    ds_read_b64_tr_b16 a[120:121], v228 offset:8192
    ds_read_b64_tr_b16 a[122:123], v228 offset:12288
    v_exp_f32 v183, v183
    v_mfma_f32_16x16x32_bf16 v[84:87], a[124:127], v[184:187], 0
    ds_read_b64_tr_b16 a[124:125], v229 offset:8192
    ds_read_b64_tr_b16 a[126:127], v229 offset:12288
    v_cvt_pk_bf16_f32 v190, v180, v181
    v_cvt_pk_bf16_f32 v191, v182, v183
    v_mfma_f32_16x16x32_bf16 v[104:107], a[128:131], v[184:187], 0
    ds_read_b64_tr_b16 a[128:129], v230 offset:8192
    ds_read_b64_tr_b16 a[130:131], v230 offset:12288
    v_add_f32 v212, v212, v180
    v_mfma_f32_16x16x32_bf16 v[124:127], a[132:135], v[184:187], 0
    ds_read_b64_tr_b16 a[132:133], v231 offset:8192
    ds_read_b64_tr_b16 a[134:135], v231 offset:12288
    v_add_f32 v217, v217, v181
    v_mfma_f32_16x16x32_bf16 v[144:147], a[136:139], v[184:187], 0
    ds_read_b64_tr_b16 a[136:137], v232 offset:8192
    ds_read_b64_tr_b16 a[138:139], v232 offset:12288
    v_add_f32 v212, v212, v182
    v_mfma_f32_16x16x32_bf16 v[164:167], a[140:143], v[184:187], 0
    ds_read_b64_tr_b16 a[140:141], v233 offset:8192
    ds_read_b64_tr_b16 a[142:143], v233 offset:12288
    v_add_f32 v217, v217, v183
    v_mfma_f32_16x16x32_bf16 v[176:179], a[80:83], a[32:35], v[200:203]
    v_exp_f32 v168, v168
    v_mfma_f32_16x16x32_bf16 v[180:183], a[96:99], a[32:35], v[200:203]
    v_exp_f32 v169, v169
    v_mfma_f32_16x16x32_bf16 v[176:179], a[84:87], a[36:39], v[176:179]
    v_add_u32 v226, s74, v226
    v_cvt_pk_bf16_f32 v184, v168, v169
    v_add_f32 v213, v213, v168
    v_mfma_f32_16x16x32_bf16 v[180:183], a[100:103], a[36:39], v[180:183]
    v_exp_f32 v170, v170
    v_mfma_f32_16x16x32_bf16 v[176:179], a[88:91], a[40:43], v[176:179]
    v_add_f32 v218, v218, v169
    v_add_f32 v213, v213, v170
    v_mfma_f32_16x16x32_bf16 v[180:183], a[104:107], a[40:43], v[180:183]
    v_add_u32 v227, s74, v227
    v_exp_f32 v171, v171
    v_mfma_f32_16x16x32_bf16 v[176:179], a[92:95], a[44:47], v[176:179]
    v_cvt_pk_bf16_f32 v185, v170, v171
    v_add_f32 v218, v218, v171
    v_mfma_f32_16x16x32_bf16 v[180:183], a[108:111], a[44:47], v[180:183]
    s_waitcnt lgkmcnt(0)
    v_exp_f32 v172, v172
    v_mfma_f32_16x16x32_bf16 v[8:11], a[112:115], v[188:191], v[8:11]
    v_add_u32 v228, s74, v228
    v_add_f32 v213, v213, v172
    v_mfma_f32_16x16x32_bf16 v[28:31], a[116:119], v[188:191], v[28:31]
    v_exp_f32 v173, v173
    v_mfma_f32_16x16x32_bf16 v[48:51], a[120:123], v[188:191], v[48:51]
    v_exp_f32 v174, v174
    v_mfma_f32_16x16x32_bf16 v[68:71], a[124:127], v[188:191], v[68:71]
    v_add_u32 v229, s74, v229
    v_cvt_pk_bf16_f32 v186, v172, v173
    v_mfma_f32_16x16x32_bf16 v[88:91], a[128:131], v[188:191], v[88:91]
    v_exp_f32 v175, v175
    v_mfma_f32_16x16x32_bf16 v[108:111], a[132:135], v[188:191], v[108:111]
    v_cvt_pk_bf16_f32 v187, v174, v175
    v_add_f32 v218, v218, v173
    v_mfma_f32_16x16x32_bf16 v[128:131], a[136:139], v[188:191], v[128:131]
    v_add_u32 v230, s74, v230
    v_add_f32 v213, v213, v174
    v_mfma_f32_16x16x32_bf16 v[148:151], a[140:143], v[188:191], v[148:151]
    v_add_f32 v218, v218, v175
    v_mfma_f32_16x16x32_bf16 v[168:171], a[80:83], a[48:51], v[204:207]
    v_exp_f32 v176, v176
    v_mfma_f32_16x16x32_bf16 v[172:175], a[96:99], a[48:51], v[204:207]
    v_add_u32 v231, s74, v231
    v_add_f32 v214, v214, v176
    v_mfma_f32_16x16x32_bf16 v[168:171], a[84:87], a[52:55], v[168:171]
    v_exp_f32 v177, v177
    v_mfma_f32_16x16x32_bf16 v[172:175], a[100:103], a[52:55], v[172:175]
    v_cvt_pk_bf16_f32 v188, v176, v177
    v_add_f32 v219, v219, v177
    v_mfma_f32_16x16x32_bf16 v[168:171], a[88:91], a[56:59], v[168:171]
    v_add_u32 v232, s74, v232
    v_exp_f32 v178, v178
    v_mfma_f32_16x16x32_bf16 v[172:175], a[104:107], a[56:59], v[172:175]
    v_exp_f32 v179, v179
    v_mfma_f32_16x16x32_bf16 v[168:171], a[92:95], a[60:63], v[168:171]
    v_cvt_pk_bf16_f32 v189, v178, v179
    v_add_f32 v214, v214, v178
    v_mfma_f32_16x16x32_bf16 v[172:175], a[108:111], a[60:63], v[172:175]
    v_add_u32 v233, s74, v233
    v_add_f32 v219, v219, v179
    v_mfma_f32_16x16x32_bf16 v[12:15], a[112:115], v[184:187], v[12:15]
    v_exp_f32 v180, v180
    v_mfma_f32_16x16x32_bf16 v[32:35], a[116:119], v[184:187], v[32:35]
    v_exp_f32 v181, v181
    v_mfma_f32_16x16x32_bf16 v[52:55], a[120:123], v[184:187], v[52:55]
    v_cvt_pk_bf16_f32 v190, v180, v181
    v_add_f32 v214, v214, v180
    v_mfma_f32_16x16x32_bf16 v[72:75], a[124:127], v[184:187], v[72:75]
    v_exp_f32 v182, v182
    v_mfma_f32_16x16x32_bf16 v[92:95], a[128:131], v[184:187], v[92:95]
    s_or_b32 s75, s3, s73
    s_cmp_lg_u32 s75, 0
    s_cbranch_scc1 L_noann2
    s_add_u32 s32, s58, 0
    s_addc_u32 s33, s59, 0
    s_and_b32 s33, s33, 0xffff
    s_mov_b32 s34, 256
    s_mov_b32 s35, 0x20000
    s_mov_b64 exec, 1
    v_mov_b32 v249, 0
    v_mov_b32 v250, 1
    buffer_atomic_add v250, v249, s[32:35], 0 offen sc1
    s_mov_b64 exec, -1
L_noann2:
    v_exp_f32 v183, v183
    v_mfma_f32_16x16x32_bf16 v[112:115], a[132:135], v[184:187], v[112:115]
    v_cvt_pk_bf16_f32 v191, v182, v183
    v_add_f32 v219, v219, v181
    v_mfma_f32_16x16x32_bf16 v[132:135], a[136:139], v[184:187], v[132:135]
    s_waitcnt vmcnt(2)
    s_waitcnt vmcnt(0)
    v_add_f32 v214, v214, v182
    v_add_f32 v219, v219, v183
    v_mfma_f32_16x16x32_bf16 v[152:155], a[140:143], v[184:187], v[152:155]
    s_barrier
    v_mfma_f32_16x16x32_bf16 v[176:179], a[80:83], a[64:67], v[208:211]
    ds_read_b128 a[80:83], v222 offset:0
    v_exp_f32 v168, v168
    v_mfma_f32_16x16x32_bf16 v[180:183], a[96:99], a[64:67], v[208:211]
    ds_read_b128 a[96:99], v222 offset:4096
    v_exp_f32 v169, v169
    v_mfma_f32_16x16x32_bf16 v[176:179], a[84:87], a[68:71], v[176:179]
    ds_read_b128 a[84:87], v223 offset:0
    v_cvt_pk_bf16_f32 v184, v168, v169
    v_add_f32 v215, v215, v168
    v_mfma_f32_16x16x32_bf16 v[180:183], a[100:103], a[68:71], v[180:183]
    ds_read_b128 a[100:103], v223 offset:4096
    v_exp_f32 v170, v170
    v_mfma_f32_16x16x32_bf16 v[176:179], a[88:91], a[72:75], v[176:179]
    ds_read_b128 a[88:91], v224 offset:0
    v_add_f32 v220, v220, v169
    v_add_f32 v215, v215, v170
    v_mfma_f32_16x16x32_bf16 v[180:183], a[104:107], a[72:75], v[180:183]
    ds_read_b128 a[104:107], v224 offset:4096
    v_exp_f32 v171, v171
    v_mfma_f32_16x16x32_bf16 v[176:179], a[92:95], a[76:79], v[176:179]
    ds_read_b128 a[92:95], v225 offset:0
    v_cvt_pk_bf16_f32 v185, v170, v171
    v_add_f32 v220, v220, v171
    v_mfma_f32_16x16x32_bf16 v[180:183], a[108:111], a[76:79], v[180:183]
    ds_read_b128 a[108:111], v225 offset:4096
    v_exp_f32 v172, v172
    v_mfma_f32_16x16x32_bf16 v[16:19], a[112:115], v[188:191], v[16:19]
    s_mov_b32 m0, s6
    v_exp_f32 v173, v173
    v_add_f32 v215, v215, v172
    v_mfma_f32_16x16x32_bf16 v[36:39], a[116:119], v[188:191], v[36:39]
    buffer_load_dwordx4 v234, s[8:11], s71 offen nt lds
    v_mfma_f32_16x16x32_bf16 v[56:59], a[120:123], v[188:191], v[56:59]
    buffer_load_dwordx4 v235, s[8:11], s71 offen offset:1024 nt lds
    v_mfma_f32_16x16x32_bf16 v[76:79], a[124:127], v[188:191], v[76:79]
    s_add_u32 m0, s6, 0x10000
    v_exp_f32 v174, v174
    v_cvt_pk_bf16_f32 v186, v172, v173
    v_mfma_f32_16x16x32_bf16 v[96:99], a[128:131], v[188:191], v[96:99]
    buffer_load_dwordx4 v234, s[12:15], s71 offen nt lds
    v_mfma_f32_16x16x32_bf16 v[116:119], a[132:135], v[188:191], v[116:119]
    buffer_load_dwordx4 v235, s[12:15], s71 offen offset:1024 nt lds
    v_mfma_f32_16x16x32_bf16 v[136:139], a[136:139], v[188:191], v[136:139]
    s_add_u32 s71, s71, 8192
    s_add_u32 s6, s6, 8192
    s_and_b32 s6, s6, 0xffff
    s_and_b32 s71, s71, 262143
    s_mov_b32 s7, 0xc000
    v_exp_f32 v175, v175
    v_add_f32 v220, v220, v173
    v_mfma_f32_16x16x32_bf16 v[156:159], a[140:143], v[188:191], v[156:159]
    s_waitcnt lgkmcnt(0)
    v_cvt_pk_bf16_f32 v187, v174, v175
    v_add_f32 v215, v215, v174
    v_add_f32 v220, v220, v175
    v_mfma_f32_16x16x32_bf16 v[168:171], a[80:83], a[0:3], v[192:195]
    v_exp_f32 v176, v176
    v_mfma_f32_16x16x32_bf16 v[172:175], a[96:99], a[0:3], v[192:195]
    v_exp_f32 v177, v177
    v_mfma_f32_16x16x32_bf16 v[168:171], a[84:87], a[4:7], v[168:171]
    v_cvt_pk_bf16_f32 v188, v176, v177
    v_add_f32 v216, v216, v176
    v_mfma_f32_16x16x32_bf16 v[172:175], a[100:103], a[4:7], v[172:175]
    v_exp_f32 v178, v178
    v_mfma_f32_16x16x32_bf16 v[168:171], a[88:91], a[8:11], v[168:171]
    v_add_f32 v221, v221, v177
    v_add_f32 v216, v216, v178
    v_mfma_f32_16x16x32_bf16 v[172:175], a[104:107], a[8:11], v[172:175]
    v_exp_f32 v179, v179
    v_mfma_f32_16x16x32_bf16 v[168:171], a[92:95], a[12:15], v[168:171]
    v_cvt_pk_bf16_f32 v189, v178, v179
    v_add_f32 v221, v221, v179
    v_mfma_f32_16x16x32_bf16 v[172:175], a[108:111], a[12:15], v[172:175]
    v_exp_f32 v180, v180
    v_mfma_f32_16x16x32_bf16 v[20:23], a[112:115], v[184:187], v[20:23]
    v_exp_f32 v181, v181
    v_mfma_f32_16x16x32_bf16 v[40:43], a[116:119], v[184:187], v[40:43]
    v_cvt_pk_bf16_f32 v190, v180, v181
    v_add_f32 v216, v216, v180
    v_mfma_f32_16x16x32_bf16 v[60:63], a[120:123], v[184:187], v[60:63]
    v_exp_f32 v182, v182
    v_mfma_f32_16x16x32_bf16 v[80:83], a[124:127], v[184:187], v[80:83]
    v_add_f32 v221, v221, v181
    v_add_f32 v216, v216, v182
    v_mfma_f32_16x16x32_bf16 v[100:103], a[128:131], v[184:187], v[100:103]
    v_exp_f32 v183, v183
    v_mfma_f32_16x16x32_bf16 v[120:123], a[132:135], v[184:187], v[120:123]
    v_cvt_pk_bf16_f32 v191, v182, v183
    v_add_f32 v221, v221, v183
    v_mfma_f32_16x16x32_bf16 v[140:143], a[136:139], v[184:187], v[140:143]
    v_mfma_f32_16x16x32_bf16 v[160:163], a[140:143], v[184:187], v[160:163]
    v_mfma_f32_16x16x32_bf16 v[176:179], a[80:83], a[16:19], v[196:199]
    v_exp_f32 v168, v168
    v_mfma_f32_16x16x32_bf16 v[180:183], a[96:99], a[16:19], v[196:199]
    v_exp_f32 v169, v169
    v_mfma_f32_16x16x32_bf16 v[176:179], a[84:87], a[20:23], v[176:179]
    v_cvt_pk_bf16_f32 v184, v168, v169
    v_add_f32 v212, v212, v168
    v_mfma_f32_16x16x32_bf16 v[180:183], a[100:103], a[20:23], v[180:183]
    v_exp_f32 v170, v170
    v_mfma_f32_16x16x32_bf16 v[176:179], a[88:91], a[24:27], v[176:179]
    v_add_f32 v217, v217, v169
    v_add_f32 v212, v212, v170
    v_mfma_f32_16x16x32_bf16 v[180:183], a[104:107], a[24:27], v[180:183]
    v_exp_f32 v171, v171
    v_mfma_f32_16x16x32_bf16 v[176:179], a[92:95], a[28:31], v[176:179]
    v_cvt_pk_bf16_f32 v185, v170, v171
    v_add_f32 v217, v217, v171
    v_mfma_f32_16x16x32_bf16 v[180:183], a[108:111], a[28:31], v[180:183]
    v_exp_f32 v172, v172
    v_mfma_f32_16x16x32_bf16 v[24:27], a[112:115], v[188:191], v[24:27]
    ds_read_b64_tr_b16 a[112:113], v226 offset:0
    ds_read_b64_tr_b16 a[114:115], v226 offset:4096
    v_exp_f32 v173, v173
    v_mfma_f32_16x16x32_bf16 v[44:47], a[116:119], v[188:191], v[44:47]
    ds_read_b64_tr_b16 a[116:117], v227 offset:0
    ds_read_b64_tr_b16 a[118:119], v227 offset:4096
    v_exp_f32 v174, v174
    v_mfma_f32_16x16x32_bf16 v[64:67], a[120:123], v[188:191], v[64:67]
    ds_read_b64_tr_b16 a[120:121], v228 offset:0
    ds_read_b64_tr_b16 a[122:123], v228 offset:4096
    v_exp_f32 v175, v175
    v_mfma_f32_16x16x32_bf16 v[84:87], a[124:127], v[188:191], v[84:87]
    ds_read_b64_tr_b16 a[124:125], v229 offset:0
    ds_read_b64_tr_b16 a[126:127], v229 offset:4096
    v_cvt_pk_bf16_f32 v186, v172, v173
    v_cvt_pk_bf16_f32 v187, v174, v175
    v_mfma_f32_16x16x32_bf16 v[104:107], a[128:131], v[188:191], v[104:107]
    ds_read_b64_tr_b16 a[128:129], v230 offset:0
    ds_read_b64_tr_b16 a[130:131], v230 offset:4096
    v_add_f32 v212, v212, v172
    v_mfma_f32_16x16x32_bf16 v[124:127], a[132:135], v[188:191], v[124:127]
    ds_read_b64_tr_b16 a[132:133], v231 offset:0
    ds_read_b64_tr_b16 a[134:135], v231 offset:4096
    v_add_f32 v217, v217, v173
    v_mfma_f32_16x16x32_bf16 v[144:147], a[136:139], v[188:191], v[144:147]
    ds_read_b64_tr_b16 a[136:137], v232 offset:0
    ds_read_b64_tr_b16 a[138:139], v232 offset:4096
    v_add_f32 v212, v212, v174
    v_mfma_f32_16x16x32_bf16 v[164:167], a[140:143], v[188:191], v[164:167]
    ds_read_b64_tr_b16 a[140:141], v233 offset:0
    ds_read_b64_tr_b16 a[142:143], v233 offset:4096
    v_add_f32 v217, v217, v175
    s_mov_b32 s72, 0
.p2align 6
L_loop_a:
    v_mfma_f32_16x16x32_bf16 v[168:171], a[80:83], a[32:35], v[200:203]
    v_exp_f32 v176, v176
    v_mfma_f32_16x16x32_bf16 v[172:175], a[96:99], a[32:35], v[200:203]
    v_exp_f32 v177, v177
    v_mfma_f32_16x16x32_bf16 v[168:171], a[84:87], a[36:39], v[168:171]
    v_cvt_pk_bf16_f32 v188, v176, v177
    v_add_f32 v213, v213, v176
    v_mfma_f32_16x16x32_bf16 v[172:175], a[100:103], a[36:39], v[172:175]
    v_exp_f32 v178, v178
    v_mfma_f32_16x16x32_bf16 v[168:171], a[88:91], a[40:43], v[168:171]
    v_add_f32 v218, v218, v177
    v_add_f32 v213, v213, v178
    v_mfma_f32_16x16x32_bf16 v[172:175], a[104:107], a[40:43], v[172:175]
    v_exp_f32 v179, v179
    v_mfma_f32_16x16x32_bf16 v[168:171], a[92:95], a[44:47], v[168:171]
    v_cvt_pk_bf16_f32 v189, v178, v179
    v_add_f32 v218, v218, v179
    v_mfma_f32_16x16x32_bf16 v[172:175], a[108:111], a[44:47], v[172:175]
    s_waitcnt lgkmcnt(0)
    v_exp_f32 v180, v180
    v_mfma_f32_16x16x32_bf16 v[8:11], a[112:115], v[184:187], v[8:11]
    v_exp_f32 v181, v181
    v_mfma_f32_16x16x32_bf16 v[28:31], a[116:119], v[184:187], v[28:31]
    v_cvt_pk_bf16_f32 v190, v180, v181
    v_add_f32 v213, v213, v180
    v_mfma_f32_16x16x32_bf16 v[48:51], a[120:123], v[184:187], v[48:51]
    v_exp_f32 v182, v182
    v_mfma_f32_16x16x32_bf16 v[68:71], a[124:127], v[184:187], v[68:71]
    v_add_f32 v218, v218, v181
    v_add_f32 v213, v213, v182
    v_mfma_f32_16x16x32_bf16 v[88:91], a[128:131], v[184:187], v[88:91]
    v_exp_f32 v183, v183
    v_mfma_f32_16x16x32_bf16 v[108:111], a[132:135], v[184:187], v[108:111]
    v_cvt_pk_bf16_f32 v191, v182, v183
    v_add_f32 v218, v218, v183
    v_mfma_f32_16x16x32_bf16 v[128:131], a[136:139], v[184:187], v[128:131]
    v_mfma_f32_16x16x32_bf16 v[148:151], a[140:143], v[184:187], v[148:151]
    v_mfma_f32_16x16x32_bf16 v[176:179], a[80:83], a[48:51], v[204:207]
    v_exp_f32 v168, v168
    v_mfma_f32_16x16x32_bf16 v[180:183], a[96:99], a[48:51], v[204:207]
    v_exp_f32 v169, v169
    v_mfma_f32_16x16x32_bf16 v[176:179], a[84:87], a[52:55], v[176:179]
    v_cvt_pk_bf16_f32 v184, v168, v169
    v_add_f32 v214, v214, v168
    v_mfma_f32_16x16x32_bf16 v[180:183], a[100:103], a[52:55], v[180:183]
    v_exp_f32 v170, v170
    v_mfma_f32_16x16x32_bf16 v[176:179], a[88:91], a[56:59], v[176:179]
    v_add_f32 v219, v219, v169
    v_add_f32 v214, v214, v170
    v_mfma_f32_16x16x32_bf16 v[180:183], a[104:107], a[56:59], v[180:183]
    v_exp_f32 v171, v171
    v_mfma_f32_16x16x32_bf16 v[176:179], a[92:95], a[60:63], v[176:179]
    v_cvt_pk_bf16_f32 v185, v170, v171
    v_add_f32 v219, v219, v171
    v_mfma_f32_16x16x32_bf16 v[180:183], a[108:111], a[60:63], v[180:183]
    v_exp_f32 v172, v172
    v_mfma_f32_16x16x32_bf16 v[12:15], a[112:115], v[188:191], v[12:15]
    v_exp_f32 v173, v173
    v_mfma_f32_16x16x32_bf16 v[32:35], a[116:119], v[188:191], v[32:35]
    v_cvt_pk_bf16_f32 v186, v172, v173
    v_add_f32 v214, v214, v172
    v_mfma_f32_16x16x32_bf16 v[52:55], a[120:123], v[188:191], v[52:55]
    v_exp_f32 v174, v174
    v_mfma_f32_16x16x32_bf16 v[72:75], a[124:127], v[188:191], v[72:75]
    v_add_f32 v219, v219, v173
    v_add_f32 v214, v214, v174
    v_mfma_f32_16x16x32_bf16 v[92:95], a[128:131], v[188:191], v[92:95]
    v_exp_f32 v175, v175
    v_mfma_f32_16x16x32_bf16 v[112:115], a[132:135], v[188:191], v[112:115]
    v_cvt_pk_bf16_f32 v187, v174, v175
    v_add_f32 v219, v219, v175
    v_mfma_f32_16x16x32_bf16 v[132:135], a[136:139], v[188:191], v[132:135]
    s_waitcnt vmcnt(2)
    s_waitcnt vmcnt(0)
    v_mfma_f32_16x16x32_bf16 v[152:155], a[140:143], v[188:191], v[152:155]
    s_barrier
    v_mfma_f32_16x16x32_bf16 v[168:171], a[80:83], a[64:67], v[208:211]
    ds_read_b128 a[80:83], v222 offset:8192
    v_exp_f32 v176, v176
    v_mfma_f32_16x16x32_bf16 v[172:175], a[96:99], a[64:67], v[208:211]
    ds_read_b128 a[96:99], v222 offset:12288
    v_exp_f32 v177, v177
    v_mfma_f32_16x16x32_bf16 v[168:171], a[84:87], a[68:71], v[168:171]
    ds_read_b128 a[84:87], v223 offset:8192
    v_cvt_pk_bf16_f32 v188, v176, v177
    v_add_f32 v215, v215, v176
    v_mfma_f32_16x16x32_bf16 v[172:175], a[100:103], a[68:71], v[172:175]
    ds_read_b128 a[100:103], v223 offset:12288
    v_exp_f32 v178, v178
    v_mfma_f32_16x16x32_bf16 v[168:171], a[88:91], a[72:75], v[168:171]
    ds_read_b128 a[88:91], v224 offset:8192
    v_add_f32 v220, v220, v177
    v_add_f32 v215, v215, v178
    v_mfma_f32_16x16x32_bf16 v[172:175], a[104:107], a[72:75], v[172:175]
    ds_read_b128 a[104:107], v224 offset:12288
    v_exp_f32 v179, v179
    v_mfma_f32_16x16x32_bf16 v[168:171], a[92:95], a[76:79], v[168:171]
    ds_read_b128 a[92:95], v225 offset:8192
    v_cvt_pk_bf16_f32 v189, v178, v179
    v_add_f32 v220, v220, v179
    v_mfma_f32_16x16x32_bf16 v[172:175], a[108:111], a[76:79], v[172:175]
    ds_read_b128 a[108:111], v225 offset:12288
    v_exp_f32 v180, v180
    v_mfma_f32_16x16x32_bf16 v[16:19], a[112:115], v[184:187], v[16:19]
    v_xor_b32 v222, s7, v222
    v_add_f32 v215, v215, v180
    v_mfma_f32_16x16x32_bf16 v[36:39], a[116:119], v[184:187], v[36:39]
    v_exp_f32 v181, v181
    v_mfma_f32_16x16x32_bf16 v[56:59], a[120:123], v[184:187], v[56:59]
    v_xor_b32 v223, s7, v223
    v_cvt_pk_bf16_f32 v190, v180, v181
    v_mfma_f32_16x16x32_bf16 v[76:79], a[124:127], v[184:187], v[76:79]
    v_exp_f32 v182, v182
    v_mfma_f32_16x16x32_bf16 v[96:99], a[128:131], v[184:187], v[96:99]
    v_xor_b32 v224, s7, v224
    v_add_f32 v220, v220, v181
    v_mfma_f32_16x16x32_bf16 v[116:119], a[132:135], v[184:187], v[116:119]
    v_exp_f32 v183, v183
    v_mfma_f32_16x16x32_bf16 v[136:139], a[136:139], v[184:187], v[136:139]
    v_xor_b32 v225, s7, v225
    v_cvt_pk_bf16_f32 v191, v182, v183
    v_mfma_f32_16x16x32_bf16 v[156:159], a[140:143], v[184:187], v[156:159]
    s_waitcnt lgkmcnt(0)
    v_add_f32 v215, v215, v182
    v_add_f32 v220, v220, v183
    v_mfma_f32_16x16x32_bf16 v[176:179], a[80:83], a[0:3], v[192:195]
    v_exp_f32 v168, v168
    v_exp_f32 v169, v169
    v_mfma_f32_16x16x32_bf16 v[180:183], a[96:99], a[0:3], v[192:195]
    v_cvt_pk_bf16_f32 v184, v168, v169
    v_add_f32 v216, v216, v168
    v_add_f32 v221, v221, v169
    v_mfma_f32_16x16x32_bf16 v[176:179], a[84:87], a[4:7], v[176:179]
    v_exp_f32 v170, v170
    v_exp_f32 v171, v171
    v_mfma_f32_16x16x32_bf16 v[180:183], a[100:103], a[4:7], v[180:183]
    s_mov_b32 m0, s6
    v_cvt_pk_bf16_f32 v185, v170, v171
    v_add_f32 v216, v216, v170
    v_add_f32 v221, v221, v171
    v_mfma_f32_16x16x32_bf16 v[176:179], a[88:91], a[8:11], v[176:179]
    buffer_load_dwordx4 v234, s[8:11], s71 offen nt lds
    v_mfma_f32_16x16x32_bf16 v[180:183], a[104:107], a[8:11], v[180:183]
    buffer_load_dwordx4 v235, s[8:11], s71 offen offset:1024 nt lds
    v_mfma_f32_16x16x32_bf16 v[176:179], a[92:95], a[12:15], v[176:179]
    s_add_u32 m0, s6, 0x10000
    v_exp_f32 v172, v172
    v_mfma_f32_16x16x32_bf16 v[180:183], a[108:111], a[12:15], v[180:183]
    buffer_load_dwordx4 v234, s[12:15], s71 offen nt lds
    v_mfma_f32_16x16x32_bf16 v[20:23], a[112:115], v[188:191], v[20:23]
    buffer_load_dwordx4 v235, s[12:15], s71 offen offset:1024 nt lds
    v_mfma_f32_16x16x32_bf16 v[40:43], a[116:119], v[188:191], v[40:43]
    s_add_u32 s71, s71, 8192
    s_add_u32 s6, s6, 8192
    s_and_b32 s6, s6, 0xffff
    s_and_b32 s71, s71, 262143
    v_exp_f32 v173, v173
    v_mfma_f32_16x16x32_bf16 v[60:63], a[120:123], v[188:191], v[60:63]
    v_cvt_pk_bf16_f32 v186, v172, v173
    v_add_f32 v216, v216, v172
    v_mfma_f32_16x16x32_bf16 v[80:83], a[124:127], v[188:191], v[80:83]
    v_exp_f32 v174, v174
    v_mfma_f32_16x16x32_bf16 v[100:103], a[128:131], v[188:191], v[100:103]
    v_exp_f32 v175, v175
    v_mfma_f32_16x16x32_bf16 v[120:123], a[132:135], v[188:191], v[120:123]
    v_cvt_pk_bf16_f32 v187, v174, v175
    v_add_f32 v221, v221, v173
    v_mfma_f32_16x16x32_bf16 v[140:143], a[136:139], v[188:191], v[140:143]
    v_add_f32 v216, v216, v174
    v_add_f32 v221, v221, v175
    v_mfma_f32_16x16x32_bf16 v[160:163], a[140:143], v[188:191], v[160:163]
    v_mfma_f32_16x16x32_bf16 v[168:171], a[80:83], a[16:19], v[196:199]
    v_exp_f32 v176, v176
    v_mfma_f32_16x16x32_bf16 v[172:175], a[96:99], a[16:19], v[196:199]
    v_exp_f32 v177, v177
    v_mfma_f32_16x16x32_bf16 v[168:171], a[84:87], a[20:23], v[168:171]
    v_cvt_pk_bf16_f32 v188, v176, v177
    v_add_f32 v212, v212, v176
    v_mfma_f32_16x16x32_bf16 v[172:175], a[100:103], a[20:23], v[172:175]
    v_exp_f32 v178, v178
    v_mfma_f32_16x16x32_bf16 v[168:171], a[88:91], a[24:27], v[168:171]
    v_add_f32 v217, v217, v177
    v_add_f32 v212, v212, v178
    v_mfma_f32_16x16x32_bf16 v[172:175], a[104:107], a[24:27], v[172:175]
    v_exp_f32 v179, v179
    v_mfma_f32_16x16x32_bf16 v[168:171], a[92:95], a[28:31], v[168:171]
    v_cvt_pk_bf16_f32 v189, v178, v179
    v_add_f32 v217, v217, v179
    v_mfma_f32_16x16x32_bf16 v[172:175], a[108:111], a[28:31], v[172:175]
    v_exp_f32 v180, v180
    v_mfma_f32_16x16x32_bf16 v[24:27], a[112:115], v[184:187], v[24:27]
    ds_read_b64_tr_b16 a[112:113], v226 offset:8192
    ds_read_b64_tr_b16 a[114:115], v226 offset:12288
    v_exp_f32 v181, v181
    v_mfma_f32_16x16x32_bf16 v[44:47], a[116:119], v[184:187], v[44:47]
    ds_read_b64_tr_b16 a[116:117], v227 offset:8192
    ds_read_b64_tr_b16 a[118:119], v227 offset:12288
    v_exp_f32 v182, v182
    v_mfma_f32_16x16x32_bf16 v[64:67], a[120:123], v[184:187], v[64:67]
    ds_read_b64_tr_b16 a[120:121], v228 offset:8192
    ds_read_b64_tr_b16 a[122:123], v228 offset:12288
    v_exp_f32 v183, v183
    v_mfma_f32_16x16x32_bf16 v[84:87], a[124:127], v[184:187], v[84:87]
    ds_read_b64_tr_b16 a[124:125], v229 offset:8192
    ds_read_b64_tr_b16 a[126:127], v229 offset:12288
    v_cvt_pk_bf16_f32 v190, v180, v181
    v_cvt_pk_bf16_f32 v191, v182, v183
    v_mfma_f32_16x16x32_bf16 v[104:107], a[128:131], v[184:187], v[104:107]
    ds_read_b64_tr_b16 a[128:129], v230 offset:8192
    ds_read_b64_tr_b16 a[130:131], v230 offset:12288
    v_add_f32 v212, v212, v180
    v_mfma_f32_16x16x32_bf16 v[124:127], a[132:135], v[184:187], v[124:127]
    ds_read_b64_tr_b16 a[132:133], v231 offset:8192
    ds_read_b64_tr_b16 a[134:135], v231 offset:12288
    v_add_f32 v217, v217, v181
    v_mfma_f32_16x16x32_bf16 v[144:147], a[136:139], v[184:187], v[144:147]
    ds_read_b64_tr_b16 a[136:137], v232 offset:8192
    ds_read_b64_tr_b16 a[138:139], v232 offset:12288
    v_add_f32 v212, v212, v182
    v_mfma_f32_16x16x32_bf16 v[164:167], a[140:143], v[184:187], v[164:167]
    ds_read_b64_tr_b16 a[140:141], v233 offset:8192
    ds_read_b64_tr_b16 a[142:143], v233 offset:12288
    v_add_f32 v217, v217, v183
    v_mfma_f32_16x16x32_bf16 v[176:179], a[80:83], a[32:35], v[200:203]
    v_exp_f32 v168, v168
    v_mfma_f32_16x16x32_bf16 v[180:183], a[96:99], a[32:35], v[200:203]
    v_exp_f32 v169, v169
    v_mfma_f32_16x16x32_bf16 v[176:179], a[84:87], a[36:39], v[176:179]
    v_xor_b32 v226, s7, v226
    v_cvt_pk_bf16_f32 v184, v168, v169
    v_add_f32 v213, v213, v168
    v_mfma_f32_16x16x32_bf16 v[180:183], a[100:103], a[36:39], v[180:183]
    v_exp_f32 v170, v170
    v_mfma_f32_16x16x32_bf16 v[176:179], a[88:91], a[40:43], v[176:179]
    v_add_f32 v218, v218, v169
    v_add_f32 v213, v213, v170
    v_mfma_f32_16x16x32_bf16 v[180:183], a[104:107], a[40:43], v[180:183]
    v_xor_b32 v227, s7, v227
    v_exp_f32 v171, v171
    v_mfma_f32_16x16x32_bf16 v[176:179], a[92:95], a[44:47], v[176:179]
    v_cvt_pk_bf16_f32 v185, v170, v171
    v_add_f32 v218, v218, v171
    v_mfma_f32_16x16x32_bf16 v[180:183], a[108:111], a[44:47], v[180:183]
    s_waitcnt lgkmcnt(0)
    v_exp_f32 v172, v172
    v_mfma_f32_16x16x32_bf16 v[8:11], a[112:115], v[188:191], v[8:11]
    v_xor_b32 v228, s7, v228
    v_add_f32 v213, v213, v172
    v_mfma_f32_16x16x32_bf16 v[28:31], a[116:119], v[188:191], v[28:31]
    v_exp_f32 v173, v173
    v_mfma_f32_16x16x32_bf16 v[48:51], a[120:123], v[188:191], v[48:51]
    v_exp_f32 v174, v174
    v_mfma_f32_16x16x32_bf16 v[68:71], a[124:127], v[188:191], v[68:71]
    v_xor_b32 v229, s7, v229
    v_cvt_pk_bf16_f32 v186, v172, v173
    v_mfma_f32_16x16x32_bf16 v[88:91], a[128:131], v[188:191], v[88:91]
    v_exp_f32 v175, v175
    v_mfma_f32_16x16x32_bf16 v[108:111], a[132:135], v[188:191], v[108:111]
    v_cvt_pk_bf16_f32 v187, v174, v175
    v_add_f32 v218, v218, v173
    v_mfma_f32_16x16x32_bf16 v[128:131], a[136:139], v[188:191], v[128:131]
    v_xor_b32 v230, s7, v230
    v_add_f32 v213, v213, v174
    v_mfma_f32_16x16x32_bf16 v[148:151], a[140:143], v[188:191], v[148:151]
    v_add_f32 v218, v218, v175
    v_mfma_f32_16x16x32_bf16 v[168:171], a[80:83], a[48:51], v[204:207]
    v_exp_f32 v176, v176
    v_mfma_f32_16x16x32_bf16 v[172:175], a[96:99], a[48:51], v[204:207]
    v_xor_b32 v231, s7, v231
    v_add_f32 v214, v214, v176
    v_mfma_f32_16x16x32_bf16 v[168:171], a[84:87], a[52:55], v[168:171]
    v_exp_f32 v177, v177
    v_mfma_f32_16x16x32_bf16 v[172:175], a[100:103], a[52:55], v[172:175]
    v_cvt_pk_bf16_f32 v188, v176, v177
    v_add_f32 v219, v219, v177
    v_mfma_f32_16x16x32_bf16 v[168:171], a[88:91], a[56:59], v[168:171]
    v_xor_b32 v232, s7, v232
    v_exp_f32 v178, v178
    v_mfma_f32_16x16x32_bf16 v[172:175], a[104:107], a[56:59], v[172:175]
    v_exp_f32 v179, v179
    v_mfma_f32_16x16x32_bf16 v[168:171], a[92:95], a[60:63], v[168:171]
    v_cvt_pk_bf16_f32 v189, v178, v179
    v_add_f32 v214, v214, v178
    v_mfma_f32_16x16x32_bf16 v[172:175], a[108:111], a[60:63], v[172:175]
    v_xor_b32 v233, s7, v233
    v_add_f32 v219, v219, v179
    v_mfma_f32_16x16x32_bf16 v[12:15], a[112:115], v[184:187], v[12:15]
    v_exp_f32 v180, v180
    v_mfma_f32_16x16x32_bf16 v[32:35], a[116:119], v[184:187], v[32:35]
    v_exp_f32 v181, v181
    v_mfma_f32_16x16x32_bf16 v[52:55], a[120:123], v[184:187], v[52:55]
    v_cvt_pk_bf16_f32 v190, v180, v181
    v_add_f32 v214, v214, v180
    v_mfma_f32_16x16x32_bf16 v[72:75], a[124:127], v[184:187], v[72:75]
    v_exp_f32 v182, v182
    v_mfma_f32_16x16x32_bf16 v[92:95], a[128:131], v[184:187], v[92:95]
    v_exp_f32 v183, v183
    v_mfma_f32_16x16x32_bf16 v[112:115], a[132:135], v[184:187], v[112:115]
    v_cvt_pk_bf16_f32 v191, v182, v183
    v_add_f32 v219, v219, v181
    v_mfma_f32_16x16x32_bf16 v[132:135], a[136:139], v[184:187], v[132:135]
    s_waitcnt vmcnt(2)
    s_waitcnt vmcnt(0)
    v_add_f32 v214, v214, v182
    v_add_f32 v219, v219, v183
    v_mfma_f32_16x16x32_bf16 v[152:155], a[140:143], v[184:187], v[152:155]
    s_barrier
    v_mfma_f32_16x16x32_bf16 v[176:179], a[80:83], a[64:67], v[208:211]
    ds_read_b128 a[80:83], v222 offset:0
    v_exp_f32 v168, v168
    v_mfma_f32_16x16x32_bf16 v[180:183], a[96:99], a[64:67], v[208:211]
    ds_read_b128 a[96:99], v222 offset:4096
    v_exp_f32 v169, v169
    v_mfma_f32_16x16x32_bf16 v[176:179], a[84:87], a[68:71], v[176:179]
    ds_read_b128 a[84:87], v223 offset:0
    v_cvt_pk_bf16_f32 v184, v168, v169
    v_add_f32 v215, v215, v168
    v_mfma_f32_16x16x32_bf16 v[180:183], a[100:103], a[68:71], v[180:183]
    ds_read_b128 a[100:103], v223 offset:4096
    v_exp_f32 v170, v170
    v_mfma_f32_16x16x32_bf16 v[176:179], a[88:91], a[72:75], v[176:179]
    ds_read_b128 a[88:91], v224 offset:0
    v_add_f32 v220, v220, v169
    v_mfma_f32_16x16x32_bf16 v[180:183], a[104:107], a[72:75], v[180:183]
    ds_read_b128 a[104:107], v224 offset:4096
    v_add_f32 v215, v215, v170
    v_mfma_f32_16x16x32_bf16 v[176:179], a[92:95], a[76:79], v[176:179]
    ds_read_b128 a[92:95], v225 offset:0
    v_exp_f32 v171, v171
    v_mfma_f32_16x16x32_bf16 v[180:183], a[108:111], a[76:79], v[180:183]
    ds_read_b128 a[108:111], v225 offset:4096
    v_cvt_pk_bf16_f32 v185, v170, v171
    v_mfma_f32_16x16x32_bf16 v[16:19], a[112:115], v[188:191], v[16:19]
    v_exp_f32 v172, v172
    v_mfma_f32_16x16x32_bf16 v[36:39], a[116:119], v[188:191], v[36:39]
    v_add_f32 v220, v220, v171
    v_add_f32 v215, v215, v172
    v_mfma_f32_16x16x32_bf16 v[56:59], a[120:123], v[188:191], v[56:59]
    v_exp_f32 v173, v173
    v_mfma_f32_16x16x32_bf16 v[76:79], a[124:127], v[188:191], v[76:79]
    v_exp_f32 v174, v174
    v_mfma_f32_16x16x32_bf16 v[96:99], a[128:131], v[188:191], v[96:99]
    v_exp_f32 v175, v175
    v_mfma_f32_16x16x32_bf16 v[116:119], a[132:135], v[188:191], v[116:119]
    v_cvt_pk_bf16_f32 v186, v172, v173
    v_cvt_pk_bf16_f32 v187, v174, v175
    v_mfma_f32_16x16x32_bf16 v[136:139], a[136:139], v[188:191], v[136:139]
    s_xor_b32 s7, s7, 0x8000
    v_add_f32 v220, v220, v173
    v_add_f32 v215, v215, v174
    v_mfma_f32_16x16x32_bf16 v[156:159], a[140:143], v[188:191], v[156:159]
    s_waitcnt lgkmcnt(0)
    v_add_f32 v220, v220, v175
    v_mfma_f32_16x16x32_bf16 v[168:171], a[80:83], a[0:3], v[192:195]
    v_exp_f32 v176, v176
    v_exp_f32 v177, v177
    v_mfma_f32_16x16x32_bf16 v[172:175], a[96:99], a[0:3], v[192:195]
    v_cvt_pk_bf16_f32 v188, v176, v177
    v_add_f32 v216, v216, v176
    v_add_f32 v221, v221, v177
    v_mfma_f32_16x16x32_bf16 v[168:171], a[84:87], a[4:7], v[168:171]
    v_exp_f32 v178, v178
    v_exp_f32 v179, v179
    v_mfma_f32_16x16x32_bf16 v[172:175], a[100:103], a[4:7], v[172:175]
    s_mov_b32 m0, s6
    v_cvt_pk_bf16_f32 v189, v178, v179
    v_add_f32 v216, v216, v178
    v_add_f32 v221, v221, v179
    v_mfma_f32_16x16x32_bf16 v[168:171], a[88:91], a[8:11], v[168:171]
    buffer_load_dwordx4 v234, s[8:11], s71 offen nt lds
    v_mfma_f32_16x16x32_bf16 v[172:175], a[104:107], a[8:11], v[172:175]
    buffer_load_dwordx4 v235, s[8:11], s71 offen offset:1024 nt lds
    v_mfma_f32_16x16x32_bf16 v[168:171], a[92:95], a[12:15], v[168:171]
    s_add_u32 m0, s6, 0x10000
    v_exp_f32 v180, v180
    v_mfma_f32_16x16x32_bf16 v[172:175], a[108:111], a[12:15], v[172:175]
    buffer_load_dwordx4 v234, s[12:15], s71 offen nt lds
    v_mfma_f32_16x16x32_bf16 v[20:23], a[112:115], v[184:187], v[20:23]
    buffer_load_dwordx4 v235, s[12:15], s71 offen offset:1024 nt lds
    v_mfma_f32_16x16x32_bf16 v[40:43], a[116:119], v[184:187], v[40:43]
    s_add_u32 s71, s71, 8192
    s_add_u32 s6, s6, 8192
    s_and_b32 s6, s6, 0xffff
    s_and_b32 s71, s71, 262143
    v_exp_f32 v181, v181
    v_mfma_f32_16x16x32_bf16 v[60:63], a[120:123], v[184:187], v[60:63]
    v_cvt_pk_bf16_f32 v190, v180, v181
    v_add_f32 v216, v216, v180
    v_mfma_f32_16x16x32_bf16 v[80:83], a[124:127], v[184:187], v[80:83]
    v_exp_f32 v182, v182
    v_mfma_f32_16x16x32_bf16 v[100:103], a[128:131], v[184:187], v[100:103]
    v_exp_f32 v183, v183
    v_mfma_f32_16x16x32_bf16 v[120:123], a[132:135], v[184:187], v[120:123]
    v_cvt_pk_bf16_f32 v191, v182, v183
    v_add_f32 v221, v221, v181
    v_mfma_f32_16x16x32_bf16 v[140:143], a[136:139], v[184:187], v[140:143]
    v_add_f32 v216, v216, v182
    v_add_f32 v221, v221, v183
    v_mfma_f32_16x16x32_bf16 v[160:163], a[140:143], v[184:187], v[160:163]
    v_mfma_f32_16x16x32_bf16 v[176:179], a[80:83], a[16:19], v[196:199]
    v_exp_f32 v168, v168
    v_mfma_f32_16x16x32_bf16 v[180:183], a[96:99], a[16:19], v[196:199]
    v_exp_f32 v169, v169
    v_mfma_f32_16x16x32_bf16 v[176:179], a[84:87], a[20:23], v[176:179]
    v_cvt_pk_bf16_f32 v184, v168, v169
    v_add_f32 v212, v212, v168
    v_mfma_f32_16x16x32_bf16 v[180:183], a[100:103], a[20:23], v[180:183]
    v_exp_f32 v170, v170
    v_mfma_f32_16x16x32_bf16 v[176:179], a[88:91], a[24:27], v[176:179]
    v_add_f32 v217, v217, v169
    v_add_f32 v212, v212, v170
    v_mfma_f32_16x16x32_bf16 v[180:183], a[104:107], a[24:27], v[180:183]
    v_exp_f32 v171, v171
    v_mfma_f32_16x16x32_bf16 v[176:179], a[92:95], a[28:31], v[176:179]
    v_cvt_pk_bf16_f32 v185, v170, v171
    v_add_f32 v217, v217, v171
    v_mfma_f32_16x16x32_bf16 v[180:183], a[108:111], a[28:31], v[180:183]
    v_exp_f32 v172, v172
    v_mfma_f32_16x16x32_bf16 v[24:27], a[112:115], v[188:191], v[24:27]
    ds_read_b64_tr_b16 a[112:113], v226 offset:0
    ds_read_b64_tr_b16 a[114:115], v226 offset:4096
    v_exp_f32 v173, v173
    v_mfma_f32_16x16x32_bf16 v[44:47], a[116:119], v[188:191], v[44:47]
    ds_read_b64_tr_b16 a[116:117], v227 offset:0
    ds_read_b64_tr_b16 a[118:119], v227 offset:4096
    v_exp_f32 v174, v174
    v_mfma_f32_16x16x32_bf16 v[64:67], a[120:123], v[188:191], v[64:67]
    ds_read_b64_tr_b16 a[120:121], v228 offset:0
    ds_read_b64_tr_b16 a[122:123], v228 offset:4096
    v_exp_f32 v175, v175
    v_mfma_f32_16x16x32_bf16 v[84:87], a[124:127], v[188:191], v[84:87]
    ds_read_b64_tr_b16 a[124:125], v229 offset:0
    ds_read_b64_tr_b16 a[126:127], v229 offset:4096
    v_cvt_pk_bf16_f32 v186, v172, v173
    v_cvt_pk_bf16_f32 v187, v174, v175
    v_mfma_f32_16x16x32_bf16 v[104:107], a[128:131], v[188:191], v[104:107]
    ds_read_b64_tr_b16 a[128:129], v230 offset:0
    ds_read_b64_tr_b16 a[130:131], v230 offset:4096
    v_add_f32 v212, v212, v172
    v_mfma_f32_16x16x32_bf16 v[124:127], a[132:135], v[188:191], v[124:127]
    ds_read_b64_tr_b16 a[132:133], v231 offset:0
    ds_read_b64_tr_b16 a[134:135], v231 offset:4096
    v_add_f32 v217, v217, v173
    v_mfma_f32_16x16x32_bf16 v[144:147], a[136:139], v[188:191], v[144:147]
    s_add_u32 s72, s72, 1
    ds_read_b64_tr_b16 a[136:137], v232 offset:0
    ds_read_b64_tr_b16 a[138:139], v232 offset:4096
    v_add_f32 v212, v212, v174
    v_mfma_f32_16x16x32_bf16 v[164:167], a[140:143], v[188:191], v[164:167]
    s_cmp_lt_u32 s72, 13
    ds_read_b64_tr_b16 a[140:141], v233 offset:0
    ds_read_b64_tr_b16 a[142:143], v233 offset:4096
    v_add_f32 v217, v217, v175
    s_cbranch_scc1 L_loop_a
    v_mfma_f32_16x16x32_bf16 v[168:171], a[80:83], a[32:35], v[200:203]
    v_exp_f32 v176, v176
    v_mfma_f32_16x16x32_bf16 v[172:175], a[96:99], a[32:35], v[200:203]
    v_exp_f32 v177, v177
    v_mfma_f32_16x16x32_bf16 v[168:171], a[84:87], a[36:39], v[168:171]
    s_lshl_b32 s75, s78, 15
    v_cvt_pk_bf16_f32 v188, v176, v177
    v_add_f32 v213, v213, v176
    v_mfma_f32_16x16x32_bf16 v[172:175], a[100:103], a[36:39], v[172:175]
    v_add_u32 v244, 0, v238
    v_exp_f32 v178, v178
    v_mfma_f32_16x16x32_bf16 v[168:171], a[88:91], a[40:43], v[168:171]
    buffer_load_dword v255, v239, s[20:23], s75 offen
    v_mfma_f32_16x16x32_bf16 v[172:175], a[104:107], a[40:43], v[172:175]
    v_add_f32 v218, v218, v177
    v_add_f32 v213, v213, v178
    v_mfma_f32_16x16x32_bf16 v[168:171], a[92:95], a[44:47], v[168:171]
    v_xor_b32 v245, 0x80, v238
    v_exp_f32 v179, v179
    v_mfma_f32_16x16x32_bf16 v[172:175], a[108:111], a[44:47], v[172:175]
    s_waitcnt lgkmcnt(0)
    v_cvt_pk_bf16_f32 v189, v178, v179
    v_add_f32 v218, v218, v179
    v_mfma_f32_16x16x32_bf16 v[8:11], a[112:115], v[184:187], v[8:11]
    v_exp_f32 v180, v180
    v_mfma_f32_16x16x32_bf16 v[28:31], a[116:119], v[184:187], v[28:31]
    v_add_u32 v245, 3072, v245
    v_exp_f32 v181, v181
    v_mfma_f32_16x16x32_bf16 v[48:51], a[120:123], v[184:187], v[48:51]
    v_exp_f32 v182, v182
    v_mfma_f32_16x16x32_bf16 v[68:71], a[124:127], v[184:187], v[68:71]
    v_exp_f32 v183, v183
    v_mfma_f32_16x16x32_bf16 v[88:91], a[128:131], v[184:187], v[88:91]
    v_add_u32 v246, 6144, v238
    v_cvt_pk_bf16_f32 v190, v180, v181
    v_mfma_f32_16x16x32_bf16 v[108:111], a[132:135], v[184:187], v[108:111]
    v_cvt_pk_bf16_f32 v191, v182, v183
    v_add_f32 v213, v213, v180
    v_mfma_f32_16x16x32_bf16 v[128:131], a[136:139], v[184:187], v[128:131]
    v_add_f32 v218, v218, v181
    v_add_f32 v213, v213, v182
    v_mfma_f32_16x16x32_bf16 v[148:151], a[140:143], v[184:187], v[148:151]
    v_xor_b32 v247, 0x80, v238
    v_add_f32 v218, v218, v183
    v_mfma_f32_16x16x32_bf16 v[176:179], a[80:83], a[48:51], v[204:207]
    v_exp_f32 v168, v168
    v_mfma_f32_16x16x32_bf16 v[180:183], a[96:99], a[48:51], v[204:207]
    v_exp_f32 v169, v169
    v_mfma_f32_16x16x32_bf16 v[176:179], a[84:87], a[52:55], v[176:179]
    v_add_u32 v247, 9216, v247
    v_cvt_pk_bf16_f32 v184, v168, v169
    v_add_f32 v214, v214, v168
    v_mfma_f32_16x16x32_bf16 v[180:183], a[100:103], a[52:55], v[180:183]
    v_exp_f32 v170, v170
    v_mfma_f32_16x16x32_bf16 v[176:179], a[88:91], a[56:59], v[176:179]
    v_add_f32 v219, v219, v169
    v_add_f32 v214, v214, v170
    v_mfma_f32_16x16x32_bf16 v[180:183], a[104:107], a[56:59], v[180:183]
    v_add_u32 v248, 16384, v238
    v_exp_f32 v171, v171
    v_mfma_f32_16x16x32_bf16 v[176:179], a[92:95], a[60:63], v[176:179]
    v_cvt_pk_bf16_f32 v185, v170, v171
    v_add_f32 v219, v219, v171
    v_mfma_f32_16x16x32_bf16 v[180:183], a[108:111], a[60:63], v[180:183]
    v_exp_f32 v172, v172
    v_mfma_f32_16x16x32_bf16 v[12:15], a[112:115], v[188:191], v[12:15]
    v_xor_b32 v249, 0x80, v238
    v_add_f32 v214, v214, v172
    v_mfma_f32_16x16x32_bf16 v[32:35], a[116:119], v[188:191], v[32:35]
    v_exp_f32 v173, v173
    v_mfma_f32_16x16x32_bf16 v[52:55], a[120:123], v[188:191], v[52:55]
    v_exp_f32 v174, v174
    v_mfma_f32_16x16x32_bf16 v[72:75], a[124:127], v[188:191], v[72:75]
    v_add_u32 v249, 19456, v249
    v_cvt_pk_bf16_f32 v186, v172, v173
    v_mfma_f32_16x16x32_bf16 v[92:95], a[128:131], v[188:191], v[92:95]
    v_exp_f32 v175, v175
    v_mfma_f32_16x16x32_bf16 v[112:115], a[132:135], v[188:191], v[112:115]
    v_cvt_pk_bf16_f32 v187, v174, v175
    v_add_f32 v219, v219, v173
    v_mfma_f32_16x16x32_bf16 v[132:135], a[136:139], v[188:191], v[132:135]
    s_waitcnt vmcnt(3)
    s_waitcnt vmcnt(1)
    v_add_u32 v250, 22528, v238
    v_add_f32 v214, v214, v174
    v_mfma_f32_16x16x32_bf16 v[152:155], a[140:143], v[188:191], v[152:155]
    s_barrier
    v_add_f32 v219, v219, v175
    v_mfma_f32_16x16x32_bf16 v[168:171], a[80:83], a[64:67], v[208:211]
    ds_read_b128 a[80:83], v222 offset:8192
    v_exp_f32 v176, v176
    v_mfma_f32_16x16x32_bf16 v[172:175], a[96:99], a[64:67], v[208:211]
    ds_read_b128 a[96:99], v222 offset:12288
    v_xor_b32 v251, 0x80, v238
    v_mfma_f32_16x16x32_bf16 v[168:171], a[84:87], a[68:71], v[168:171]
    ds_read_b128 a[84:87], v223 offset:8192
    v_exp_f32 v177, v177
    v_mfma_f32_16x16x32_bf16 v[172:175], a[100:103], a[68:71], v[172:175]
    ds_read_b128 a[100:103], v223 offset:12288
    v_cvt_pk_bf16_f32 v188, v176, v177
    v_add_f32 v215, v215, v176
    v_mfma_f32_16x16x32_bf16 v[168:171], a[88:91], a[72:75], v[168:171]
    ds_read_b128 a[88:91], v224 offset:8192
    v_add_u32 v251, 25600, v251
    v_mfma_f32_16x16x32_bf16 v[172:175], a[104:107], a[72:75], v[172:175]
    ds_read_b128 a[104:107], v224 offset:12288
    v_exp_f32 v178, v178
    v_mfma_f32_16x16x32_bf16 v[168:171], a[92:95], a[76:79], v[168:171]
    ds_read_b128 a[92:95], v225 offset:8192
    v_add_f32 v220, v220, v177
    v_add_f32 v215, v215, v178
    v_mfma_f32_16x16x32_bf16 v[172:175], a[108:111], a[76:79], v[172:175]
    ds_read_b128 a[108:111], v225 offset:12288
    v_exp_f32 v179, v179
    v_mfma_f32_16x16x32_bf16 v[16:19], a[112:115], v[184:187], v[16:19]
    v_xor_b32 v222, s7, v222
    v_cvt_pk_bf16_f32 v189, v178, v179
    v_add_f32 v220, v220, v179
    v_mfma_f32_16x16x32_bf16 v[36:39], a[116:119], v[184:187], v[36:39]
    v_exp_f32 v180, v180
    v_mfma_f32_16x16x32_bf16 v[56:59], a[120:123], v[184:187], v[56:59]
    v_xor_b32 v223, s7, v223
    v_exp_f32 v181, v181
    v_mfma_f32_16x16x32_bf16 v[76:79], a[124:127], v[184:187], v[76:79]
    v_exp_f32 v182, v182
    v_mfma_f32_16x16x32_bf16 v[96:99], a[128:131], v[184:187], v[96:99]
    v_xor_b32 v224, s7, v224
    v_exp_f32 v183, v183
    v_mfma_f32_16x16x32_bf16 v[116:119], a[132:135], v[184:187], v[116:119]
    v_cvt_pk_bf16_f32 v190, v180, v181
    v_cvt_pk_bf16_f32 v191, v182, v183
    v_mfma_f32_16x16x32_bf16 v[136:139], a[136:139], v[184:187], v[136:139]
    v_xor_b32 v225, s7, v225
    v_add_f32 v215, v215, v180
    v_add_f32 v220, v220, v181
    v_mfma_f32_16x16x32_bf16 v[156:159], a[140:143], v[184:187], v[156:159]
    s_waitcnt lgkmcnt(0)
    v_add_f32 v215, v215, v182
    v_add_f32 v220, v220, v183
    v_mfma_f32_16x16x32_bf16 v[176:179], a[80:83], a[0:3], v[192:195]
    v_exp_f32 v168, v168
    v_exp_f32 v169, v169
    v_mfma_f32_16x16x32_bf16 v[180:183], a[96:99], a[0:3], v[192:195]
    v_cvt_pk_bf16_f32 v184, v168, v169
    v_add_f32 v216, v216, v168
    v_add_f32 v221, v221, v169
    v_mfma_f32_16x16x32_bf16 v[176:179], a[84:87], a[4:7], v[176:179]
    v_exp_f32 v170, v170
    v_exp_f32 v171, v171
    v_mfma_f32_16x16x32_bf16 v[180:183], a[100:103], a[4:7], v[180:183]
    s_mov_b32 m0, s6
    v_cvt_pk_bf16_f32 v185, v170, v171
    v_add_f32 v216, v216, v170
    v_add_f32 v221, v221, v171
    v_mfma_f32_16x16x32_bf16 v[176:179], a[88:91], a[8:11], v[176:179]
    buffer_load_dwordx4 v234, s[8:11], s71 offen nt lds
    v_mfma_f32_16x16x32_bf16 v[180:183], a[104:107], a[8:11], v[180:183]
    buffer_load_dwordx4 v235, s[8:11], s71 offen offset:1024 nt lds
    v_mfma_f32_16x16x32_bf16 v[176:179], a[92:95], a[12:15], v[176:179]
    s_add_u32 m0, s6, 0x10000
    v_exp_f32 v172, v172
    v_mfma_f32_16x16x32_bf16 v[180:183], a[108:111], a[12:15], v[180:183]
    buffer_load_dwordx4 v234, s[12:15], s71 offen nt lds
    v_mfma_f32_16x16x32_bf16 v[20:23], a[112:115], v[188:191], v[20:23]
    buffer_load_dwordx4 v235, s[12:15], s71 offen offset:1024 nt lds
    v_mfma_f32_16x16x32_bf16 v[40:43], a[116:119], v[188:191], v[40:43]
    s_add_u32 s71, s71, 8192
    s_add_u32 s6, s6, 8192
    s_and_b32 s6, s6, 0xffff
    s_and_b32 s71, s71, 262143
    v_exp_f32 v173, v173
    v_mfma_f32_16x16x32_bf16 v[60:63], a[120:123], v[188:191], v[60:63]
    v_cvt_pk_bf16_f32 v186, v172, v173
    v_add_f32 v216, v216, v172
    v_mfma_f32_16x16x32_bf16 v[80:83], a[124:127], v[188:191], v[80:83]
    v_exp_f32 v174, v174
    v_mfma_f32_16x16x32_bf16 v[100:103], a[128:131], v[188:191], v[100:103]
    v_exp_f32 v175, v175
    v_mfma_f32_16x16x32_bf16 v[120:123], a[132:135], v[188:191], v[120:123]
    v_cvt_pk_bf16_f32 v187, v174, v175
    v_add_f32 v221, v221, v173
    v_mfma_f32_16x16x32_bf16 v[140:143], a[136:139], v[188:191], v[140:143]
    v_add_f32 v216, v216, v174
    v_add_f32 v221, v221, v175
    v_mfma_f32_16x16x32_bf16 v[160:163], a[140:143], v[188:191], v[160:163]
    v_mfma_f32_16x16x32_bf16 v[168:171], a[80:83], a[16:19], v[196:199]
    v_exp_f32 v176, v176
    v_mfma_f32_16x16x32_bf16 v[172:175], a[96:99], a[16:19], v[196:199]
    v_exp_f32 v177, v177
    v_mfma_f32_16x16x32_bf16 v[168:171], a[84:87], a[20:23], v[168:171]
    v_cvt_pk_bf16_f32 v188, v176, v177
    v_add_f32 v212, v212, v176
    v_mfma_f32_16x16x32_bf16 v[172:175], a[100:103], a[20:23], v[172:175]
    v_exp_f32 v178, v178
    v_mfma_f32_16x16x32_bf16 v[168:171], a[88:91], a[24:27], v[168:171]
    v_add_f32 v217, v217, v177
    v_add_f32 v212, v212, v178
    v_mfma_f32_16x16x32_bf16 v[172:175], a[104:107], a[24:27], v[172:175]
    v_exp_f32 v179, v179
    v_mfma_f32_16x16x32_bf16 v[168:171], a[92:95], a[28:31], v[168:171]
    v_cvt_pk_bf16_f32 v189, v178, v179
    v_add_f32 v217, v217, v179
    v_mfma_f32_16x16x32_bf16 v[172:175], a[108:111], a[28:31], v[172:175]
    v_exp_f32 v180, v180
    v_mfma_f32_16x16x32_bf16 v[24:27], a[112:115], v[184:187], v[24:27]
    ds_read_b64_tr_b16 a[112:113], v226 offset:8192
    ds_read_b64_tr_b16 a[114:115], v226 offset:12288
    v_exp_f32 v181, v181
    v_mfma_f32_16x16x32_bf16 v[44:47], a[116:119], v[184:187], v[44:47]
    ds_read_b64_tr_b16 a[116:117], v227 offset:8192
    ds_read_b64_tr_b16 a[118:119], v227 offset:12288
    v_exp_f32 v182, v182
    v_mfma_f32_16x16x32_bf16 v[64:67], a[120:123], v[184:187], v[64:67]
    ds_read_b64_tr_b16 a[120:121], v228 offset:8192
    ds_read_b64_tr_b16 a[122:123], v228 offset:12288
    v_exp_f32 v183, v183
    v_mfma_f32_16x16x32_bf16 v[84:87], a[124:127], v[184:187], v[84:87]
    ds_read_b64_tr_b16 a[124:125], v229 offset:8192
    ds_read_b64_tr_b16 a[126:127], v229 offset:12288
    v_cvt_pk_bf16_f32 v190, v180, v181
    v_cvt_pk_bf16_f32 v191, v182, v183
    v_mfma_f32_16x16x32_bf16 v[104:107], a[128:131], v[184:187], v[104:107]
    ds_read_b64_tr_b16 a[128:129], v230 offset:8192
    ds_read_b64_tr_b16 a[130:131], v230 offset:12288
    v_add_f32 v212, v212, v180
    v_mfma_f32_16x16x32_bf16 v[124:127], a[132:135], v[184:187], v[124:127]
    ds_read_b64_tr_b16 a[132:133], v231 offset:8192
    ds_read_b64_tr_b16 a[134:135], v231 offset:12288
    v_add_f32 v217, v217, v181
    v_mfma_f32_16x16x32_bf16 v[144:147], a[136:139], v[184:187], v[144:147]
    ds_read_b64_tr_b16 a[136:137], v232 offset:8192
    ds_read_b64_tr_b16 a[138:139], v232 offset:12288
    v_add_f32 v212, v212, v182
    v_mfma_f32_16x16x32_bf16 v[164:167], a[140:143], v[184:187], v[164:167]
    ds_read_b64_tr_b16 a[140:141], v233 offset:8192
    ds_read_b64_tr_b16 a[142:143], v233 offset:12288
    v_add_f32 v217, v217, v183
    v_mfma_f32_16x16x32_bf16 v[176:179], a[80:83], a[32:35], v[200:203]
    v_exp_f32 v168, v168
    v_mfma_f32_16x16x32_bf16 v[180:183], a[96:99], a[32:35], v[200:203]
    v_exp_f32 v169, v169
    v_mfma_f32_16x16x32_bf16 v[176:179], a[84:87], a[36:39], v[176:179]
    v_xor_b32 v226, s7, v226
    v_cvt_pk_bf16_f32 v184, v168, v169
    v_add_f32 v213, v213, v168
    v_mfma_f32_16x16x32_bf16 v[180:183], a[100:103], a[36:39], v[180:183]
    v_exp_f32 v170, v170
    v_mfma_f32_16x16x32_bf16 v[176:179], a[88:91], a[40:43], v[176:179]
    v_add_f32 v218, v218, v169
    v_add_f32 v213, v213, v170
    v_mfma_f32_16x16x32_bf16 v[180:183], a[104:107], a[40:43], v[180:183]
    v_xor_b32 v227, s7, v227
    v_exp_f32 v171, v171
    v_mfma_f32_16x16x32_bf16 v[176:179], a[92:95], a[44:47], v[176:179]
    v_cvt_pk_bf16_f32 v185, v170, v171
    v_add_f32 v218, v218, v171
    v_mfma_f32_16x16x32_bf16 v[180:183], a[108:111], a[44:47], v[180:183]
    s_waitcnt lgkmcnt(0)
    v_exp_f32 v172, v172
    v_mfma_f32_16x16x32_bf16 v[8:11], a[112:115], v[188:191], v[8:11]
    v_xor_b32 v228, s7, v228
    v_add_f32 v213, v213, v172
    v_mfma_f32_16x16x32_bf16 v[28:31], a[116:119], v[188:191], v[28:31]
    v_exp_f32 v173, v173
    v_mfma_f32_16x16x32_bf16 v[48:51], a[120:123], v[188:191], v[48:51]
    v_exp_f32 v174, v174
    v_mfma_f32_16x16x32_bf16 v[68:71], a[124:127], v[188:191], v[68:71]
    v_xor_b32 v229, s7, v229
    v_cvt_pk_bf16_f32 v186, v172, v173
    v_mfma_f32_16x16x32_bf16 v[88:91], a[128:131], v[188:191], v[88:91]
    v_exp_f32 v175, v175
    v_mfma_f32_16x16x32_bf16 v[108:111], a[132:135], v[188:191], v[108:111]
    v_cvt_pk_bf16_f32 v187, v174, v175
    v_add_f32 v218, v218, v173
    v_mfma_f32_16x16x32_bf16 v[128:131], a[136:139], v[188:191], v[128:131]
    v_xor_b32 v230, s7, v230
    v_add_f32 v213, v213, v174
    v_mfma_f32_16x16x32_bf16 v[148:151], a[140:143], v[188:191], v[148:151]
    v_add_f32 v218, v218, v175
    v_mfma_f32_16x16x32_bf16 v[168:171], a[80:83], a[48:51], v[204:207]
    v_exp_f32 v176, v176
    v_mfma_f32_16x16x32_bf16 v[172:175], a[96:99], a[48:51], v[204:207]
    v_xor_b32 v231, s7, v231
    v_add_f32 v214, v214, v176
    v_mfma_f32_16x16x32_bf16 v[168:171], a[84:87], a[52:55], v[168:171]
    v_exp_f32 v177, v177
    v_mfma_f32_16x16x32_bf16 v[172:175], a[100:103], a[52:55], v[172:175]
    v_cvt_pk_bf16_f32 v188, v176, v177
    v_add_f32 v219, v219, v177
    v_mfma_f32_16x16x32_bf16 v[168:171], a[88:91], a[56:59], v[168:171]
    v_xor_b32 v232, s7, v232
    v_exp_f32 v178, v178
    v_mfma_f32_16x16x32_bf16 v[172:175], a[104:107], a[56:59], v[172:175]
    v_exp_f32 v179, v179
    v_mfma_f32_16x16x32_bf16 v[168:171], a[92:95], a[60:63], v[168:171]
    v_cvt_pk_bf16_f32 v189, v178, v179
    v_add_f32 v214, v214, v178
    v_mfma_f32_16x16x32_bf16 v[172:175], a[108:111], a[60:63], v[172:175]
    v_xor_b32 v233, s7, v233
    v_add_f32 v219, v219, v179
    v_mfma_f32_16x16x32_bf16 v[12:15], a[112:115], v[184:187], v[12:15]
    v_exp_f32 v180, v180
    v_mfma_f32_16x16x32_bf16 v[32:35], a[116:119], v[184:187], v[32:35]
    v_exp_f32 v181, v181
    v_mfma_f32_16x16x32_bf16 v[52:55], a[120:123], v[184:187], v[52:55]
    v_cvt_pk_bf16_f32 v190, v180, v181
    v_add_f32 v214, v214, v180
    v_mfma_f32_16x16x32_bf16 v[72:75], a[124:127], v[184:187], v[72:75]
    v_exp_f32 v182, v182
    v_mfma_f32_16x16x32_bf16 v[92:95], a[128:131], v[184:187], v[92:95]
    v_exp_f32 v183, v183
    v_mfma_f32_16x16x32_bf16 v[112:115], a[132:135], v[184:187], v[112:115]
    v_cvt_pk_bf16_f32 v191, v182, v183
    v_add_f32 v219, v219, v181
    v_mfma_f32_16x16x32_bf16 v[132:135], a[136:139], v[184:187], v[132:135]
    s_waitcnt vmcnt(2)
    s_waitcnt vmcnt(0)
    v_add_f32 v214, v214, v182
    v_add_f32 v219, v219, v183
    v_mfma_f32_16x16x32_bf16 v[152:155], a[140:143], v[184:187], v[152:155]
    s_barrier
    v_mfma_f32_16x16x32_bf16 v[176:179], a[80:83], a[64:67], v[208:211]
    ds_read_b128 a[80:83], v222 offset:0
    v_exp_f32 v168, v168
    v_mfma_f32_16x16x32_bf16 v[180:183], a[96:99], a[64:67], v[208:211]
    ds_read_b128 a[96:99], v222 offset:4096
    v_exp_f32 v169, v169
    v_mfma_f32_16x16x32_bf16 v[176:179], a[84:87], a[68:71], v[176:179]
    ds_read_b128 a[84:87], v223 offset:0
    v_cvt_pk_bf16_f32 v184, v168, v169
    v_add_f32 v215, v215, v168
    v_mfma_f32_16x16x32_bf16 v[180:183], a[100:103], a[68:71], v[180:183]
    ds_read_b128 a[100:103], v223 offset:4096
    v_exp_f32 v170, v170
    v_mfma_f32_16x16x32_bf16 v[176:179], a[88:91], a[72:75], v[176:179]
    ds_read_b128 a[88:91], v224 offset:0
    v_add_f32 v220, v220, v169
    v_mfma_f32_16x16x32_bf16 v[180:183], a[104:107], a[72:75], v[180:183]
    ds_read_b128 a[104:107], v224 offset:4096
    v_add_f32 v215, v215, v170
    v_mfma_f32_16x16x32_bf16 v[176:179], a[92:95], a[76:79], v[176:179]
    ds_read_b128 a[92:95], v225 offset:0
    v_exp_f32 v171, v171
    v_mfma_f32_16x16x32_bf16 v[180:183], a[108:111], a[76:79], v[180:183]
    ds_read_b128 a[108:111], v225 offset:4096
    v_cvt_pk_bf16_f32 v185, v170, v171
    v_mfma_f32_16x16x32_bf16 v[16:19], a[112:115], v[188:191], v[16:19]
    v_exp_f32 v172, v172
    v_mfma_f32_16x16x32_bf16 v[36:39], a[116:119], v[188:191], v[36:39]
    v_add_f32 v220, v220, v171
    v_add_f32 v215, v215, v172
    v_mfma_f32_16x16x32_bf16 v[56:59], a[120:123], v[188:191], v[56:59]
    v_exp_f32 v173, v173
    v_mfma_f32_16x16x32_bf16 v[76:79], a[124:127], v[188:191], v[76:79]
    v_exp_f32 v174, v174
    v_mfma_f32_16x16x32_bf16 v[96:99], a[128:131], v[188:191], v[96:99]
    v_exp_f32 v175, v175
    v_mfma_f32_16x16x32_bf16 v[116:119], a[132:135], v[188:191], v[116:119]
    v_cvt_pk_bf16_f32 v186, v172, v173
    v_cvt_pk_bf16_f32 v187, v174, v175
    v_mfma_f32_16x16x32_bf16 v[136:139], a[136:139], v[188:191], v[136:139]
    s_xor_b32 s7, s7, 0x8000
    v_add_f32 v220, v220, v173
    v_add_f32 v215, v215, v174
    v_mfma_f32_16x16x32_bf16 v[156:159], a[140:143], v[188:191], v[156:159]
    s_waitcnt lgkmcnt(0)
    v_add_f32 v220, v220, v175
    v_mfma_f32_16x16x32_bf16 v[168:171], a[80:83], a[0:3], v[192:195]
    v_exp_f32 v176, v176
    v_exp_f32 v177, v177
    v_mfma_f32_16x16x32_bf16 v[172:175], a[96:99], a[0:3], v[192:195]
    v_cvt_pk_bf16_f32 v188, v176, v177
    v_add_f32 v216, v216, v176
    v_add_f32 v221, v221, v177
    v_mfma_f32_16x16x32_bf16 v[168:171], a[84:87], a[4:7], v[168:171]
    v_exp_f32 v178, v178
    v_exp_f32 v179, v179
    v_mfma_f32_16x16x32_bf16 v[172:175], a[100:103], a[4:7], v[172:175]
    s_mov_b32 m0, s6
    v_cvt_pk_bf16_f32 v189, v178, v179
    v_add_f32 v216, v216, v178
    v_add_f32 v221, v221, v179
    v_mfma_f32_16x16x32_bf16 v[168:171], a[88:91], a[8:11], v[168:171]
    buffer_load_dwordx4 v234, s[8:11], s71 offen nt lds
    v_mfma_f32_16x16x32_bf16 v[172:175], a[104:107], a[8:11], v[172:175]
    buffer_load_dwordx4 v235, s[8:11], s71 offen offset:1024 nt lds
    v_mfma_f32_16x16x32_bf16 v[168:171], a[92:95], a[12:15], v[168:171]
    s_add_u32 m0, s6, 0x10000
    v_exp_f32 v180, v180
    v_mfma_f32_16x16x32_bf16 v[172:175], a[108:111], a[12:15], v[172:175]
    buffer_load_dwordx4 v234, s[12:15], s71 offen nt lds
    v_mfma_f32_16x16x32_bf16 v[20:23], a[112:115], v[184:187], v[20:23]
    buffer_load_dwordx4 v235, s[12:15], s71 offen offset:1024 nt lds
    v_mfma_f32_16x16x32_bf16 v[40:43], a[116:119], v[184:187], v[40:43]
    s_add_u32 s71, s71, 8192
    s_add_u32 s6, s6, 8192
    s_and_b32 s6, s6, 0xffff
    s_and_b32 s71, s71, 262143
    v_exp_f32 v181, v181
    v_mfma_f32_16x16x32_bf16 v[60:63], a[120:123], v[184:187], v[60:63]
    v_cvt_pk_bf16_f32 v190, v180, v181
    v_add_f32 v216, v216, v180
    v_mfma_f32_16x16x32_bf16 v[80:83], a[124:127], v[184:187], v[80:83]
    v_exp_f32 v182, v182
    v_mfma_f32_16x16x32_bf16 v[100:103], a[128:131], v[184:187], v[100:103]
    v_exp_f32 v183, v183
    v_mfma_f32_16x16x32_bf16 v[120:123], a[132:135], v[184:187], v[120:123]
    v_cvt_pk_bf16_f32 v191, v182, v183
    v_add_f32 v221, v221, v181
    v_mfma_f32_16x16x32_bf16 v[140:143], a[136:139], v[184:187], v[140:143]
    v_add_f32 v216, v216, v182
    v_add_f32 v221, v221, v183
    v_mfma_f32_16x16x32_bf16 v[160:163], a[140:143], v[184:187], v[160:163]
    v_mfma_f32_16x16x32_bf16 v[176:179], a[80:83], a[16:19], v[196:199]
    v_exp_f32 v168, v168
    v_mfma_f32_16x16x32_bf16 v[180:183], a[96:99], a[16:19], v[196:199]
    v_exp_f32 v169, v169
    v_mfma_f32_16x16x32_bf16 v[176:179], a[84:87], a[20:23], v[176:179]
    v_cvt_pk_bf16_f32 v184, v168, v169
    v_add_f32 v212, v212, v168
    v_mfma_f32_16x16x32_bf16 v[180:183], a[100:103], a[20:23], v[180:183]
    v_exp_f32 v170, v170
    v_mfma_f32_16x16x32_bf16 v[176:179], a[88:91], a[24:27], v[176:179]
    v_add_f32 v217, v217, v169
    v_add_f32 v212, v212, v170
    v_mfma_f32_16x16x32_bf16 v[180:183], a[104:107], a[24:27], v[180:183]
    v_exp_f32 v171, v171
    v_mfma_f32_16x16x32_bf16 v[176:179], a[92:95], a[28:31], v[176:179]
    v_cvt_pk_bf16_f32 v185, v170, v171
    v_add_f32 v217, v217, v171
    v_mfma_f32_16x16x32_bf16 v[180:183], a[108:111], a[28:31], v[180:183]
    v_exp_f32 v172, v172
    v_mfma_f32_16x16x32_bf16 v[24:27], a[112:115], v[188:191], v[24:27]
    ds_read_b64_tr_b16 a[112:113], v226 offset:0
    ds_read_b64_tr_b16 a[114:115], v226 offset:4096
    v_exp_f32 v173, v173
    v_mfma_f32_16x16x32_bf16 v[44:47], a[116:119], v[188:191], v[44:47]
    ds_read_b64_tr_b16 a[116:117], v227 offset:0
    ds_read_b64_tr_b16 a[118:119], v227 offset:4096
    v_exp_f32 v174, v174
    v_mfma_f32_16x16x32_bf16 v[64:67], a[120:123], v[188:191], v[64:67]
    ds_read_b64_tr_b16 a[120:121], v228 offset:0
    ds_read_b64_tr_b16 a[122:123], v228 offset:4096
    v_exp_f32 v175, v175
    v_mfma_f32_16x16x32_bf16 v[84:87], a[124:127], v[188:191], v[84:87]
    ds_read_b64_tr_b16 a[124:125], v229 offset:0
    ds_read_b64_tr_b16 a[126:127], v229 offset:4096
    v_cvt_pk_bf16_f32 v186, v172, v173
    v_cvt_pk_bf16_f32 v187, v174, v175
    v_mfma_f32_16x16x32_bf16 v[104:107], a[128:131], v[188:191], v[104:107]
    ds_read_b64_tr_b16 a[128:129], v230 offset:0
    ds_read_b64_tr_b16 a[130:131], v230 offset:4096
    v_add_f32 v212, v212, v172
    v_mfma_f32_16x16x32_bf16 v[124:127], a[132:135], v[188:191], v[124:127]
    ds_read_b64_tr_b16 a[132:133], v231 offset:0
    ds_read_b64_tr_b16 a[134:135], v231 offset:4096
    v_add_f32 v217, v217, v173
    v_mfma_f32_16x16x32_bf16 v[144:147], a[136:139], v[188:191], v[144:147]
    ds_read_b64_tr_b16 a[136:137], v232 offset:0
    ds_read_b64_tr_b16 a[138:139], v232 offset:4096
    v_add_f32 v212, v212, v174
    v_mfma_f32_16x16x32_bf16 v[164:167], a[140:143], v[188:191], v[164:167]
    ds_read_b64_tr_b16 a[140:141], v233 offset:0
    ds_read_b64_tr_b16 a[142:143], v233 offset:4096
    v_add_f32 v217, v217, v175
    v_mfma_f32_16x16x32_bf16 v[168:171], a[80:83], a[32:35], v[200:203]
    v_exp_f32 v176, v176
    v_mfma_f32_16x16x32_bf16 v[172:175], a[96:99], a[32:35], v[200:203]
    v_exp_f32 v177, v177
    v_mfma_f32_16x16x32_bf16 v[168:171], a[84:87], a[36:39], v[168:171]
    v_cvt_pk_bf16_f32 v188, v176, v177
    v_add_f32 v213, v213, v176
    v_mfma_f32_16x16x32_bf16 v[172:175], a[100:103], a[36:39], v[172:175]
    v_exp_f32 v178, v178
    v_mfma_f32_16x16x32_bf16 v[168:171], a[88:91], a[40:43], v[168:171]
    v_add_f32 v218, v218, v177
    v_add_f32 v213, v213, v178
    v_mfma_f32_16x16x32_bf16 v[172:175], a[104:107], a[40:43], v[172:175]
    v_exp_f32 v179, v179
    v_mfma_f32_16x16x32_bf16 v[168:171], a[92:95], a[44:47], v[168:171]
    v_cvt_pk_bf16_f32 v189, v178, v179
    v_add_f32 v218, v218, v179
    v_mfma_f32_16x16x32_bf16 v[172:175], a[108:111], a[44:47], v[172:175]
    s_waitcnt lgkmcnt(0)
    v_exp_f32 v180, v180
    v_mfma_f32_16x16x32_bf16 v[8:11], a[112:115], v[184:187], v[8:11]
    v_exp_f32 v181, v181
    v_mfma_f32_16x16x32_bf16 v[28:31], a[116:119], v[184:187], v[28:31]
    v_cvt_pk_bf16_f32 v190, v180, v181
    v_add_f32 v213, v213, v180
    v_mfma_f32_16x16x32_bf16 v[48:51], a[120:123], v[184:187], v[48:51]
    v_exp_f32 v182, v182
    v_mfma_f32_16x16x32_bf16 v[68:71], a[124:127], v[184:187], v[68:71]
    v_add_f32 v218, v218, v181
    v_add_f32 v213, v213, v182
    v_mfma_f32_16x16x32_bf16 v[88:91], a[128:131], v[184:187], v[88:91]
    v_exp_f32 v183, v183
    v_mfma_f32_16x16x32_bf16 v[108:111], a[132:135], v[184:187], v[108:111]
    v_cvt_pk_bf16_f32 v191, v182, v183
    v_add_f32 v218, v218, v183
    v_mfma_f32_16x16x32_bf16 v[128:131], a[136:139], v[184:187], v[128:131]
    v_mfma_f32_16x16x32_bf16 v[148:151], a[140:143], v[184:187], v[148:151]
    v_mfma_f32_16x16x32_bf16 v[176:179], a[80:83], a[48:51], v[204:207]
    v_exp_f32 v168, v168
    v_mfma_f32_16x16x32_bf16 v[180:183], a[96:99], a[48:51], v[204:207]
    v_exp_f32 v169, v169
    v_mfma_f32_16x16x32_bf16 v[176:179], a[84:87], a[52:55], v[176:179]
    v_cvt_pk_bf16_f32 v184, v168, v169
    v_add_f32 v214, v214, v168
    v_mfma_f32_16x16x32_bf16 v[180:183], a[100:103], a[52:55], v[180:183]
    v_exp_f32 v170, v170
    v_mfma_f32_16x16x32_bf16 v[176:179], a[88:91], a[56:59], v[176:179]
    v_add_f32 v219, v219, v169
    v_add_f32 v214, v214, v170
    v_mfma_f32_16x16x32_bf16 v[180:183], a[104:107], a[56:59], v[180:183]
    v_exp_f32 v171, v171
    v_mfma_f32_16x16x32_bf16 v[176:179], a[92:95], a[60:63], v[176:179]
    v_cvt_pk_bf16_f32 v185, v170, v171
    v_add_f32 v219, v219, v171
    v_mfma_f32_16x16x32_bf16 v[180:183], a[108:111], a[60:63], v[180:183]
    v_exp_f32 v172, v172
    v_mfma_f32_16x16x32_bf16 v[12:15], a[112:115], v[188:191], v[12:15]
    v_exp_f32 v173, v173
    v_mfma_f32_16x16x32_bf16 v[32:35], a[116:119], v[188:191], v[32:35]
    v_cvt_pk_bf16_f32 v186, v172, v173
    v_add_f32 v214, v214, v172
    v_mfma_f32_16x16x32_bf16 v[52:55], a[120:123], v[188:191], v[52:55]
    v_exp_f32 v174, v174
    v_mfma_f32_16x16x32_bf16 v[72:75], a[124:127], v[188:191], v[72:75]
    v_add_f32 v219, v219, v173
    v_add_f32 v214, v214, v174
    v_mfma_f32_16x16x32_bf16 v[92:95], a[128:131], v[188:191], v[92:95]
    v_exp_f32 v175, v175
    v_mfma_f32_16x16x32_bf16 v[112:115], a[132:135], v[188:191], v[112:115]
    v_cvt_pk_bf16_f32 v187, v174, v175
    v_add_f32 v219, v219, v175
    v_mfma_f32_16x16x32_bf16 v[132:135], a[136:139], v[188:191], v[132:135]
    s_waitcnt vmcnt(2)
    s_waitcnt vmcnt(0)
    v_mfma_f32_16x16x32_bf16 v[152:155], a[140:143], v[188:191], v[152:155]
    s_barrier
    v_mfma_f32_16x16x32_bf16 v[168:171], a[80:83], a[64:67], v[208:211]
    ds_read_b128 a[80:83], v222 offset:8192
    v_exp_f32 v176, v176
    v_mfma_f32_16x16x32_bf16 v[172:175], a[96:99], a[64:67], v[208:211]
    ds_read_b128 a[96:99], v222 offset:12288
    v_exp_f32 v177, v177
    v_mfma_f32_16x16x32_bf16 v[168:171], a[84:87], a[68:71], v[168:171]
    ds_read_b128 a[84:87], v223 offset:8192
    v_cvt_pk_bf16_f32 v188, v176, v177
    v_add_f32 v215, v215, v176
    v_mfma_f32_16x16x32_bf16 v[172:175], a[100:103], a[68:71], v[172:175]
    ds_read_b128 a[100:103], v223 offset:12288
    v_exp_f32 v178, v178
    v_mfma_f32_16x16x32_bf16 v[168:171], a[88:91], a[72:75], v[168:171]
    ds_read_b128 a[88:91], v224 offset:8192
    v_add_f32 v220, v220, v177
    v_mfma_f32_16x16x32_bf16 v[172:175], a[104:107], a[72:75], v[172:175]
    ds_read_b128 a[104:107], v224 offset:12288
    v_add_f32 v215, v215, v178
    v_mfma_f32_16x16x32_bf16 v[168:171], a[92:95], a[76:79], v[168:171]
    ds_read_b128 a[92:95], v225 offset:8192
    v_exp_f32 v179, v179
    v_mfma_f32_16x16x32_bf16 v[172:175], a[108:111], a[76:79], v[172:175]
    ds_read_b128 a[108:111], v225 offset:12288
    v_cvt_pk_bf16_f32 v189, v178, v179
    v_mfma_f32_16x16x32_bf16 v[16:19], a[112:115], v[184:187], v[16:19]
    v_exp_f32 v180, v180
    v_mfma_f32_16x16x32_bf16 v[36:39], a[116:119], v[184:187], v[36:39]
    v_add_f32 v220, v220, v179
    v_add_f32 v215, v215, v180
    v_mfma_f32_16x16x32_bf16 v[56:59], a[120:123], v[184:187], v[56:59]
    v_exp_f32 v181, v181
    v_mfma_f32_16x16x32_bf16 v[76:79], a[124:127], v[184:187], v[76:79]
    v_exp_f32 v182, v182
    v_mfma_f32_16x16x32_bf16 v[96:99], a[128:131], v[184:187], v[96:99]
    v_exp_f32 v183, v183
    v_mfma_f32_16x16x32_bf16 v[116:119], a[132:135], v[184:187], v[116:119]
    v_cvt_pk_bf16_f32 v190, v180, v181
    v_cvt_pk_bf16_f32 v191, v182, v183
    v_mfma_f32_16x16x32_bf16 v[136:139], a[136:139], v[184:187], v[136:139]
    v_add_f32 v220, v220, v181
    v_add_f32 v215, v215, v182
    v_mfma_f32_16x16x32_bf16 v[156:159], a[140:143], v[184:187], v[156:159]
    s_waitcnt lgkmcnt(0)
    v_add_f32 v220, v220, v183
    v_mfma_f32_16x16x32_bf16 v[176:179], a[80:83], a[0:3], v[192:195]
    v_exp_f32 v168, v168
    v_mfma_f32_16x16x32_bf16 v[180:183], a[96:99], a[0:3], v[192:195]
    v_exp_f32 v169, v169
    v_mfma_f32_16x16x32_bf16 v[176:179], a[84:87], a[4:7], v[176:179]
    v_cvt_pk_bf16_f32 v184, v168, v169
    v_add_f32 v216, v216, v168
    v_mfma_f32_16x16x32_bf16 v[180:183], a[100:103], a[4:7], v[180:183]
    v_exp_f32 v170, v170
    v_mfma_f32_16x16x32_bf16 v[176:179], a[88:91], a[8:11], v[176:179]
    v_add_f32 v221, v221, v169
    v_add_f32 v216, v216, v170
    v_mfma_f32_16x16x32_bf16 v[180:183], a[104:107], a[8:11], v[180:183]
    v_exp_f32 v171, v171
    v_mfma_f32_16x16x32_bf16 v[176:179], a[92:95], a[12:15], v[176:179]
    v_cvt_pk_bf16_f32 v185, v170, v171
    v_add_f32 v221, v221, v171
    v_mfma_f32_16x16x32_bf16 v[180:183], a[108:111], a[12:15], v[180:183]
    v_exp_f32 v172, v172
    v_mfma_f32_16x16x32_bf16 v[20:23], a[112:115], v[188:191], v[20:23]
    v_exp_f32 v173, v173
    v_mfma_f32_16x16x32_bf16 v[40:43], a[116:119], v[188:191], v[40:43]
    v_cvt_pk_bf16_f32 v186, v172, v173
    v_add_f32 v216, v216, v172
    v_mfma_f32_16x16x32_bf16 v[60:63], a[120:123], v[188:191], v[60:63]
    v_exp_f32 v174, v174
    v_mfma_f32_16x16x32_bf16 v[80:83], a[124:127], v[188:191], v[80:83]
    v_add_f32 v221, v221, v173
    v_add_f32 v216, v216, v174
    v_mfma_f32_16x16x32_bf16 v[100:103], a[128:131], v[188:191], v[100:103]
    v_exp_f32 v175, v175
    v_mfma_f32_16x16x32_bf16 v[120:123], a[132:135], v[188:191], v[120:123]
    v_cvt_pk_bf16_f32 v187, v174, v175
    v_add_f32 v221, v221, v175
    v_mfma_f32_16x16x32_bf16 v[140:143], a[136:139], v[188:191], v[140:143]
    v_mfma_f32_16x16x32_bf16 v[160:163], a[140:143], v[188:191], v[160:163]
    v_mfma_f32_16x16x32_bf16 v[168:171], a[80:83], a[16:19], v[196:199]
    v_exp_f32 v176, v176
    v_mfma_f32_16x16x32_bf16 v[172:175], a[96:99], a[16:19], v[196:199]
    v_exp_f32 v177, v177
    v_mfma_f32_16x16x32_bf16 v[168:171], a[84:87], a[20:23], v[168:171]
    v_cvt_pk_bf16_f32 v192, v176, v177
    v_add_f32 v212, v212, v176
    v_mfma_f32_16x16x32_bf16 v[172:175], a[100:103], a[20:23], v[172:175]
    v_exp_f32 v178, v178
    v_mfma_f32_16x16x32_bf16 v[168:171], a[88:91], a[24:27], v[168:171]
    v_add_f32 v217, v217, v177
    v_add_f32 v212, v212, v178
    v_mfma_f32_16x16x32_bf16 v[172:175], a[104:107], a[24:27], v[172:175]
    v_exp_f32 v179, v179
    v_mfma_f32_16x16x32_bf16 v[168:171], a[92:95], a[28:31], v[168:171]
    v_cvt_pk_bf16_f32 v193, v178, v179
    v_add_f32 v217, v217, v179
    v_mfma_f32_16x16x32_bf16 v[172:175], a[108:111], a[28:31], v[172:175]
    v_exp_f32 v180, v180
    v_mfma_f32_16x16x32_bf16 v[24:27], a[112:115], v[184:187], v[24:27]
    v_exp_f32 v181, v181
    v_mfma_f32_16x16x32_bf16 v[44:47], a[116:119], v[184:187], v[44:47]
    v_cvt_pk_bf16_f32 v194, v180, v181
    v_add_f32 v212, v212, v180
    v_mfma_f32_16x16x32_bf16 v[64:67], a[120:123], v[184:187], v[64:67]
    v_exp_f32 v182, v182
    v_mfma_f32_16x16x32_bf16 v[84:87], a[124:127], v[184:187], v[84:87]
    v_add_f32 v217, v217, v181
    v_add_f32 v212, v212, v182
    v_mfma_f32_16x16x32_bf16 v[104:107], a[128:131], v[184:187], v[104:107]
    v_exp_f32 v183, v183
    v_mfma_f32_16x16x32_bf16 v[124:127], a[132:135], v[184:187], v[124:127]
    v_cvt_pk_bf16_f32 v195, v182, v183
    v_add_f32 v217, v217, v183
    v_mfma_f32_16x16x32_bf16 v[144:147], a[136:139], v[184:187], v[144:147]
    v_mfma_f32_16x16x32_bf16 v[164:167], a[140:143], v[184:187], v[164:167]
    v_mfma_f32_16x16x32_bf16 v[176:179], a[80:83], a[32:35], v[200:203]
    v_exp_f32 v168, v168
    v_exp_f32 v169, v169
    v_mfma_f32_16x16x32_bf16 v[180:183], a[96:99], a[32:35], v[200:203]
    v_cvt_pk_bf16_f32 v196, v168, v169
    v_add_f32 v213, v213, v168
    v_exp_f32 v170, v170
    v_mfma_f32_16x16x32_bf16 v[176:179], a[84:87], a[36:39], v[176:179]
    v_add_f32 v218, v218, v169
    v_exp_f32 v171, v171
    v_add_f32 v213, v213, v170
    v_mfma_f32_16x16x32_bf16 v[180:183], a[100:103], a[36:39], v[180:183]
    v_exp_f32 v172, v172
    v_cvt_pk_bf16_f32 v197, v170, v171
    v_add_f32 v218, v218, v171
    v_mfma_f32_16x16x32_bf16 v[176:179], a[88:91], a[40:43], v[176:179]
    v_exp_f32 v173, v173
    v_add_f32 v213, v213, v172
    v_mfma_f32_16x16x32_bf16 v[180:183], a[104:107], a[40:43], v[180:183]
    v_exp_f32 v174, v174
    v_cvt_pk_bf16_f32 v198, v172, v173
    v_mfma_f32_16x16x32_bf16 v[176:179], a[92:95], a[44:47], v[176:179]
    v_exp_f32 v175, v175
    v_add_f32 v218, v218, v173
    v_mfma_f32_16x16x32_bf16 v[180:183], a[108:111], a[44:47], v[180:183]
    v_cvt_pk_bf16_f32 v199, v174, v175
    v_add_f32 v213, v213, v174
    v_add_f32 v218, v218, v175
    v_mfma_f32_16x16x32_bf16 v[168:171], a[80:83], a[48:51], v[204:207]
    v_mfma_f32_16x16x32_bf16 v[172:175], a[96:99], a[48:51], v[204:207]
    v_mfma_f32_16x16x32_bf16 v[168:171], a[84:87], a[52:55], v[168:171]
    v_mfma_f32_16x16x32_bf16 v[172:175], a[100:103], a[52:55], v[172:175]
    v_exp_f32 v176, v176
    v_exp_f32 v177, v177
    v_exp_f32 v178, v178
    v_mfma_f32_16x16x32_bf16 v[168:171], a[88:91], a[56:59], v[168:171]
    v_cvt_pk_bf16_f32 v200, v176, v177
    v_add_f32 v214, v214, v176
    v_add_f32 v219, v219, v177
    v_exp_f32 v179, v179
    v_add_f32 v214, v214, v178
    v_mfma_f32_16x16x32_bf16 v[172:175], a[104:107], a[56:59], v[172:175]
    v_exp_f32 v180, v180
    v_exp_f32 v181, v181
    v_cvt_pk_bf16_f32 v201, v178, v179
    v_add_f32 v219, v219, v179
    v_mfma_f32_16x16x32_bf16 v[168:171], a[92:95], a[60:63], v[168:171]
    v_exp_f32 v182, v182
    v_exp_f32 v183, v183
    v_cvt_pk_bf16_f32 v202, v180, v181
    v_mfma_f32_16x16x32_bf16 v[172:175], a[108:111], a[60:63], v[172:175]
    v_cvt_pk_bf16_f32 v203, v182, v183
    v_add_f32 v214, v214, v180
    v_add_f32 v219, v219, v181
    v_add_f32 v214, v214, v182
    v_add_f32 v219, v219, v183
    v_mfma_f32_16x16x32_bf16 v[176:179], a[80:83], a[64:67], v[208:211]
    v_mfma_f32_16x16x32_bf16 v[180:183], a[96:99], a[64:67], v[208:211]
    v_mfma_f32_16x16x32_bf16 v[176:179], a[84:87], a[68:71], v[176:179]
    v_mfma_f32_16x16x32_bf16 v[180:183], a[100:103], a[68:71], v[180:183]
    v_mfma_f32_16x16x32_bf16 v[176:179], a[88:91], a[72:75], v[176:179]
    v_mfma_f32_16x16x32_bf16 v[180:183], a[104:107], a[72:75], v[180:183]
    v_mfma_f32_16x16x32_bf16 v[176:179], a[92:95], a[76:79], v[176:179]
    v_mfma_f32_16x16x32_bf16 v[180:183], a[108:111], a[76:79], v[180:183]
    v_exp_f32 v168, v168
    v_exp_f32 v169, v169
    v_exp_f32 v170, v170
    v_exp_f32 v171, v171
    v_exp_f32 v172, v172
    v_exp_f32 v173, v173
    v_exp_f32 v174, v174
    v_exp_f32 v175, v175
    v_cvt_pk_bf16_f32 v204, v168, v169
    v_cvt_pk_bf16_f32 v205, v170, v171
    v_cvt_pk_bf16_f32 v206, v172, v173
    v_cvt_pk_bf16_f32 v207, v174, v175
    v_add_f32 v215, v215, v168
    v_add_f32 v220, v220, v169
    v_add_f32 v215, v215, v170
    v_add_f32 v220, v220, v171
    v_add_f32 v215, v215, v172
    v_add_f32 v220, v220, v173
    v_add_f32 v215, v215, v174
    v_add_f32 v220, v220, v175
    v_exp_f32 v176, v176
    v_exp_f32 v177, v177
    v_exp_f32 v178, v178
    v_exp_f32 v179, v179
    v_exp_f32 v180, v180
    v_exp_f32 v181, v181
    v_exp_f32 v182, v182
    v_exp_f32 v183, v183
    v_cvt_pk_bf16_f32 v208, v176, v177
    v_cvt_pk_bf16_f32 v209, v178, v179
    v_cvt_pk_bf16_f32 v210, v180, v181
    v_cvt_pk_bf16_f32 v211, v182, v183
    v_add_f32 v216, v216, v176
    v_add_f32 v221, v221, v177
    v_add_f32 v216, v216, v178
    v_add_f32 v221, v221, v179
    v_add_f32 v216, v216, v180
    v_add_f32 v221, v221, v181
    v_add_f32 v216, v216, v182
    v_add_f32 v221, v221, v183
    ds_read_b64_tr_b16 a[112:113], v226 offset:8192
    ds_read_b64_tr_b16 a[114:115], v226 offset:12288
    ds_read_b64_tr_b16 a[116:117], v227 offset:8192
    ds_read_b64_tr_b16 a[118:119], v227 offset:12288
    ds_read_b64_tr_b16 a[120:121], v228 offset:8192
    ds_read_b64_tr_b16 a[122:123], v228 offset:12288
    ds_read_b64_tr_b16 a[124:125], v229 offset:8192
    ds_read_b64_tr_b16 a[126:127], v229 offset:12288
    ds_read_b64_tr_b16 a[128:129], v230 offset:8192
    ds_read_b64_tr_b16 a[130:131], v230 offset:12288
    ds_read_b64_tr_b16 a[132:133], v231 offset:8192
    ds_read_b64_tr_b16 a[134:135], v231 offset:12288
    ds_read_b64_tr_b16 a[136:137], v232 offset:8192
    ds_read_b64_tr_b16 a[138:139], v232 offset:12288
    ds_read_b64_tr_b16 a[140:141], v233 offset:8192
    ds_read_b64_tr_b16 a[142:143], v233 offset:12288
    s_mov_b32 s100, s3
    s_lshl_b32 s74, s3, 14
    s_lshl_b32 s75, s3, 12
    v_add_f32 v212, v212, v217
    v_add_f32 v213, v213, v218
    v_add_f32 v214, v214, v219
    v_add_f32 v215, v215, v220
    v_add_f32 v216, v216, v221
    v_mov_b32 v217, v212
    v_mov_b32 v218, v213
    v_mov_b32 v219, v214
    v_mov_b32 v220, v215
    v_mov_b32 v221, v216
    v_permlane32_swap_b32 v217, v212
    v_permlane32_swap_b32 v218, v213
    v_permlane32_swap_b32 v219, v214
    v_permlane32_swap_b32 v220, v215
    v_permlane32_swap_b32 v221, v216
    v_add_f32 v212, v212, v217
    v_add_f32 v213, v213, v218
    v_add_f32 v214, v214, v219
    v_add_f32 v215, v215, v220
    v_add_f32 v216, v216, v221
    v_mov_b32 v217, v212
    v_mov_b32 v218, v213
    v_mov_b32 v219, v214
    v_mov_b32 v220, v215
    v_mov_b32 v221, v216
    v_permlane16_swap_b32 v217, v212
    v_permlane16_swap_b32 v218, v213
    v_permlane16_swap_b32 v219, v214
    v_permlane16_swap_b32 v220, v215
    v_permlane16_swap_b32 v221, v216
    v_add_f32 v212, v212, v217
    v_add_f32 v213, v213, v218
    v_add_f32 v214, v214, v219
    v_add_f32 v215, v215, v220
    v_add_f32 v216, v216, v221
    v_rcp_f32 v217, v212
    v_rcp_f32 v218, v213
    v_rcp_f32 v219, v214
    v_rcp_f32 v220, v215
    v_rcp_f32 v221, v216
    v_add_u32 v176, s74, v240
    v_add_u32 v177, s75, v241
    s_waitcnt lgkmcnt(0)
    s_barrier
    s_mov_b32 m0, s62
    v_mfma_f32_16x16x32_bf16 v[8:11], a[112:115], v[192:195], v[8:11]
    buffer_load_dwordx4 v244, s[20:23], s79 offen offset:0 lds
    v_mfma_f32_16x16x32_bf16 v[28:31], a[116:119], v[192:195], v[28:31]
    buffer_load_dwordx4 v245, s[20:23], s79 offen offset:1024 lds
    v_mfma_f32_16x16x32_bf16 v[48:51], a[120:123], v[192:195], v[48:51]
    buffer_load_dwordx4 v246, s[20:23], s79 offen offset:2048 lds
    v_mfma_f32_16x16x32_bf16 v[68:71], a[124:127], v[192:195], v[68:71]
    buffer_load_dwordx4 v247, s[20:23], s79 offen offset:3072 lds
    s_mov_b32 m0, s63
    v_mfma_f32_16x16x32_bf16 v[88:91], a[128:131], v[192:195], v[88:91]
    buffer_load_dwordx4 v248, s[20:23], s79 offen offset:0 lds
    v_mfma_f32_16x16x32_bf16 v[108:111], a[132:135], v[192:195], v[108:111]
    buffer_load_dwordx4 v249, s[20:23], s79 offen offset:1024 lds
    v_mfma_f32_16x16x32_bf16 v[128:131], a[136:139], v[192:195], v[128:131]
    buffer_load_dwordx4 v250, s[20:23], s79 offen offset:2048 lds
    v_mfma_f32_16x16x32_bf16 v[148:151], a[140:143], v[192:195], v[148:151]
    buffer_load_dwordx4 v251, s[20:23], s79 offen offset:3072 lds
    s_add_u32 s79, s79, 32768
    s_and_b32 s79, s79, 524287
    s_mov_b32 m0, s64
    v_mfma_f32_16x16x32_bf16 v[12:15], a[112:115], v[196:199], v[12:15]
    buffer_load_dwordx4 v244, s[20:23], s79 offen offset:0 lds
    v_mfma_f32_16x16x32_bf16 v[32:35], a[116:119], v[196:199], v[32:35]
    buffer_load_dwordx4 v245, s[20:23], s79 offen offset:1024 lds
    v_mfma_f32_16x16x32_bf16 v[52:55], a[120:123], v[196:199], v[52:55]
    buffer_load_dwordx4 v246, s[20:23], s79 offen offset:2048 lds
    v_pk_mul_f32 v[8:9], v[8:9], v[216:217] op_sel:[0,1] op_sel_hi:[1,1]
    v_pk_mul_f32 v[10:11], v[10:11], v[216:217] op_sel:[0,1] op_sel_hi:[1,1]
    v_pk_mul_f32 v[28:29], v[28:29], v[216:217] op_sel:[0,1] op_sel_hi:[1,1]
    v_pk_mul_f32 v[30:31], v[30:31], v[216:217] op_sel:[0,1] op_sel_hi:[1,1]
    v_pk_mul_f32 v[48:49], v[48:49], v[216:217] op_sel:[0,1] op_sel_hi:[1,1]
    v_pk_mul_f32 v[50:51], v[50:51], v[216:217] op_sel:[0,1] op_sel_hi:[1,1]
    v_pk_mul_f32 v[68:69], v[68:69], v[216:217] op_sel:[0,1] op_sel_hi:[1,1]
    v_pk_mul_f32 v[70:71], v[70:71], v[216:217] op_sel:[0,1] op_sel_hi:[1,1]
    v_pk_mul_f32 v[88:89], v[88:89], v[216:217] op_sel:[0,1] op_sel_hi:[1,1]
    v_pk_mul_f32 v[90:91], v[90:91], v[216:217] op_sel:[0,1] op_sel_hi:[1,1]
    v_pk_mul_f32 v[108:109], v[108:109], v[216:217] op_sel:[0,1] op_sel_hi:[1,1]
    v_pk_mul_f32 v[110:111], v[110:111], v[216:217] op_sel:[0,1] op_sel_hi:[1,1]
    v_pk_mul_f32 v[128:129], v[128:129], v[216:217] op_sel:[0,1] op_sel_hi:[1,1]
    v_pk_mul_f32 v[130:131], v[130:131], v[216:217] op_sel:[0,1] op_sel_hi:[1,1]
    v_pk_mul_f32 v[148:149], v[148:149], v[216:217] op_sel:[0,1] op_sel_hi:[1,1]
    v_pk_mul_f32 v[150:151], v[150:151], v[216:217] op_sel:[0,1] op_sel_hi:[1,1]
    v_mfma_f32_16x16x32_bf16 v[72:75], a[124:127], v[196:199], v[72:75]
    v_cvt_pk_bf16_f32 v8, v8, v9
    v_cvt_pk_bf16_f32 v9, v10, v11
    v_cvt_pk_bf16_f32 v10, v28, v29
    v_cvt_pk_bf16_f32 v11, v30, v31
    v_mfma_f32_16x16x32_bf16 v[92:95], a[128:131], v[196:199], v[92:95]
    ds_write_b128 v176, v[8:11] offset:0
    v_cvt_pk_bf16_f32 v48, v48, v49
    v_cvt_pk_bf16_f32 v49, v50, v51
    v_cvt_pk_bf16_f32 v50, v68, v69
    v_cvt_pk_bf16_f32 v51, v70, v71
    v_mfma_f32_16x16x32_bf16 v[112:115], a[132:135], v[196:199], v[112:115]
    ds_write_b128 v176, v[48:51] offset:5120
    v_cvt_pk_bf16_f32 v88, v88, v89
    v_cvt_pk_bf16_f32 v89, v90, v91
    v_cvt_pk_bf16_f32 v90, v108, v109
    v_cvt_pk_bf16_f32 v91, v110, v111
    v_mfma_f32_16x16x32_bf16 v[132:135], a[136:139], v[196:199], v[132:135]
    ds_write_b128 v176, v[88:91] offset:10240
    v_cvt_pk_bf16_f32 v128, v128, v129
    v_cvt_pk_bf16_f32 v129, v130, v131
    v_cvt_pk_bf16_f32 v130, v148, v149
    v_cvt_pk_bf16_f32 v131, v150, v151
    v_mfma_f32_16x16x32_bf16 v[152:155], a[140:143], v[196:199], v[152:155]
    ds_write_b128 v176, v[128:131] offset:15360
    v_mfma_f32_16x16x32_bf16 v[16:19], a[112:115], v[200:203], v[16:19]
    buffer_load_dwordx4 v247, s[20:23], s79 offen offset:3072 lds
    s_mov_b32 m0, s65
    v_mfma_f32_16x16x32_bf16 v[36:39], a[116:119], v[200:203], v[36:39]
    buffer_load_dwordx4 v248, s[20:23], s79 offen offset:0 lds
    v_mfma_f32_16x16x32_bf16 v[56:59], a[120:123], v[200:203], v[56:59]
    buffer_load_dwordx4 v249, s[20:23], s79 offen offset:1024 lds
    v_pk_mul_f32 v[12:13], v[12:13], v[218:219] op_sel_hi:[1,0]
    v_pk_mul_f32 v[14:15], v[14:15], v[218:219] op_sel_hi:[1,0]
    v_pk_mul_f32 v[32:33], v[32:33], v[218:219] op_sel_hi:[1,0]
    v_pk_mul_f32 v[34:35], v[34:35], v[218:219] op_sel_hi:[1,0]
    v_pk_mul_f32 v[52:53], v[52:53], v[218:219] op_sel_hi:[1,0]
    v_pk_mul_f32 v[54:55], v[54:55], v[218:219] op_sel_hi:[1,0]
    v_pk_mul_f32 v[72:73], v[72:73], v[218:219] op_sel_hi:[1,0]
    v_pk_mul_f32 v[74:75], v[74:75], v[218:219] op_sel_hi:[1,0]
    v_pk_mul_f32 v[92:93], v[92:93], v[218:219] op_sel_hi:[1,0]
    v_pk_mul_f32 v[94:95], v[94:95], v[218:219] op_sel_hi:[1,0]
    v_pk_mul_f32 v[112:113], v[112:113], v[218:219] op_sel_hi:[1,0]
    v_pk_mul_f32 v[114:115], v[114:115], v[218:219] op_sel_hi:[1,0]
    v_pk_mul_f32 v[132:133], v[132:133], v[218:219] op_sel_hi:[1,0]
    v_pk_mul_f32 v[134:135], v[134:135], v[218:219] op_sel_hi:[1,0]
    v_pk_mul_f32 v[152:153], v[152:153], v[218:219] op_sel_hi:[1,0]
    v_pk_mul_f32 v[154:155], v[154:155], v[218:219] op_sel_hi:[1,0]
    v_mfma_f32_16x16x32_bf16 v[76:79], a[124:127], v[200:203], v[76:79]
    v_cvt_pk_bf16_f32 v12, v12, v13
    v_cvt_pk_bf16_f32 v13, v14, v15
    v_cvt_pk_bf16_f32 v14, v32, v33
    v_cvt_pk_bf16_f32 v15, v34, v35
    v_mfma_f32_16x16x32_bf16 v[96:99], a[128:131], v[200:203], v[96:99]
    ds_write_b128 v176, v[12:15] offset:1024
    v_cvt_pk_bf16_f32 v52, v52, v53
    v_cvt_pk_bf16_f32 v53, v54, v55
    v_cvt_pk_bf16_f32 v54, v72, v73
    v_cvt_pk_bf16_f32 v55, v74, v75
    v_mfma_f32_16x16x32_bf16 v[116:119], a[132:135], v[200:203], v[116:119]
    ds_write_b128 v176, v[52:55] offset:6144
    v_cvt_pk_bf16_f32 v92, v92, v93
    v_cvt_pk_bf16_f32 v93, v94, v95
    v_cvt_pk_bf16_f32 v94, v112, v113
    v_cvt_pk_bf16_f32 v95, v114, v115
    v_mfma_f32_16x16x32_bf16 v[136:139], a[136:139], v[200:203], v[136:139]
    ds_write_b128 v176, v[92:95] offset:11264
    v_cvt_pk_bf16_f32 v132, v132, v133
    v_cvt_pk_bf16_f32 v133, v134, v135
    v_cvt_pk_bf16_f32 v134, v152, v153
    v_cvt_pk_bf16_f32 v135, v154, v155
    v_mfma_f32_16x16x32_bf16 v[156:159], a[140:143], v[200:203], v[156:159]
    ds_write_b128 v177, v[132:135] offset:0
    v_mfma_f32_16x16x32_bf16 v[20:23], a[112:115], v[204:207], v[20:23]
    buffer_load_dwordx4 v250, s[20:23], s79 offen offset:2048 lds
    v_mfma_f32_16x16x32_bf16 v[40:43], a[116:119], v[204:207], v[40:43]
    buffer_load_dwordx4 v251, s[20:23], s79 offen offset:3072 lds
    s_add_u32 s79, s79, 32768
    s_and_b32 s79, s79, 524287
    v_mfma_f32_16x16x32_bf16 v[60:63], a[120:123], v[204:207], v[60:63]
    v_pk_mul_f32 v[16:17], v[16:17], v[218:219] op_sel:[0,1] op_sel_hi:[1,1]
    v_pk_mul_f32 v[18:19], v[18:19], v[218:219] op_sel:[0,1] op_sel_hi:[1,1]
    v_pk_mul_f32 v[36:37], v[36:37], v[218:219] op_sel:[0,1] op_sel_hi:[1,1]
    v_pk_mul_f32 v[38:39], v[38:39], v[218:219] op_sel:[0,1] op_sel_hi:[1,1]
    v_pk_mul_f32 v[56:57], v[56:57], v[218:219] op_sel:[0,1] op_sel_hi:[1,1]
    v_pk_mul_f32 v[58:59], v[58:59], v[218:219] op_sel:[0,1] op_sel_hi:[1,1]
    v_pk_mul_f32 v[76:77], v[76:77], v[218:219] op_sel:[0,1] op_sel_hi:[1,1]
    v_pk_mul_f32 v[78:79], v[78:79], v[218:219] op_sel:[0,1] op_sel_hi:[1,1]
    v_pk_mul_f32 v[96:97], v[96:97], v[218:219] op_sel:[0,1] op_sel_hi:[1,1]
    v_pk_mul_f32 v[98:99], v[98:99], v[218:219] op_sel:[0,1] op_sel_hi:[1,1]
    v_pk_mul_f32 v[116:117], v[116:117], v[218:219] op_sel:[0,1] op_sel_hi:[1,1]
    v_pk_mul_f32 v[118:119], v[118:119], v[218:219] op_sel:[0,1] op_sel_hi:[1,1]
    v_pk_mul_f32 v[136:137], v[136:137], v[218:219] op_sel:[0,1] op_sel_hi:[1,1]
    v_pk_mul_f32 v[138:139], v[138:139], v[218:219] op_sel:[0,1] op_sel_hi:[1,1]
    v_pk_mul_f32 v[156:157], v[156:157], v[218:219] op_sel:[0,1] op_sel_hi:[1,1]
    v_pk_mul_f32 v[158:159], v[158:159], v[218:219] op_sel:[0,1] op_sel_hi:[1,1]
    v_mfma_f32_16x16x32_bf16 v[80:83], a[124:127], v[204:207], v[80:83]
    v_cvt_pk_bf16_f32 v16, v16, v17
    v_cvt_pk_bf16_f32 v17, v18, v19
    v_cvt_pk_bf16_f32 v18, v36, v37
    v_cvt_pk_bf16_f32 v19, v38, v39
    v_mfma_f32_16x16x32_bf16 v[100:103], a[128:131], v[204:207], v[100:103]
    ds_write_b128 v176, v[16:19] offset:2048
    v_cvt_pk_bf16_f32 v56, v56, v57
    v_cvt_pk_bf16_f32 v57, v58, v59
    v_cvt_pk_bf16_f32 v58, v76, v77
    v_cvt_pk_bf16_f32 v59, v78, v79
    v_mfma_f32_16x16x32_bf16 v[120:123], a[132:135], v[204:207], v[120:123]
    ds_write_b128 v176, v[56:59] offset:7168
    v_cvt_pk_bf16_f32 v96, v96, v97
    v_cvt_pk_bf16_f32 v97, v98, v99
    v_cvt_pk_bf16_f32 v98, v116, v117
    v_cvt_pk_bf16_f32 v99, v118, v119
    v_mfma_f32_16x16x32_bf16 v[140:143], a[136:139], v[204:207], v[140:143]
    ds_write_b128 v176, v[96:99] offset:12288
    v_cvt_pk_bf16_f32 v136, v136, v137
    v_cvt_pk_bf16_f32 v137, v138, v139
    v_cvt_pk_bf16_f32 v138, v156, v157
    v_cvt_pk_bf16_f32 v139, v158, v159
    v_mfma_f32_16x16x32_bf16 v[160:163], a[140:143], v[204:207], v[160:163]
    ds_write_b128 v177, v[136:139] offset:1024
    v_mfma_f32_16x16x32_bf16 v[24:27], a[112:115], v[208:211], v[24:27]
    v_mfma_f32_16x16x32_bf16 v[44:47], a[116:119], v[208:211], v[44:47]
    v_mfma_f32_16x16x32_bf16 v[64:67], a[120:123], v[208:211], v[64:67]
    v_pk_mul_f32 v[20:21], v[20:21], v[220:221] op_sel_hi:[1,0]
    v_pk_mul_f32 v[22:23], v[22:23], v[220:221] op_sel_hi:[1,0]
    v_pk_mul_f32 v[40:41], v[40:41], v[220:221] op_sel_hi:[1,0]
    v_pk_mul_f32 v[42:43], v[42:43], v[220:221] op_sel_hi:[1,0]
    v_pk_mul_f32 v[60:61], v[60:61], v[220:221] op_sel_hi:[1,0]
    v_pk_mul_f32 v[62:63], v[62:63], v[220:221] op_sel_hi:[1,0]
    v_pk_mul_f32 v[80:81], v[80:81], v[220:221] op_sel_hi:[1,0]
    v_pk_mul_f32 v[82:83], v[82:83], v[220:221] op_sel_hi:[1,0]
    v_pk_mul_f32 v[100:101], v[100:101], v[220:221] op_sel_hi:[1,0]
    v_pk_mul_f32 v[102:103], v[102:103], v[220:221] op_sel_hi:[1,0]
    v_pk_mul_f32 v[120:121], v[120:121], v[220:221] op_sel_hi:[1,0]
    v_pk_mul_f32 v[122:123], v[122:123], v[220:221] op_sel_hi:[1,0]
    v_pk_mul_f32 v[140:141], v[140:141], v[220:221] op_sel_hi:[1,0]
    v_pk_mul_f32 v[142:143], v[142:143], v[220:221] op_sel_hi:[1,0]
    v_pk_mul_f32 v[160:161], v[160:161], v[220:221] op_sel_hi:[1,0]
    v_pk_mul_f32 v[162:163], v[162:163], v[220:221] op_sel_hi:[1,0]
    v_mfma_f32_16x16x32_bf16 v[84:87], a[124:127], v[208:211], v[84:87]
    v_cvt_pk_bf16_f32 v20, v20, v21
    v_cvt_pk_bf16_f32 v21, v22, v23
    v_cvt_pk_bf16_f32 v22, v40, v41
    v_cvt_pk_bf16_f32 v23, v42, v43
    v_mfma_f32_16x16x32_bf16 v[104:107], a[128:131], v[208:211], v[104:107]
    ds_write_b128 v176, v[20:23] offset:3072
    v_cvt_pk_bf16_f32 v60, v60, v61
    v_cvt_pk_bf16_f32 v61, v62, v63
    v_cvt_pk_bf16_f32 v62, v80, v81
    v_cvt_pk_bf16_f32 v63, v82, v83
    v_mfma_f32_16x16x32_bf16 v[124:127], a[132:135], v[208:211], v[124:127]
    ds_write_b128 v176, v[60:63] offset:8192
    v_cvt_pk_bf16_f32 v100, v100, v101
    v_cvt_pk_bf16_f32 v101, v102, v103
    v_cvt_pk_bf16_f32 v102, v120, v121
    v_cvt_pk_bf16_f32 v103, v122, v123
    v_mfma_f32_16x16x32_bf16 v[144:147], a[136:139], v[208:211], v[144:147]
    ds_write_b128 v176, v[100:103] offset:13312
    v_cvt_pk_bf16_f32 v140, v140, v141
    v_cvt_pk_bf16_f32 v141, v142, v143
    v_cvt_pk_bf16_f32 v142, v160, v161
    v_cvt_pk_bf16_f32 v143, v162, v163
    v_mfma_f32_16x16x32_bf16 v[164:167], a[140:143], v[208:211], v[164:167]
    ds_write_b128 v177, v[140:143] offset:2048
    v_pk_mul_f32 v[24:25], v[24:25], v[220:221] op_sel:[0,1] op_sel_hi:[1,1]
    v_pk_mul_f32 v[26:27], v[26:27], v[220:221] op_sel:[0,1] op_sel_hi:[1,1]
    v_pk_mul_f32 v[44:45], v[44:45], v[220:221] op_sel:[0,1] op_sel_hi:[1,1]
    v_pk_mul_f32 v[46:47], v[46:47], v[220:221] op_sel:[0,1] op_sel_hi:[1,1]
    v_pk_mul_f32 v[64:65], v[64:65], v[220:221] op_sel:[0,1] op_sel_hi:[1,1]
    v_pk_mul_f32 v[66:67], v[66:67], v[220:221] op_sel:[0,1] op_sel_hi:[1,1]
    v_pk_mul_f32 v[84:85], v[84:85], v[220:221] op_sel:[0,1] op_sel_hi:[1,1]
    v_pk_mul_f32 v[86:87], v[86:87], v[220:221] op_sel:[0,1] op_sel_hi:[1,1]
    v_pk_mul_f32 v[104:105], v[104:105], v[220:221] op_sel:[0,1] op_sel_hi:[1,1]
    v_pk_mul_f32 v[106:107], v[106:107], v[220:221] op_sel:[0,1] op_sel_hi:[1,1]
    v_pk_mul_f32 v[124:125], v[124:125], v[220:221] op_sel:[0,1] op_sel_hi:[1,1]
    v_pk_mul_f32 v[126:127], v[126:127], v[220:221] op_sel:[0,1] op_sel_hi:[1,1]
    v_pk_mul_f32 v[144:145], v[144:145], v[220:221] op_sel:[0,1] op_sel_hi:[1,1]
    v_pk_mul_f32 v[146:147], v[146:147], v[220:221] op_sel:[0,1] op_sel_hi:[1,1]
    v_pk_mul_f32 v[164:165], v[164:165], v[220:221] op_sel:[0,1] op_sel_hi:[1,1]
    v_pk_mul_f32 v[166:167], v[166:167], v[220:221] op_sel:[0,1] op_sel_hi:[1,1]
    v_cvt_pk_bf16_f32 v24, v24, v25
    v_cvt_pk_bf16_f32 v25, v26, v27
    v_cvt_pk_bf16_f32 v26, v44, v45
    v_cvt_pk_bf16_f32 v27, v46, v47
    ds_write_b128 v176, v[24:27] offset:4096
    v_cvt_pk_bf16_f32 v64, v64, v65
    v_cvt_pk_bf16_f32 v65, v66, v67
    v_cvt_pk_bf16_f32 v66, v84, v85
    v_cvt_pk_bf16_f32 v67, v86, v87
    ds_write_b128 v176, v[64:67] offset:9216
    v_cvt_pk_bf16_f32 v104, v104, v105
    v_cvt_pk_bf16_f32 v105, v106, v107
    v_cvt_pk_bf16_f32 v106, v124, v125
    v_cvt_pk_bf16_f32 v107, v126, v127
    ds_write_b128 v176, v[104:107] offset:14336
    v_cvt_pk_bf16_f32 v144, v144, v145
    v_cvt_pk_bf16_f32 v145, v146, v147
    v_cvt_pk_bf16_f32 v146, v164, v165
    v_cvt_pk_bf16_f32 v147, v166, v167
    ds_write_b128 v177, v[144:147] offset:3072
    s_lshl_b32 s74, s3, 14
    v_and_b32 v222, 0x3fff, v222
    v_add_u32 v222, s74, v222
    v_and_b32 v223, 0x3fff, v223
    v_add_u32 v223, s74, v223
    v_and_b32 v224, 0x3fff, v224
    v_add_u32 v224, s74, v224
    v_and_b32 v225, 0x3fff, v225
    v_add_u32 v225, s74, v225
    s_add_u32 s74, s74, 0x10000
    v_and_b32 v226, 0x3fff, v226
    v_add_u32 v226, s74, v226
    v_and_b32 v227, 0x3fff, v227
    v_add_u32 v227, s74, v227
    v_and_b32 v228, 0x3fff, v228
    v_add_u32 v228, s74, v228
    v_and_b32 v229, 0x3fff, v229
    v_add_u32 v229, s74, v229
    v_and_b32 v230, 0x3fff, v230
    v_add_u32 v230, s74, v230
    v_and_b32 v231, 0x3fff, v231
    v_add_u32 v231, s74, v231
    v_and_b32 v232, 0x3fff, v232
    v_add_u32 v232, s74, v232
    v_and_b32 v233, 0x3fff, v233
    v_add_u32 v233, s74, v233
    s_branch L_join
L_code_end:
.section .rodata,"a"
.p2align 6
.amdhsa_kernel concat_heads__gqa_block_cached__mha_block_cached__near_ridge_kernel
  .amdhsa_next_free_vgpr 512
  .amdhsa_next_free_sgpr 102
  .amdhsa_accum_offset 256
  .amdhsa_group_segment_fixed_size 0
  .amdhsa_kernarg_size 104
  .amdhsa_user_sgpr_count 2
  .amdhsa_user_sgpr_kernarg_segment_ptr 1
  .amdhsa_system_sgpr_workgroup_id_x 1
.end_amdhsa_kernel
```
